```python
import torch

def _softmax(x, axis=-1):
    return torch.softmax(x, dim=axis)
def _gelu(x):
    return torch.nn.functional.gelu(x, approximate="tanh")
def _silu(x):
    return torch.nn.functional.silu(x)
def _sigmoid(x):
    return torch.sigmoid(x)
def _layernorm(x, axis=-1, eps=1e-5):
    m = x.mean(dim=axis, keepdim=True)
    v = x.var(dim=axis, keepdim=True, unbiased=False)
    return (x - m) / torch.sqrt(v + eps)
def _scatter_add(tgt, idx, src, axis=0):
    return tgt.clone().index_add_(axis, idx, src)
def _segment_sum(src, seg, n):
    out = torch.zeros((n,) + src.shape[1:], dtype=src.dtype)
    return out.index_add_(0, seg, src)
def _pad(x, pw):
    flat = tuple(v for pair in reversed(pw) for v in pair)
    return torch.nn.functional.pad(x, flat)

kernel_name = 'parallel_sum__sliding_block__mixer_channel_mlp__prompt'

def setup_inputs():

    _w = (lambda a: (lambda t: t.to(torch.bfloat16) if t.is_floating_point() else t)(torch.as_tensor(a)))
    def _A_setup():
        B, S, D = 1, 2048, 1024
        return {
            "x": _w((lambda *s: torch.randn(*s, dtype=torch.bfloat16) * 0.05)(B, S, D)),
            "wqkv": _w((lambda *s: torch.randn(*s, dtype=torch.bfloat16) * 0.05)(D, 3 * D)),
            "wo": _w((lambda *s: torch.randn(*s, dtype=torch.bfloat16) * 0.05)(D, D)),
        }
    _A_in = _A_setup()

    def _B_setup():
        B, S, D, F = 1, 2048, 1024, 3584
        return {
            "x": _w((lambda *s: torch.randn(*s, dtype=torch.bfloat16) * 0.05)(B, S, D)),
            "w1": _w((lambda *s: torch.randn(*s, dtype=torch.bfloat16) * 3.2)(D, F) * (D ** -0.5)),
            "b1": _w((lambda *s: torch.randn(*s, dtype=torch.bfloat16) * 1.6)(F)),
            "w2": _w((lambda *s: torch.randn(*s, dtype=torch.bfloat16) * 0.4)(F, D) * (F ** -0.5)),
            "b2": _w((lambda *s: torch.randn(*s, dtype=torch.bfloat16) * 0.8)(D)),
        }
    _B_in = _B_setup()

    return {
        "A_x": _A_in["x"],
        "A_wqkv": _A_in["wqkv"],
        "A_wo": _A_in["wo"],
        "B_x": _B_in["x"],
        "B_w1": _B_in["w1"],
        "B_b1": _B_in["b1"],
        "B_w2": _B_in["w2"],
        "B_b2": _B_in["b2"],
    }

def reference(A_x, A_wqkv, A_wo, B_x, B_w1, B_b1, B_w2, B_b2):
    def _A_ref(x, wqkv, wo):
        B, S, D = x.shape
        H = 32; Dh = D // H; W = 256
        qkv = (lambda x, *d: x.permute(*d))((x @ wqkv).reshape(B, S, 3, H, Dh), 2, 0, 3, 1, 4)
        q, k, v = qkv[0], qkv[1], qkv[2]
        scores = torch.einsum("bhqd,bhkd->bhqk", q, k) * (Dh ** -0.5)
        idx = torch.arange(S)
        mask = (idx[:, None] - idx[None, :] >= 0) & (idx[:, None] - idx[None, :] < W)
        scores = torch.where(mask[None, None], scores, -1e9)
        p = _softmax(scores, axis=-1)
        o = torch.einsum("bhqk,bhkd->bhqd", p, v)
        return (lambda x, *d: x.permute(*d))(o, 0, 2, 1, 3).reshape(B, S, D) @ wo

    def _B_ref(x, w1, b1, w2, b2):
        y = _layernorm(x, axis=-1)
        h = _gelu(torch.einsum("bsd,df->bsf", y, w1) + b1)
        return torch.einsum("bsf,fd->bsd", h, w2) + b2

    x = A_x
    xn = _layernorm(x, axis=-1)
    return x + _A_ref(xn, A_wqkv, A_wo) + _B_ref(xn, B_w1, B_b1, B_w2, B_b2)
```

```asm
; @launch grid=(256,1,1) block=(512,1,1) lds=163840
.amdgcn_target "amdgcn-amd-amdhsa--gfx950"
.text
.globl parallel_sum__sliding_block__mixer_channel_mlp__prompt_kernel
.p2align 8
.type parallel_sum__sliding_block__mixer_channel_mlp__prompt_kernel,@function
parallel_sum__sliding_block__mixer_channel_mlp__prompt_kernel:
    s_cmp_ge_u32 s2, 256
    s_cbranch_scc1 L_k1_done
    s_load_dwordx4 s[20:23], s[0:1], 0
    s_load_dwordx4 s[24:27], s[0:1], 32
    s_load_dwordx4 s[4:7], s[0:1], 72
    s_load_dwordx2 s[90:91], s[0:1], 48
    s_load_dwordx2 s[92:93], s[0:1], 16
    v_and_b32 v1, 63, v0
    v_lshrrev_b32 v2, 6, v0
    v_lshlrev_b32 v19, 4, v1
    v_readfirstlane_b32 s28, v2
    s_and_b32 s29, s2, 1
    s_lshl_b32 s29, s29, 2
    s_bfe_u32 s30, s2, 0x20003
    s_add_u32 s29, s29, s30
    s_bfe_u32 s30, s2, 0x20001
    s_lshl_b32 s30, s30, 2
    s_lshr_b32 s31, s2, 6
    s_add_u32 s30, s30, s31
    s_and_b32 s32, s28, 3
    s_lshr_b32 s33, s28, 2
    s_mul_i32 s34, s33, 7
    s_xor_b32 s32, s32, s34
    s_lshl_b32 s31, s2, 3
    s_add_u32 s31, s31, s28
    s_lshl_b32 s34, s31, 11
    s_waitcnt lgkmcnt(0)
    s_mov_b32 s8, s20
    s_mov_b32 s9, s21
    s_mov_b32 s10, 0x400000
    s_mov_b32 s11, 0x00020000
    buffer_load_dwordx4 v[160:163], v19, s[8:11], s34 offen
    buffer_load_dwordx4 v[164:167], v19, s[8:11], s34 offen offset:1024
    v_lshrrev_b32 v3, 3, v1
    v_lshlrev_b32 v3, 11, v3
    v_and_b32 v7, 7, v1
    v_lshrrev_b32 v2, 4, v1
    v_xor_b32 v7, v7, v2
    v_lshl_add_u32 v3, v7, 4, v3
    v_xor_b32 v4, 64, v3
    v_add_u32 v4, 15360, v4
    s_lshl_b32 s36, s29, 19
    s_lshl_b32 s34, s28, 16
    s_add_u32 s36, s36, s34
    s_lshl_b32 s46, s28, 12
    s_mov_b32 s37, 0
    s_lshl_b32 s35, s28, 11
    s_add_u32 s35, s35, 98304
    v_lshrrev_b32 v7, 3, v1
    v_and_b32 v7, 2, v7
    v_and_b32 v5, 3, v1
    v_xor_b32 v5, v5, v7
    v_lshlrev_b32 v5, 4, v5
    v_lshrrev_b32 v6, 4, v1
    v_lshlrev_b32 v6, 3, v6
    v_bfe_u32 v7, v1, 2, 2
    v_add_u32 v6, v6, v7
    s_bitcmp1_b32 s2, 5
    s_cbranch_scc1 L_k1_w1
    s_mov_b32 s12, s22
    s_mov_b32 s13, s23
    s_mov_b32 s14, 0x600000
    s_mov_b32 s15, 0x00020000
    s_cmp_ge_u32 s28, 3
    s_cselect_b32 s38, 1, 0
    s_mul_i32 s39, s38, 3
    s_sub_u32 s39, s28, s39
    s_lshl_b32 s39, s39, 11
    s_lshl_b32 s40, s30, 1
    s_add_u32 s40, s40, s38
    s_lshl_b32 s40, s40, 6
    s_add_u32 s39, s39, s40
    s_movk_i32 s40, 6144
    v_mul_lo_u32 v6, v6, s40
    v_add3_u32 v5, v5, v6, s39
    v_add_u32 v6, 23552, v5
    s_movk_i32 s40, 7168
    s_movk_i32 s49, 0x3f80
    s_cmp_ge_u32 s28, 6
    s_cbranch_scc1 L_k1_qkv_role1
    s_add_u32 m0, s35, 0
    s_nop 0
    buffer_load_dwordx4 v5, s[12:15], s37 offen lds
    buffer_load_dwordx4 v6, s[12:15], s37 offen offset:1024 lds
    s_add_u32 s37, s37, 196608
    s_mov_b32 m0, s46
    s_nop 0
    buffer_load_dwordx4 v3, s[8:11], s36 offen lds
    buffer_load_dwordx4 v4, s[8:11], s36 offen offset:1024 lds
    s_add_u32 s34, s36, 32768
    s_add_u32 m0, s46, 2048
    s_add_u32 s36, s36, 128
    buffer_load_dwordx4 v3, s[8:11], s34 offen lds
    buffer_load_dwordx4 v4, s[8:11], s34 offen offset:1024 lds
    s_add_u32 s46, s46, 32768
    s_cmp_ge_u32 s46, 98304
    s_cselect_b32 s38, 98304, 0
    s_sub_u32 s46, s46, s38
    s_add_u32 m0, s35, 14336
    s_nop 0
    buffer_load_dwordx4 v5, s[12:15], s37 offen lds
    buffer_load_dwordx4 v6, s[12:15], s37 offen offset:1024 lds
    s_add_u32 s37, s37, 196608
    s_cmp_lt_u32 s2, 96
    s_cselect_b32 s16, s22, s24
    s_cselect_b32 s17, s23, s25
    s_cselect_b32 s38, 6144, s40
    s_cselect_b32 s39, 0, 96
    s_lshl_b32 s18, s38, 10
    s_cmp_ge_u32 s2, 208
    s_cselect_b32 s18, 0, s18
    s_mov_b32 s19, 0x00020000
    s_sub_u32 s39, s2, s39
    s_and_b32 s41, s39, 1
    s_lshl_b32 s41, s41, 3
    s_add_u32 s41, s41, s28
    s_lshl_b32 s41, s41, 6
    s_mul_i32 s41, s41, s38
    s_lshr_b32 s39, s39, 1
    s_lshl_b32 s39, s39, 7
    s_add_u32 s41, s41, s39
    v_lshrrev_b32 v18, 3, v1
    v_mul_lo_u32 v18, v18, s38
    v_and_b32 v2, 7, v1
    v_lshl_add_u32 v18, v2, 4, v18
    s_lshl_b32 s42, s38, 3
    v_and_b32 v2, 15, v1
    v_and_b32 v7, 1, v1
    v_lshlrev_b32 v7, 4, v7
    v_lshlrev_b32 v7, v7, s49
    v_lshrrev_b32 v2, 1, v2
    v_cmp_eq_u32 vcc, 0, v2
    s_nop 1
    v_cndmask_b32 v12, 0, v7, vcc
    v_cmp_eq_u32 vcc, 1, v2
    s_nop 1
    v_cndmask_b32 v13, 0, v7, vcc
    v_cmp_eq_u32 vcc, 2, v2
    s_nop 1
    v_cndmask_b32 v14, 0, v7, vcc
    v_cmp_eq_u32 vcc, 3, v2
    s_nop 1
    v_cndmask_b32 v15, 0, v7, vcc
    v_and_b32 v2, 15, v1
    v_lshlrev_b32 v8, 7, v2
    v_lshrrev_b32 v2, 1, v2
    v_lshrrev_b32 v7, 4, v1
    v_xor_b32 v2, v2, v7
    v_lshl_add_u32 v2, v2, 4, v8
    s_lshl_b32 s38, s32, 12
    s_sub_u32 s39, 28672, s38
    v_add_u32 v8, s38, v2
    v_add_u32 v10, s39, v2
    v_xor_b32 v9, 64, v8
    v_xor_b32 v11, 64, v10
    v_lshrrev_b32 v0, 2, v1
    v_lshlrev_b32 v0, 6, v0
    v_and_b32 v7, 16, v1
    v_lshl_add_u32 v0, v7, 1, v0
    v_and_b32 v7, 3, v1
    v_lshl_add_u32 v0, v7, 3, v0
    s_mul_i32 s40, s33, 6144
    s_add_u32 s40, s40, 98304
    v_add_u32 v16, s40, v0
    v_xor_b32 v17, 32, v16
    v_mov_b32 v20, 0
    v_mov_b32 v21, 0
    v_mov_b32 v22, 0
    v_mov_b32 v23, 0
    s_mov_b32 s47, 0
    s_mov_b32 s50, 32768
    s_mov_b32 s51, 32768
    s_add_u32 s52, s6, 0x3000000
    s_addc_u32 s53, s7, 0
    s_mov_b32 s54, 0x20000
    s_mov_b32 s55, 0x00020000
    s_mov_b32 s56, s4
    s_mov_b32 s57, s5
    s_mov_b32 s58, 0x100
    s_mov_b32 s59, 0x00020000
    s_waitcnt vmcnt(8)
    v_lshlrev_b32 v168, 16, v160
    v_and_b32 v169, 0xffff0000, v160
    v_lshlrev_b32 v170, 16, v161
    v_and_b32 v171, 0xffff0000, v161
    v_lshlrev_b32 v172, 16, v162
    v_and_b32 v173, 0xffff0000, v162
    v_lshlrev_b32 v174, 16, v163
    v_and_b32 v175, 0xffff0000, v163
    v_lshlrev_b32 v176, 16, v164
    v_and_b32 v177, 0xffff0000, v164
    v_lshlrev_b32 v178, 16, v165
    v_and_b32 v179, 0xffff0000, v165
    v_lshlrev_b32 v180, 16, v166
    v_and_b32 v181, 0xffff0000, v166
    v_lshlrev_b32 v182, 16, v167
    v_and_b32 v183, 0xffff0000, v167
    v_add_f32 v184, v168, v169
    v_add_f32 v185, v170, v171
    v_add_f32 v184, v184, v172
    v_add_f32 v185, v185, v173
    v_add_f32 v184, v184, v174
    v_add_f32 v185, v185, v175
    v_add_f32 v184, v184, v176
    v_add_f32 v185, v185, v177
    v_add_f32 v184, v184, v178
    v_add_f32 v185, v185, v179
    v_add_f32 v184, v184, v180
    v_add_f32 v185, v185, v181
    v_add_f32 v184, v184, v182
    v_add_f32 v185, v185, v183
    v_add_f32 v184, v184, v185
    s_nop 1
    v_add_f32_dpp v184, v184, v184 row_ror:8 row_mask:0xf bank_mask:0xf
    s_nop 1
    v_add_f32_dpp v184, v184, v184 row_ror:4 row_mask:0xf bank_mask:0xf
    s_nop 1
    v_add_f32_dpp v184, v184, v184 row_ror:2 row_mask:0xf bank_mask:0xf
    s_nop 1
    v_add_f32_dpp v184, v184, v184 row_ror:1 row_mask:0xf bank_mask:0xf
    v_mov_b32 v185, v184
    s_nop 1
    v_permlane16_swap_b32 v184, v185
    v_add_f32 v184, v184, v185
    v_mov_b32 v185, v184
    s_nop 1
    v_permlane32_swap_b32 v184, v185
    v_add_f32 v184, v184, v185
    v_mul_f32 v186, 0x3a800000, v184
    v_sub_f32 v168, v168, v186
    v_sub_f32 v169, v169, v186
    v_sub_f32 v170, v170, v186
    v_sub_f32 v171, v171, v186
    v_sub_f32 v172, v172, v186
    v_sub_f32 v173, v173, v186
    v_sub_f32 v174, v174, v186
    v_sub_f32 v175, v175, v186
    v_sub_f32 v176, v176, v186
    v_sub_f32 v177, v177, v186
    v_sub_f32 v178, v178, v186
    v_sub_f32 v179, v179, v186
    v_sub_f32 v180, v180, v186
    v_sub_f32 v181, v181, v186
    v_sub_f32 v182, v182, v186
    v_sub_f32 v183, v183, v186
    v_mul_f32 v184, v168, v168
    v_mul_f32 v185, v169, v169
    v_fmac_f32 v184, v170, v170
    v_fmac_f32 v185, v171, v171
    v_fmac_f32 v184, v172, v172
    v_fmac_f32 v185, v173, v173
    v_fmac_f32 v184, v174, v174
    v_fmac_f32 v185, v175, v175
    v_fmac_f32 v184, v176, v176
    v_fmac_f32 v185, v177, v177
    v_fmac_f32 v184, v178, v178
    v_fmac_f32 v185, v179, v179
    v_fmac_f32 v184, v180, v180
    v_fmac_f32 v185, v181, v181
    v_fmac_f32 v184, v182, v182
    v_fmac_f32 v185, v183, v183
    v_add_f32 v184, v184, v185
    s_nop 1
    v_add_f32_dpp v184, v184, v184 row_ror:8 row_mask:0xf bank_mask:0xf
    s_nop 1
    v_add_f32_dpp v184, v184, v184 row_ror:4 row_mask:0xf bank_mask:0xf
    s_nop 1
    v_add_f32_dpp v184, v184, v184 row_ror:2 row_mask:0xf bank_mask:0xf
    s_nop 1
    v_add_f32_dpp v184, v184, v184 row_ror:1 row_mask:0xf bank_mask:0xf
    v_mov_b32 v185, v184
    s_nop 1
    v_permlane16_swap_b32 v184, v185
    v_add_f32 v184, v184, v185
    v_mov_b32 v185, v184
    s_nop 1
    v_permlane32_swap_b32 v184, v185
    v_add_f32 v184, v184, v185
    v_mul_f32 v187, 0x3a800000, v184
    v_mov_b32 v168, v187
    v_cvt_pk_bf16_f32 v168, v168, v168
    v_lshlrev_b32 v168, 16, v168
    v_add_f32 v168, 0x3727c5ac, v168
    v_cvt_pk_bf16_f32 v168, v168, v168
    v_lshlrev_b32 v168, 16, v168
    v_sqrt_f32 v168, v168
    s_nop 0
    v_cvt_pk_bf16_f32 v168, v168, v168
    v_lshlrev_b32 v168, 16, v168
    v_rcp_f32 v160, v168
    v_mov_b32 v169, v186
    v_cvt_pk_bf16_f32 v169, v169, v169
    v_lshlrev_b32 v169, 16, v169
    v_mul_f32 v161, -v160, v169
    v_sub_f32 v171, v186, v169
    v_mul_f32 v171, v171, v160
    v_cvt_pk_bf16_f32 v171, v171, v171
    v_lshlrev_b32 v171, 16, v171
    v_mul_f32 v187, v187, v160
    v_mul_f32 v187, v187, v160
    v_mov_b32 v170, v187
    v_cvt_pk_bf16_f32 v170, v170, v170
    v_lshlrev_b32 v170, 16, v170
    v_add_f32 v170, 0x3727c5ac, v170
    v_cvt_pk_bf16_f32 v170, v170, v170
    v_lshlrev_b32 v170, 16, v170
    v_sqrt_f32 v170, v170
    s_nop 0
    v_cvt_pk_bf16_f32 v170, v170, v170
    v_lshlrev_b32 v170, 16, v170
    v_rcp_f32 v170, v170
    v_fma_f32 v171, v171, v168, v169
    v_mul_f32 v162, v160, v170
    v_mul_f32 v163, -v162, v171
    v_cmp_eq_u32 vcc, 1, v1
    s_nop 1
    v_cndmask_b32 v160, v160, v161, vcc
    v_cmp_eq_u32 vcc, 2, v1
    s_nop 1
    v_cndmask_b32 v160, v160, v162, vcc
    v_cmp_eq_u32 vcc, 3, v1
    s_nop 1
    v_cndmask_b32 v160, v160, v163, vcc
    v_lshlrev_b32 v2, 13, v1
    s_lshl_b32 s38, s31, 2
    s_add_u32 s39, s38, 32768
    s_lshl_b32 s38, s31, 4
    s_mov_b64 exec, 15
    buffer_store_dword v160, v2, s[52:55], s39 offen sc1
    s_mov_b64 exec, 1
    buffer_store_dwordx4 v[20:23], v20, s[52:55], s38 offen sc1
    s_mov_b64 exec, -1
    s_mov_b32 m0, s46
    s_nop 0
    buffer_load_dwordx4 v3, s[8:11], s36 offen lds
    buffer_load_dwordx4 v4, s[8:11], s36 offen offset:1024 lds
    s_add_u32 s34, s36, 32768
    s_add_u32 m0, s46, 2048
    s_add_u32 s36, s36, 128
    buffer_load_dwordx4 v3, s[8:11], s34 offen lds
    buffer_load_dwordx4 v4, s[8:11], s34 offen offset:1024 lds
    s_add_u32 s46, s46, 32768
    s_cmp_ge_u32 s46, 98304
    s_cselect_b32 s38, 98304, 0
    s_sub_u32 s46, s46, s38
    s_add_u32 m0, s35, 28672
    s_nop 0
    buffer_load_dwordx4 v5, s[12:15], s37 offen lds
    buffer_load_dwordx4 v6, s[12:15], s37 offen offset:1024 lds
    s_add_u32 s37, s37, 196608
    s_waitcnt vmcnt(10) lgkmcnt(0)
    s_barrier
    ds_read_b128 v[116:119], v8 offset:0
    ds_read_b64_tr_b16 v[132:133], v16 offset:0
    ds_read_b64_tr_b16 v[134:135], v16 offset:1024
    ds_read_b64_tr_b16 v[136:137], v17 offset:0
    ds_read_b64_tr_b16 v[138:139], v17 offset:1024
    ds_read_b64_tr_b16 v[140:141], v16 offset:2048
    ds_read_b64_tr_b16 v[142:143], v16 offset:3072
    ds_read_b64_tr_b16 v[144:145], v17 offset:2048
    ds_read_b64_tr_b16 v[146:147], v17 offset:3072
    ds_read_b64_tr_b16 v[148:149], v16 offset:4096
    ds_read_b64_tr_b16 v[150:151], v16 offset:5120
    ds_read_b64_tr_b16 v[152:153], v17 offset:4096
    ds_read_b64_tr_b16 v[154:155], v17 offset:5120
    ds_read_b128 v[120:123], v8 offset:2048
    ds_read_b128 v[124:127], v10 offset:0
    ds_read_b128 v[128:131], v10 offset:2048
    s_add_u32 m0, s35, 43008
    s_nop 0
    buffer_load_dwordx4 v5, s[12:15], s37 offen lds
    buffer_load_dwordx4 v6, s[12:15], s37 offen offset:1024 lds
    s_add_u32 s37, s37, 196608
    s_waitcnt vmcnt(10) lgkmcnt(0)
    s_barrier
    v_mfma_f32_16x16x32_bf16 v[20:23], v[132:135], v[116:119], 0
    ds_read_b128 v[156:159], v9 offset:0
    v_mfma_f32_16x16x32_bf16 v[24:27], v[136:139], v[116:119], 0
    ds_read_b64_tr_b16 v[172:173], v16 offset:14336
    v_mfma_f32_16x16x32_bf16 v[28:31], v[140:143], v[116:119], 0
    ds_read_b64_tr_b16 v[174:175], v16 offset:15360
    s_mov_b32 m0, s46
    s_nop 0
    buffer_load_dwordx4 v3, s[8:11], s36 offen lds
    v_mfma_f32_16x16x32_bf16 v[32:35], v[144:147], v[116:119], 0
    ds_read_b64_tr_b16 v[176:177], v17 offset:14336
    v_mfma_f32_16x16x32_bf16 v[36:39], v[116:119], v[148:151], 0
    v_mfma_f32_16x16x32_bf16 v[40:43], v[116:119], v[152:155], 0
    ds_read_b64_tr_b16 v[178:179], v17 offset:15360
    v_mfma_f32_16x16x32_bf16 v[44:47], v[132:135], v[120:123], 0
    ds_read_b64_tr_b16 v[180:181], v16 offset:16384
    buffer_load_dwordx4 v4, s[8:11], s36 offen offset:1024 lds
    s_add_u32 s34, s36, 32768
    v_mfma_f32_16x16x32_bf16 v[48:51], v[136:139], v[120:123], 0
    ds_read_b64_tr_b16 v[182:183], v16 offset:17408
    v_mfma_f32_16x16x32_bf16 v[52:55], v[140:143], v[120:123], 0
    ds_read_b64_tr_b16 v[184:185], v17 offset:16384
    v_mfma_f32_16x16x32_bf16 v[56:59], v[144:147], v[120:123], 0
    v_mfma_f32_16x16x32_bf16 v[60:63], v[120:123], v[148:151], 0
    ds_read_b64_tr_b16 v[186:187], v17 offset:17408
    s_add_u32 m0, s46, 2048
    s_add_u32 s36, s36, 128
    buffer_load_dwordx4 v3, s[8:11], s34 offen lds
    v_mfma_f32_16x16x32_bf16 v[64:67], v[120:123], v[152:155], 0
    ds_read_b64_tr_b16 v[188:189], v16 offset:18432
    v_mfma_f32_16x16x32_bf16 v[68:71], v[132:135], v[124:127], 0
    ds_read_b64_tr_b16 v[190:191], v16 offset:19456
    v_mfma_f32_16x16x32_bf16 v[72:75], v[136:139], v[124:127], 0
    ds_read_b64_tr_b16 v[192:193], v17 offset:18432
    v_mfma_f32_16x16x32_bf16 v[76:79], v[140:143], v[124:127], 0
    buffer_load_dwordx4 v4, s[8:11], s34 offen offset:1024 lds
    s_add_u32 s46, s46, 32768
    s_cmp_ge_u32 s46, 98304
    s_cselect_b32 s38, 98304, 0
    s_sub_u32 s46, s46, s38
    v_mfma_f32_16x16x32_bf16 v[80:83], v[144:147], v[124:127], 0
    ds_read_b64_tr_b16 v[194:195], v17 offset:19456
    v_mfma_f32_16x16x32_bf16 v[84:87], v[124:127], v[148:151], 0
    ds_read_b128 v[160:163], v9 offset:2048
    v_mfma_f32_16x16x32_bf16 v[88:91], v[124:127], v[152:155], 0
    ds_read_b128 v[164:167], v11 offset:0
    v_mfma_f32_16x16x32_bf16 v[92:95], v[132:135], v[128:131], 0
    ds_read_b128 v[168:171], v11 offset:2048
    s_add_u32 m0, s35, 0
    s_nop 0
    buffer_load_dwordx4 v5, s[12:15], s37 offen lds
    v_mfma_f32_16x16x32_bf16 v[96:99], v[136:139], v[128:131], 0
    v_mfma_f32_16x16x32_bf16 v[100:103], v[140:143], v[128:131], 0
    v_mfma_f32_16x16x32_bf16 v[104:107], v[144:147], v[128:131], 0
    v_mfma_f32_16x16x32_bf16 v[108:111], v[128:131], v[148:151], 0
    buffer_load_dwordx4 v6, s[12:15], s37 offen offset:1024 lds
    s_add_u32 s37, s37, 196608
    v_add_u32 v8, s50, v8
    v_add_u32 v10, s50, v10
    v_mfma_f32_16x16x32_bf16 v[112:115], v[128:131], v[152:155], 0
    s_waitcnt vmcnt(8) lgkmcnt(0)
    s_barrier
    v_mfma_f32_16x16x32_bf16 v[20:23], v[172:175], v[156:159], v[20:23]
    ds_read_b128 v[116:119], v8 offset:0
    v_mfma_f32_16x16x32_bf16 v[24:27], v[176:179], v[156:159], v[24:27]
    ds_read_b64_tr_b16 v[132:133], v16 offset:28672
    s_add_u32 m0, s35, 14336
    s_nop 0
    buffer_load_dwordx4 v5, s[12:15], s37 offen lds
    v_mfma_f32_16x16x32_bf16 v[28:31], v[180:183], v[156:159], v[28:31]
    ds_read_b64_tr_b16 v[134:135], v16 offset:29696
    v_mfma_f32_16x16x32_bf16 v[32:35], v[184:187], v[156:159], v[32:35]
    ds_read_b64_tr_b16 v[136:137], v17 offset:28672
    v_mfma_f32_16x16x32_bf16 v[36:39], v[156:159], v[188:191], v[36:39]
    buffer_load_dwordx4 v6, s[12:15], s37 offen offset:1024 lds
    s_add_u32 s37, s37, 196608
    v_mfma_f32_16x16x32_bf16 v[40:43], v[156:159], v[192:195], v[40:43]
    ds_read_b64_tr_b16 v[138:139], v17 offset:29696
    v_mfma_f32_16x16x32_bf16 v[44:47], v[172:175], v[160:163], v[44:47]
    ds_read_b64_tr_b16 v[140:141], v16 offset:30720
    v_mfma_f32_16x16x32_bf16 v[48:51], v[176:179], v[160:163], v[48:51]
    ds_read_b64_tr_b16 v[142:143], v16 offset:31744
    s_mov_b32 m0, s46
    s_nop 0
    buffer_load_dwordx4 v3, s[8:11], s36 offen lds
    v_mfma_f32_16x16x32_bf16 v[52:55], v[180:183], v[160:163], v[52:55]
    ds_read_b64_tr_b16 v[144:145], v17 offset:30720
    v_mfma_f32_16x16x32_bf16 v[56:59], v[184:187], v[160:163], v[56:59]
    v_mfma_f32_16x16x32_bf16 v[60:63], v[160:163], v[188:191], v[60:63]
    ds_read_b64_tr_b16 v[146:147], v17 offset:31744
    buffer_load_dwordx4 v4, s[8:11], s36 offen offset:1024 lds
    s_add_u32 s34, s36, 32768
    v_mfma_f32_16x16x32_bf16 v[64:67], v[160:163], v[192:195], v[64:67]
    ds_read_b64_tr_b16 v[148:149], v16 offset:32768
    v_mfma_f32_16x16x32_bf16 v[68:71], v[172:175], v[164:167], v[68:71]
    ds_read_b64_tr_b16 v[150:151], v16 offset:33792
    v_mfma_f32_16x16x32_bf16 v[72:75], v[176:179], v[164:167], v[72:75]
    ds_read_b64_tr_b16 v[152:153], v17 offset:32768
    buffer_load_dwordx4 v[224:227], v18, s[16:19], s41 offen
    s_add_u32 s41, s41, s42
    v_mfma_f32_16x16x32_bf16 v[76:79], v[180:183], v[164:167], v[76:79]
    v_mfma_f32_16x16x32_bf16 v[80:83], v[184:187], v[164:167], v[80:83]
    ds_read_b64_tr_b16 v[154:155], v17 offset:33792
    v_mfma_f32_16x16x32_bf16 v[84:87], v[164:167], v[188:191], v[84:87]
    ds_read_b128 v[120:123], v8 offset:2048
    buffer_load_dwordx4 v[228:231], v18, s[16:19], s41 offen
    s_add_u32 s41, s41, s42
    v_mfma_f32_16x16x32_bf16 v[88:91], v[164:167], v[192:195], v[88:91]
    ds_read_b128 v[124:127], v10 offset:0
    v_mfma_f32_16x16x32_bf16 v[92:95], v[172:175], v[168:171], v[92:95]
    ds_read_b128 v[128:131], v10 offset:2048
    v_mfma_f32_16x16x32_bf16 v[96:99], v[176:179], v[168:171], v[96:99]
    buffer_load_dwordx4 v[232:235], v18, s[16:19], s41 offen
    s_add_u32 s41, s41, s42
    v_mfma_f32_16x16x32_bf16 v[100:103], v[180:183], v[168:171], v[100:103]
    v_mfma_f32_16x16x32_bf16 v[104:107], v[184:187], v[168:171], v[104:107]
    v_mfma_f32_16x16x32_bf16 v[108:111], v[168:171], v[188:191], v[108:111]
    buffer_load_dwordx4 v[236:239], v18, s[16:19], s41 offen
    s_add_u32 s41, s41, s42
    v_add_u32 v9, s50, v9
    v_add_u32 v11, s50, v11
    s_add_u32 s47, s47, s50
    s_cmp_eq_u32 s47, 65536
    s_cselect_b32 s50, 0xffff0000, s51
    v_mfma_f32_16x16x32_bf16 v[112:115], v[168:171], v[192:195], v[112:115]
    s_waitcnt vmcnt(14) lgkmcnt(0)
    s_barrier
    v_mfma_f32_16x16x32_bf16 v[20:23], v[132:135], v[116:119], v[20:23]
    ds_read_b128 v[156:159], v9 offset:0
    v_mfma_f32_16x16x32_bf16 v[24:27], v[136:139], v[116:119], v[24:27]
    ds_read_b64_tr_b16 v[172:173], v16 offset:43008
    s_add_u32 m0, s35, 28672
    s_nop 0
    buffer_load_dwordx4 v5, s[12:15], s37 offen lds
    v_mfma_f32_16x16x32_bf16 v[28:31], v[140:143], v[116:119], v[28:31]
    ds_read_b64_tr_b16 v[174:175], v16 offset:44032
    v_mfma_f32_16x16x32_bf16 v[32:35], v[144:147], v[116:119], v[32:35]
    ds_read_b64_tr_b16 v[176:177], v17 offset:43008
    v_mfma_f32_16x16x32_bf16 v[36:39], v[116:119], v[148:151], v[36:39]
    buffer_load_dwordx4 v6, s[12:15], s37 offen offset:1024 lds
    s_add_u32 s37, s37, 196608
    v_mfma_f32_16x16x32_bf16 v[40:43], v[116:119], v[152:155], v[40:43]
    ds_read_b64_tr_b16 v[178:179], v17 offset:44032
    v_mfma_f32_16x16x32_bf16 v[44:47], v[132:135], v[120:123], v[44:47]
    ds_read_b64_tr_b16 v[180:181], v16 offset:45056
    v_mfma_f32_16x16x32_bf16 v[48:51], v[136:139], v[120:123], v[48:51]
    ds_read_b64_tr_b16 v[182:183], v16 offset:46080
    s_add_u32 m0, s46, 2048
    s_add_u32 s36, s36, 128
    buffer_load_dwordx4 v3, s[8:11], s34 offen lds
    v_mfma_f32_16x16x32_bf16 v[52:55], v[140:143], v[120:123], v[52:55]
    ds_read_b64_tr_b16 v[184:185], v17 offset:45056
    v_mfma_f32_16x16x32_bf16 v[56:59], v[144:147], v[120:123], v[56:59]
    v_mfma_f32_16x16x32_bf16 v[60:63], v[120:123], v[148:151], v[60:63]
    ds_read_b64_tr_b16 v[186:187], v17 offset:46080
    buffer_load_dwordx4 v4, s[8:11], s34 offen offset:1024 lds
    s_add_u32 s46, s46, 32768
    s_cmp_ge_u32 s46, 98304
    s_cselect_b32 s38, 98304, 0
    s_sub_u32 s46, s46, s38
    v_mfma_f32_16x16x32_bf16 v[64:67], v[120:123], v[152:155], v[64:67]
    ds_read_b64_tr_b16 v[188:189], v16 offset:47104
    v_mfma_f32_16x16x32_bf16 v[68:71], v[132:135], v[124:127], v[68:71]
    ds_read_b64_tr_b16 v[190:191], v16 offset:48128
    v_mfma_f32_16x16x32_bf16 v[72:75], v[136:139], v[124:127], v[72:75]
    ds_read_b64_tr_b16 v[192:193], v17 offset:47104
    buffer_load_dwordx4 v[240:243], v18, s[16:19], s41 offen
    s_add_u32 s41, s41, s42
    v_mfma_f32_16x16x32_bf16 v[76:79], v[140:143], v[124:127], v[76:79]
    v_mfma_f32_16x16x32_bf16 v[80:83], v[144:147], v[124:127], v[80:83]
    ds_read_b64_tr_b16 v[194:195], v17 offset:48128
    v_mfma_f32_16x16x32_bf16 v[84:87], v[124:127], v[148:151], v[84:87]
    ds_read_b128 v[160:163], v9 offset:2048
    buffer_load_dwordx4 v[244:247], v18, s[16:19], s41 offen
    s_add_u32 s41, s41, s42
    v_mfma_f32_16x16x32_bf16 v[88:91], v[124:127], v[152:155], v[88:91]
    ds_read_b128 v[164:167], v11 offset:0
    v_mfma_f32_16x16x32_bf16 v[92:95], v[132:135], v[128:131], v[92:95]
    ds_read_b128 v[168:171], v11 offset:2048
    v_mfma_f32_16x16x32_bf16 v[96:99], v[136:139], v[128:131], v[96:99]
    buffer_load_dwordx4 v[248:251], v18, s[16:19], s41 offen
    s_add_u32 s41, s41, s42
    v_mfma_f32_16x16x32_bf16 v[100:103], v[140:143], v[128:131], v[100:103]
    v_mfma_f32_16x16x32_bf16 v[104:107], v[144:147], v[128:131], v[104:107]
    v_mfma_f32_16x16x32_bf16 v[108:111], v[128:131], v[148:151], v[108:111]
    buffer_load_dwordx4 v[252:255], v18, s[16:19], s41 offen
    s_add_u32 s41, s41, s42
    v_add_u32 v8, s50, v8
    v_add_u32 v10, s50, v10
    v_mfma_f32_16x16x32_bf16 v[112:115], v[128:131], v[152:155], v[112:115]
    s_waitcnt vmcnt(16) lgkmcnt(0)
    s_barrier
    v_mfma_f32_16x16x32_bf16 v[20:23], v[172:175], v[156:159], v[20:23]
    ds_read_b128 v[116:119], v8 offset:0
    v_mfma_f32_16x16x32_bf16 v[24:27], v[176:179], v[156:159], v[24:27]
    ds_read_b64_tr_b16 v[132:133], v16 offset:0
    v_mfma_f32_16x16x32_bf16 v[28:31], v[180:183], v[156:159], v[28:31]
    ds_read_b64_tr_b16 v[134:135], v16 offset:1024
    v_mfma_f32_16x16x32_bf16 v[32:35], v[184:187], v[156:159], v[32:35]
    ds_read_b64_tr_b16 v[136:137], v17 offset:0
    s_add_u32 m0, s35, 43008
    s_nop 0
    buffer_load_dwordx4 v5, s[12:15], s37 offen lds
    v_mfma_f32_16x16x32_bf16 v[36:39], v[156:159], v[188:191], v[36:39]
    v_mfma_f32_16x16x32_bf16 v[40:43], v[156:159], v[192:195], v[40:43]
    ds_read_b64_tr_b16 v[138:139], v17 offset:1024
    v_mfma_f32_16x16x32_bf16 v[44:47], v[172:175], v[160:163], v[44:47]
    ds_read_b64_tr_b16 v[140:141], v16 offset:2048
    v_mfma_f32_16x16x32_bf16 v[48:51], v[176:179], v[160:163], v[48:51]
    ds_read_b64_tr_b16 v[142:143], v16 offset:3072
    v_mfma_f32_16x16x32_bf16 v[52:55], v[180:183], v[160:163], v[52:55]
    ds_read_b64_tr_b16 v[144:145], v17 offset:2048
    v_mfma_f32_16x16x32_bf16 v[56:59], v[184:187], v[160:163], v[56:59]
    buffer_load_dwordx4 v6, s[12:15], s37 offen offset:1024 lds
    s_add_u32 s37, s37, 196608
    v_mfma_f32_16x16x32_bf16 v[60:63], v[160:163], v[188:191], v[60:63]
    ds_read_b64_tr_b16 v[146:147], v17 offset:3072
    v_mfma_f32_16x16x32_bf16 v[64:67], v[160:163], v[192:195], v[64:67]
    ds_read_b64_tr_b16 v[148:149], v16 offset:4096
    v_mfma_f32_16x16x32_bf16 v[68:71], v[172:175], v[164:167], v[68:71]
    ds_read_b64_tr_b16 v[150:151], v16 offset:5120
    v_mfma_f32_16x16x32_bf16 v[72:75], v[176:179], v[164:167], v[72:75]
    ds_read_b64_tr_b16 v[152:153], v17 offset:4096
    v_mfma_f32_16x16x32_bf16 v[76:79], v[180:183], v[164:167], v[76:79]
    v_mfma_f32_16x16x32_bf16 v[80:83], v[184:187], v[164:167], v[80:83]
    ds_read_b64_tr_b16 v[154:155], v17 offset:5120
    s_mov_b32 m0, s46
    s_nop 0
    buffer_load_dwordx4 v3, s[8:11], s36 offen lds
    v_mfma_f32_16x16x32_bf16 v[84:87], v[164:167], v[188:191], v[84:87]
    ds_read_b128 v[120:123], v8 offset:2048
    v_mfma_f32_16x16x32_bf16 v[88:91], v[164:167], v[192:195], v[88:91]
    ds_read_b128 v[124:127], v10 offset:0
    v_mfma_f32_16x16x32_bf16 v[92:95], v[172:175], v[168:171], v[92:95]
    ds_read_b128 v[128:131], v10 offset:2048
    v_mfma_f32_16x16x32_bf16 v[96:99], v[176:179], v[168:171], v[96:99]
    v_mfma_f32_16x16x32_bf16 v[100:103], v[180:183], v[168:171], v[100:103]
    v_mfma_f32_16x16x32_bf16 v[104:107], v[184:187], v[168:171], v[104:107]
    buffer_load_dwordx4 v4, s[8:11], s36 offen offset:1024 lds
    s_add_u32 s34, s36, 32768
    v_mfma_f32_16x16x32_bf16 v[108:111], v[168:171], v[188:191], v[108:111]
    v_add_u32 v9, s50, v9
    v_add_u32 v11, s50, v11
    s_add_u32 s47, s47, s50
    s_cmp_eq_u32 s47, 65536
    s_cselect_b32 s50, 0xffff0000, s51
    v_mfma_f32_16x16x32_bf16 v[112:115], v[168:171], v[192:195], v[112:115]
    s_waitcnt vmcnt(18) lgkmcnt(0)
    s_barrier
    v_mfma_f32_16x16x32_bf16 v[20:23], v[132:135], v[116:119], v[20:23]
    ds_read_b128 v[156:159], v9 offset:0
    v_mfma_f32_16x16x32_bf16 v[24:27], v[136:139], v[116:119], v[24:27]
    ds_read_b64_tr_b16 v[172:173], v16 offset:14336
    v_mfma_f32_16x16x32_bf16 v[28:31], v[140:143], v[116:119], v[28:31]
    ds_read_b64_tr_b16 v[174:175], v16 offset:15360
    v_mfma_f32_16x16x32_bf16 v[32:35], v[144:147], v[116:119], v[32:35]
    ds_read_b64_tr_b16 v[176:177], v17 offset:14336
    s_add_u32 m0, s35, 0
    s_nop 0
    buffer_load_dwordx4 v5, s[12:15], s37 offen lds
    v_mfma_f32_16x16x32_bf16 v[36:39], v[116:119], v[148:151], v[36:39]
    v_mfma_f32_16x16x32_bf16 v[40:43], v[116:119], v[152:155], v[40:43]
    ds_read_b64_tr_b16 v[178:179], v17 offset:15360
    v_mfma_f32_16x16x32_bf16 v[44:47], v[132:135], v[120:123], v[44:47]
    ds_read_b64_tr_b16 v[180:181], v16 offset:16384
    v_mfma_f32_16x16x32_bf16 v[48:51], v[136:139], v[120:123], v[48:51]
    ds_read_b64_tr_b16 v[182:183], v16 offset:17408
    v_mfma_f32_16x16x32_bf16 v[52:55], v[140:143], v[120:123], v[52:55]
    ds_read_b64_tr_b16 v[184:185], v17 offset:16384
    v_mfma_f32_16x16x32_bf16 v[56:59], v[144:147], v[120:123], v[56:59]
    buffer_load_dwordx4 v6, s[12:15], s37 offen offset:1024 lds
    s_add_u32 s37, s37, 196608
    v_mfma_f32_16x16x32_bf16 v[60:63], v[120:123], v[148:151], v[60:63]
    ds_read_b64_tr_b16 v[186:187], v17 offset:17408
    v_mfma_f32_16x16x32_bf16 v[64:67], v[120:123], v[152:155], v[64:67]
    ds_read_b64_tr_b16 v[188:189], v16 offset:18432
    v_mfma_f32_16x16x32_bf16 v[68:71], v[132:135], v[124:127], v[68:71]
    ds_read_b64_tr_b16 v[190:191], v16 offset:19456
    v_mfma_f32_16x16x32_bf16 v[72:75], v[136:139], v[124:127], v[72:75]
    ds_read_b64_tr_b16 v[192:193], v17 offset:18432
    v_mfma_f32_16x16x32_bf16 v[76:79], v[140:143], v[124:127], v[76:79]
    v_mfma_f32_16x16x32_bf16 v[80:83], v[144:147], v[124:127], v[80:83]
    ds_read_b64_tr_b16 v[194:195], v17 offset:19456
    s_add_u32 m0, s46, 2048
    s_add_u32 s36, s36, 128
    buffer_load_dwordx4 v3, s[8:11], s34 offen lds
    v_mfma_f32_16x16x32_bf16 v[84:87], v[124:127], v[148:151], v[84:87]
    ds_read_b128 v[160:163], v9 offset:2048
    v_mfma_f32_16x16x32_bf16 v[88:91], v[124:127], v[152:155], v[88:91]
    ds_read_b128 v[164:167], v11 offset:0
    v_mfma_f32_16x16x32_bf16 v[92:95], v[132:135], v[128:131], v[92:95]
    ds_read_b128 v[168:171], v11 offset:2048
    v_mfma_f32_16x16x32_bf16 v[96:99], v[136:139], v[128:131], v[96:99]
    v_mfma_f32_16x16x32_bf16 v[100:103], v[140:143], v[128:131], v[100:103]
    v_mfma_f32_16x16x32_bf16 v[104:107], v[144:147], v[128:131], v[104:107]
    buffer_load_dwordx4 v4, s[8:11], s34 offen offset:1024 lds
    s_add_u32 s46, s46, 32768
    s_cmp_ge_u32 s46, 98304
    s_cselect_b32 s38, 98304, 0
    s_sub_u32 s46, s46, s38
    v_mfma_f32_16x16x32_bf16 v[108:111], v[128:131], v[148:151], v[108:111]
    v_add_u32 v8, s50, v8
    v_add_u32 v10, s50, v10
    v_mfma_f32_16x16x32_bf16 v[112:115], v[128:131], v[152:155], v[112:115]
    s_waitcnt vmcnt(12) lgkmcnt(0)
    s_barrier
    v_mfma_f32_16x16x32_bf16 v[20:23], v[172:175], v[156:159], v[20:23]
    ds_read_b128 v[116:119], v8 offset:0
    v_mfma_f32_16x16x32_bf16 v[24:27], v[176:179], v[156:159], v[24:27]
    ds_read_b64_tr_b16 v[132:133], v16 offset:28672
    v_mfma_f32_16x16x32_bf16 v[28:31], v[180:183], v[156:159], v[28:31]
    ds_read_b64_tr_b16 v[134:135], v16 offset:29696
    v_mfma_f32_16x16x32_bf16 v[32:35], v[184:187], v[156:159], v[32:35]
    ds_read_b64_tr_b16 v[136:137], v17 offset:28672
    s_add_u32 m0, s35, 14336
    s_nop 0
    buffer_load_dwordx4 v5, s[12:15], s37 offen lds
    v_mfma_f32_16x16x32_bf16 v[36:39], v[156:159], v[188:191], v[36:39]
    v_mfma_f32_16x16x32_bf16 v[40:43], v[156:159], v[192:195], v[40:43]
    ds_read_b64_tr_b16 v[138:139], v17 offset:29696
    v_mfma_f32_16x16x32_bf16 v[44:47], v[172:175], v[160:163], v[44:47]
    ds_read_b64_tr_b16 v[140:141], v16 offset:30720
    v_mfma_f32_16x16x32_bf16 v[48:51], v[176:179], v[160:163], v[48:51]
    ds_read_b64_tr_b16 v[142:143], v16 offset:31744
    v_mfma_f32_16x16x32_bf16 v[52:55], v[180:183], v[160:163], v[52:55]
    ds_read_b64_tr_b16 v[144:145], v17 offset:30720
    v_mfma_f32_16x16x32_bf16 v[56:59], v[184:187], v[160:163], v[56:59]
    buffer_load_dwordx4 v6, s[12:15], s37 offen offset:1024 lds
    s_add_u32 s37, s37, 196608
    v_mfma_f32_16x16x32_bf16 v[60:63], v[160:163], v[188:191], v[60:63]
    ds_read_b64_tr_b16 v[146:147], v17 offset:31744
    v_mfma_f32_16x16x32_bf16 v[64:67], v[160:163], v[192:195], v[64:67]
    ds_read_b64_tr_b16 v[148:149], v16 offset:32768
    v_mfma_f32_16x16x32_bf16 v[68:71], v[172:175], v[164:167], v[68:71]
    ds_read_b64_tr_b16 v[150:151], v16 offset:33792
    v_mfma_f32_16x16x32_bf16 v[72:75], v[176:179], v[164:167], v[72:75]
    ds_read_b64_tr_b16 v[152:153], v17 offset:32768
    v_mfma_f32_16x16x32_bf16 v[76:79], v[180:183], v[164:167], v[76:79]
    v_mfma_f32_16x16x32_bf16 v[80:83], v[184:187], v[164:167], v[80:83]
    ds_read_b64_tr_b16 v[154:155], v17 offset:33792
    s_mov_b32 m0, s46
    s_nop 0
    buffer_load_dwordx4 v3, s[8:11], s36 offen lds
    v_mfma_f32_16x16x32_bf16 v[84:87], v[164:167], v[188:191], v[84:87]
    ds_read_b128 v[120:123], v8 offset:2048
    v_mfma_f32_16x16x32_bf16 v[88:91], v[164:167], v[192:195], v[88:91]
    ds_read_b128 v[124:127], v10 offset:0
    v_mfma_f32_16x16x32_bf16 v[92:95], v[172:175], v[168:171], v[92:95]
    ds_read_b128 v[128:131], v10 offset:2048
    v_mfma_f32_16x16x32_bf16 v[96:99], v[176:179], v[168:171], v[96:99]
    v_mfma_f32_16x16x32_bf16 v[100:103], v[180:183], v[168:171], v[100:103]
    v_mfma_f32_16x16x32_bf16 v[104:107], v[184:187], v[168:171], v[104:107]
    buffer_load_dwordx4 v4, s[8:11], s36 offen offset:1024 lds
    s_add_u32 s34, s36, 32768
    v_mfma_f32_16x16x32_bf16 v[108:111], v[168:171], v[188:191], v[108:111]
    v_add_u32 v9, s50, v9
    v_add_u32 v11, s50, v11
    s_add_u32 s47, s47, s50
    s_cmp_eq_u32 s47, 65536
    s_cselect_b32 s50, 0xffff0000, s51
    v_mfma_f32_16x16x32_bf16 v[112:115], v[168:171], v[192:195], v[112:115]
    s_waitcnt vmcnt(10) lgkmcnt(0)
    s_barrier
    v_mfma_f32_16x16x32_bf16 v[220:223], v[12:15], v[224:227], 0
    v_mfma_f32_16x16x32_bf16 v[220:223], v[12:15], v[228:231], v[220:223]
    v_mfma_f32_16x16x32_bf16 v[220:223], v[12:15], v[232:235], v[220:223]
    v_mfma_f32_16x16x32_bf16 v[220:223], v[12:15], v[236:239], v[220:223]
    v_mfma_f32_16x16x32_bf16 v[220:223], v[12:15], v[240:243], v[220:223]
    v_mfma_f32_16x16x32_bf16 v[220:223], v[12:15], v[244:247], v[220:223]
    v_mfma_f32_16x16x32_bf16 v[220:223], v[12:15], v[248:251], v[220:223]
    v_mfma_f32_16x16x32_bf16 v[220:223], v[12:15], v[252:255], v[220:223]
    s_lshl_b32 s38, s28, 10
    s_add_u32 s38, s38, 155648
    v_add_u32 v2, s38, v19
    v_mfma_f32_16x16x32_bf16 v[20:23], v[132:135], v[116:119], v[20:23]
    ds_read_b128 v[156:159], v9 offset:0
    v_mfma_f32_16x16x32_bf16 v[24:27], v[136:139], v[116:119], v[24:27]
    ds_read_b64_tr_b16 v[172:173], v16 offset:43008
    v_mfma_f32_16x16x32_bf16 v[28:31], v[140:143], v[116:119], v[28:31]
    ds_read_b64_tr_b16 v[174:175], v16 offset:44032
    v_mfma_f32_16x16x32_bf16 v[32:35], v[144:147], v[116:119], v[32:35]
    ds_read_b64_tr_b16 v[176:177], v17 offset:43008
    s_add_u32 m0, s35, 28672
    s_nop 0
    buffer_load_dwordx4 v5, s[12:15], s37 offen lds
    v_mfma_f32_16x16x32_bf16 v[36:39], v[116:119], v[148:151], v[36:39]
    v_mfma_f32_16x16x32_bf16 v[40:43], v[116:119], v[152:155], v[40:43]
    ds_read_b64_tr_b16 v[178:179], v17 offset:44032
    v_mfma_f32_16x16x32_bf16 v[44:47], v[132:135], v[120:123], v[44:47]
    ds_read_b64_tr_b16 v[180:181], v16 offset:45056
    v_mfma_f32_16x16x32_bf16 v[48:51], v[136:139], v[120:123], v[48:51]
    ds_read_b64_tr_b16 v[182:183], v16 offset:46080
    v_mfma_f32_16x16x32_bf16 v[52:55], v[140:143], v[120:123], v[52:55]
    ds_read_b64_tr_b16 v[184:185], v17 offset:45056
    v_mfma_f32_16x16x32_bf16 v[56:59], v[144:147], v[120:123], v[56:59]
    buffer_load_dwordx4 v6, s[12:15], s37 offen offset:1024 lds
    s_add_u32 s37, s37, 196608
    v_mfma_f32_16x16x32_bf16 v[60:63], v[120:123], v[148:151], v[60:63]
    ds_read_b64_tr_b16 v[186:187], v17 offset:46080
    v_mfma_f32_16x16x32_bf16 v[64:67], v[120:123], v[152:155], v[64:67]
    ds_read_b64_tr_b16 v[188:189], v16 offset:47104
    v_mfma_f32_16x16x32_bf16 v[68:71], v[132:135], v[124:127], v[68:71]
    ds_read_b64_tr_b16 v[190:191], v16 offset:48128
    v_mfma_f32_16x16x32_bf16 v[72:75], v[136:139], v[124:127], v[72:75]
    ds_read_b64_tr_b16 v[192:193], v17 offset:47104
    v_mfma_f32_16x16x32_bf16 v[76:79], v[140:143], v[124:127], v[76:79]
    v_mfma_f32_16x16x32_bf16 v[80:83], v[144:147], v[124:127], v[80:83]
    ds_read_b64_tr_b16 v[194:195], v17 offset:48128
    s_add_u32 m0, s46, 2048
    s_add_u32 s36, s36, 128
    buffer_load_dwordx4 v3, s[8:11], s34 offen lds
    v_mfma_f32_16x16x32_bf16 v[84:87], v[124:127], v[148:151], v[84:87]
    ds_read_b128 v[160:163], v9 offset:2048
    v_mfma_f32_16x16x32_bf16 v[88:91], v[124:127], v[152:155], v[88:91]
    ds_read_b128 v[164:167], v11 offset:0
    v_mfma_f32_16x16x32_bf16 v[92:95], v[132:135], v[128:131], v[92:95]
    ds_read_b128 v[168:171], v11 offset:2048
    v_mfma_f32_16x16x32_bf16 v[96:99], v[136:139], v[128:131], v[96:99]
    v_mfma_f32_16x16x32_bf16 v[100:103], v[140:143], v[128:131], v[100:103]
    v_mfma_f32_16x16x32_bf16 v[104:107], v[144:147], v[128:131], v[104:107]
    buffer_load_dwordx4 v4, s[8:11], s34 offen offset:1024 lds
    s_add_u32 s46, s46, 32768
    s_cmp_ge_u32 s46, 98304
    s_cselect_b32 s38, 98304, 0
    s_sub_u32 s46, s46, s38
    v_mfma_f32_16x16x32_bf16 v[108:111], v[128:131], v[148:151], v[108:111]
    v_add_u32 v8, s50, v8
    v_add_u32 v10, s50, v10
    v_mfma_f32_16x16x32_bf16 v[112:115], v[128:131], v[152:155], v[112:115]
    ds_write_b128 v2, v[220:223]
    s_waitcnt vmcnt(8) lgkmcnt(0)
    s_barrier
    v_mfma_f32_16x16x32_bf16 v[20:23], v[172:175], v[156:159], v[20:23]
    ds_read_b128 v[116:119], v8 offset:0
    v_mfma_f32_16x16x32_bf16 v[24:27], v[176:179], v[156:159], v[24:27]
    ds_read_b64_tr_b16 v[132:133], v16 offset:0
    v_mfma_f32_16x16x32_bf16 v[28:31], v[180:183], v[156:159], v[28:31]
    ds_read_b64_tr_b16 v[134:135], v16 offset:1024
    v_mfma_f32_16x16x32_bf16 v[32:35], v[184:187], v[156:159], v[32:35]
    ds_read_b64_tr_b16 v[136:137], v17 offset:0
    s_add_u32 m0, s35, 43008
    s_nop 0
    buffer_load_dwordx4 v5, s[12:15], s37 offen lds
    v_mfma_f32_16x16x32_bf16 v[36:39], v[156:159], v[188:191], v[36:39]
    v_mfma_f32_16x16x32_bf16 v[40:43], v[156:159], v[192:195], v[40:43]
    ds_read_b64_tr_b16 v[138:139], v17 offset:1024
    v_mfma_f32_16x16x32_bf16 v[44:47], v[172:175], v[160:163], v[44:47]
    ds_read_b64_tr_b16 v[140:141], v16 offset:2048
    v_mfma_f32_16x16x32_bf16 v[48:51], v[176:179], v[160:163], v[48:51]
    ds_read_b64_tr_b16 v[142:143], v16 offset:3072
    v_mfma_f32_16x16x32_bf16 v[52:55], v[180:183], v[160:163], v[52:55]
    ds_read_b64_tr_b16 v[144:145], v17 offset:2048
    v_mfma_f32_16x16x32_bf16 v[56:59], v[184:187], v[160:163], v[56:59]
    buffer_load_dwordx4 v6, s[12:15], s37 offen offset:1024 lds
    s_add_u32 s37, s37, 196608
    v_mfma_f32_16x16x32_bf16 v[60:63], v[160:163], v[188:191], v[60:63]
    ds_read_b64_tr_b16 v[146:147], v17 offset:3072
    v_mfma_f32_16x16x32_bf16 v[64:67], v[160:163], v[192:195], v[64:67]
    ds_read_b64_tr_b16 v[148:149], v16 offset:4096
    v_mfma_f32_16x16x32_bf16 v[68:71], v[172:175], v[164:167], v[68:71]
    ds_read_b64_tr_b16 v[150:151], v16 offset:5120
    v_mfma_f32_16x16x32_bf16 v[72:75], v[176:179], v[164:167], v[72:75]
    ds_read_b64_tr_b16 v[152:153], v17 offset:4096
    v_mfma_f32_16x16x32_bf16 v[76:79], v[180:183], v[164:167], v[76:79]
    v_mfma_f32_16x16x32_bf16 v[80:83], v[184:187], v[164:167], v[80:83]
    ds_read_b64_tr_b16 v[154:155], v17 offset:5120
    s_mov_b32 m0, s46
    s_nop 0
    buffer_load_dwordx4 v3, s[8:11], s36 offen lds
    v_mfma_f32_16x16x32_bf16 v[84:87], v[164:167], v[188:191], v[84:87]
    ds_read_b128 v[120:123], v8 offset:2048
    v_mfma_f32_16x16x32_bf16 v[88:91], v[164:167], v[192:195], v[88:91]
    ds_read_b128 v[124:127], v10 offset:0
    v_mfma_f32_16x16x32_bf16 v[92:95], v[172:175], v[168:171], v[92:95]
    ds_read_b128 v[128:131], v10 offset:2048
    v_mfma_f32_16x16x32_bf16 v[96:99], v[176:179], v[168:171], v[96:99]
    v_mfma_f32_16x16x32_bf16 v[100:103], v[180:183], v[168:171], v[100:103]
    v_mfma_f32_16x16x32_bf16 v[104:107], v[184:187], v[168:171], v[104:107]
    buffer_load_dwordx4 v4, s[8:11], s36 offen offset:1024 lds
    s_add_u32 s34, s36, 32768
    v_mfma_f32_16x16x32_bf16 v[108:111], v[168:171], v[188:191], v[108:111]
    v_add_u32 v9, s50, v9
    v_add_u32 v11, s50, v11
    s_add_u32 s47, s47, s50
    s_cmp_eq_u32 s47, 65536
    s_cselect_b32 s50, 0xffff0000, s51
    v_mfma_f32_16x16x32_bf16 v[112:115], v[168:171], v[192:195], v[112:115]
    s_mov_b32 s44, 5
L_k1loop_1:
    s_waitcnt vmcnt(8) lgkmcnt(0)
    s_barrier
    v_mfma_f32_16x16x32_bf16 v[20:23], v[132:135], v[116:119], v[20:23]
    ds_read_b128 v[156:159], v9 offset:0
    v_mfma_f32_16x16x32_bf16 v[24:27], v[136:139], v[116:119], v[24:27]
    ds_read_b64_tr_b16 v[172:173], v16 offset:14336
    v_mfma_f32_16x16x32_bf16 v[28:31], v[140:143], v[116:119], v[28:31]
    ds_read_b64_tr_b16 v[174:175], v16 offset:15360
    v_mfma_f32_16x16x32_bf16 v[32:35], v[144:147], v[116:119], v[32:35]
    ds_read_b64_tr_b16 v[176:177], v17 offset:14336
    s_add_u32 m0, s35, 0
    s_nop 0
    buffer_load_dwordx4 v5, s[12:15], s37 offen lds
    v_mfma_f32_16x16x32_bf16 v[36:39], v[116:119], v[148:151], v[36:39]
    v_mfma_f32_16x16x32_bf16 v[40:43], v[116:119], v[152:155], v[40:43]
    ds_read_b64_tr_b16 v[178:179], v17 offset:15360
    v_mfma_f32_16x16x32_bf16 v[44:47], v[132:135], v[120:123], v[44:47]
    ds_read_b64_tr_b16 v[180:181], v16 offset:16384
    v_mfma_f32_16x16x32_bf16 v[48:51], v[136:139], v[120:123], v[48:51]
    ds_read_b64_tr_b16 v[182:183], v16 offset:17408
    v_mfma_f32_16x16x32_bf16 v[52:55], v[140:143], v[120:123], v[52:55]
    ds_read_b64_tr_b16 v[184:185], v17 offset:16384
    v_mfma_f32_16x16x32_bf16 v[56:59], v[144:147], v[120:123], v[56:59]
    buffer_load_dwordx4 v6, s[12:15], s37 offen offset:1024 lds
    s_add_u32 s37, s37, 196608
    v_mfma_f32_16x16x32_bf16 v[60:63], v[120:123], v[148:151], v[60:63]
    ds_read_b64_tr_b16 v[186:187], v17 offset:17408
    v_mfma_f32_16x16x32_bf16 v[64:67], v[120:123], v[152:155], v[64:67]
    ds_read_b64_tr_b16 v[188:189], v16 offset:18432
    v_mfma_f32_16x16x32_bf16 v[68:71], v[132:135], v[124:127], v[68:71]
    ds_read_b64_tr_b16 v[190:191], v16 offset:19456
    v_mfma_f32_16x16x32_bf16 v[72:75], v[136:139], v[124:127], v[72:75]
    ds_read_b64_tr_b16 v[192:193], v17 offset:18432
    v_mfma_f32_16x16x32_bf16 v[76:79], v[140:143], v[124:127], v[76:79]
    v_mfma_f32_16x16x32_bf16 v[80:83], v[144:147], v[124:127], v[80:83]
    ds_read_b64_tr_b16 v[194:195], v17 offset:19456
    s_add_u32 m0, s46, 2048
    s_add_u32 s36, s36, 128
    buffer_load_dwordx4 v3, s[8:11], s34 offen lds
    v_mfma_f32_16x16x32_bf16 v[84:87], v[124:127], v[148:151], v[84:87]
    ds_read_b128 v[160:163], v9 offset:2048
    v_mfma_f32_16x16x32_bf16 v[88:91], v[124:127], v[152:155], v[88:91]
    ds_read_b128 v[164:167], v11 offset:0
    v_mfma_f32_16x16x32_bf16 v[92:95], v[132:135], v[128:131], v[92:95]
    ds_read_b128 v[168:171], v11 offset:2048
    v_mfma_f32_16x16x32_bf16 v[96:99], v[136:139], v[128:131], v[96:99]
    v_mfma_f32_16x16x32_bf16 v[100:103], v[140:143], v[128:131], v[100:103]
    v_mfma_f32_16x16x32_bf16 v[104:107], v[144:147], v[128:131], v[104:107]
    buffer_load_dwordx4 v4, s[8:11], s34 offen offset:1024 lds
    s_add_u32 s46, s46, 32768
    s_cmp_ge_u32 s46, 98304
    s_cselect_b32 s38, 98304, 0
    s_sub_u32 s46, s46, s38
    v_mfma_f32_16x16x32_bf16 v[108:111], v[128:131], v[148:151], v[108:111]
    v_add_u32 v8, s50, v8
    v_add_u32 v10, s50, v10
    v_mfma_f32_16x16x32_bf16 v[112:115], v[128:131], v[152:155], v[112:115]
    s_waitcnt vmcnt(8) lgkmcnt(0)
    s_barrier
    v_mfma_f32_16x16x32_bf16 v[20:23], v[172:175], v[156:159], v[20:23]
    ds_read_b128 v[116:119], v8 offset:0
    v_mfma_f32_16x16x32_bf16 v[24:27], v[176:179], v[156:159], v[24:27]
    ds_read_b64_tr_b16 v[132:133], v16 offset:28672
    v_mfma_f32_16x16x32_bf16 v[28:31], v[180:183], v[156:159], v[28:31]
    ds_read_b64_tr_b16 v[134:135], v16 offset:29696
    v_mfma_f32_16x16x32_bf16 v[32:35], v[184:187], v[156:159], v[32:35]
    ds_read_b64_tr_b16 v[136:137], v17 offset:28672
    s_add_u32 m0, s35, 14336
    s_nop 0
    buffer_load_dwordx4 v5, s[12:15], s37 offen lds
    v_mfma_f32_16x16x32_bf16 v[36:39], v[156:159], v[188:191], v[36:39]
    v_mfma_f32_16x16x32_bf16 v[40:43], v[156:159], v[192:195], v[40:43]
    ds_read_b64_tr_b16 v[138:139], v17 offset:29696
    v_mfma_f32_16x16x32_bf16 v[44:47], v[172:175], v[160:163], v[44:47]
    ds_read_b64_tr_b16 v[140:141], v16 offset:30720
    v_mfma_f32_16x16x32_bf16 v[48:51], v[176:179], v[160:163], v[48:51]
    ds_read_b64_tr_b16 v[142:143], v16 offset:31744
    v_mfma_f32_16x16x32_bf16 v[52:55], v[180:183], v[160:163], v[52:55]
    ds_read_b64_tr_b16 v[144:145], v17 offset:30720
    v_mfma_f32_16x16x32_bf16 v[56:59], v[184:187], v[160:163], v[56:59]
    buffer_load_dwordx4 v6, s[12:15], s37 offen offset:1024 lds
    s_add_u32 s37, s37, 196608
    v_mfma_f32_16x16x32_bf16 v[60:63], v[160:163], v[188:191], v[60:63]
    ds_read_b64_tr_b16 v[146:147], v17 offset:31744
    v_mfma_f32_16x16x32_bf16 v[64:67], v[160:163], v[192:195], v[64:67]
    ds_read_b64_tr_b16 v[148:149], v16 offset:32768
    v_mfma_f32_16x16x32_bf16 v[68:71], v[172:175], v[164:167], v[68:71]
    ds_read_b64_tr_b16 v[150:151], v16 offset:33792
    v_mfma_f32_16x16x32_bf16 v[72:75], v[176:179], v[164:167], v[72:75]
    ds_read_b64_tr_b16 v[152:153], v17 offset:32768
    v_mfma_f32_16x16x32_bf16 v[76:79], v[180:183], v[164:167], v[76:79]
    v_mfma_f32_16x16x32_bf16 v[80:83], v[184:187], v[164:167], v[80:83]
    ds_read_b64_tr_b16 v[154:155], v17 offset:33792
    s_mov_b32 m0, s46
    s_nop 0
    buffer_load_dwordx4 v3, s[8:11], s36 offen lds
    v_mfma_f32_16x16x32_bf16 v[84:87], v[164:167], v[188:191], v[84:87]
    ds_read_b128 v[120:123], v8 offset:2048
    v_mfma_f32_16x16x32_bf16 v[88:91], v[164:167], v[192:195], v[88:91]
    ds_read_b128 v[124:127], v10 offset:0
    v_mfma_f32_16x16x32_bf16 v[92:95], v[172:175], v[168:171], v[92:95]
    ds_read_b128 v[128:131], v10 offset:2048
    v_mfma_f32_16x16x32_bf16 v[96:99], v[176:179], v[168:171], v[96:99]
    v_mfma_f32_16x16x32_bf16 v[100:103], v[180:183], v[168:171], v[100:103]
    v_mfma_f32_16x16x32_bf16 v[104:107], v[184:187], v[168:171], v[104:107]
    buffer_load_dwordx4 v4, s[8:11], s36 offen offset:1024 lds
    s_add_u32 s34, s36, 32768
    v_mfma_f32_16x16x32_bf16 v[108:111], v[168:171], v[188:191], v[108:111]
    v_add_u32 v9, s50, v9
    v_add_u32 v11, s50, v11
    s_add_u32 s47, s47, s50
    s_cmp_eq_u32 s47, 65536
    s_cselect_b32 s50, 0xffff0000, s51
    v_mfma_f32_16x16x32_bf16 v[112:115], v[168:171], v[192:195], v[112:115]
    s_waitcnt vmcnt(8) lgkmcnt(0)
    s_barrier
    v_mfma_f32_16x16x32_bf16 v[20:23], v[132:135], v[116:119], v[20:23]
    ds_read_b128 v[156:159], v9 offset:0
    v_mfma_f32_16x16x32_bf16 v[24:27], v[136:139], v[116:119], v[24:27]
    ds_read_b64_tr_b16 v[172:173], v16 offset:43008
    v_mfma_f32_16x16x32_bf16 v[28:31], v[140:143], v[116:119], v[28:31]
    ds_read_b64_tr_b16 v[174:175], v16 offset:44032
    v_mfma_f32_16x16x32_bf16 v[32:35], v[144:147], v[116:119], v[32:35]
    ds_read_b64_tr_b16 v[176:177], v17 offset:43008
    s_add_u32 m0, s35, 28672
    s_nop 0
    buffer_load_dwordx4 v5, s[12:15], s37 offen lds
    v_mfma_f32_16x16x32_bf16 v[36:39], v[116:119], v[148:151], v[36:39]
    v_mfma_f32_16x16x32_bf16 v[40:43], v[116:119], v[152:155], v[40:43]
    ds_read_b64_tr_b16 v[178:179], v17 offset:44032
    v_mfma_f32_16x16x32_bf16 v[44:47], v[132:135], v[120:123], v[44:47]
    ds_read_b64_tr_b16 v[180:181], v16 offset:45056
    v_mfma_f32_16x16x32_bf16 v[48:51], v[136:139], v[120:123], v[48:51]
    ds_read_b64_tr_b16 v[182:183], v16 offset:46080
    v_mfma_f32_16x16x32_bf16 v[52:55], v[140:143], v[120:123], v[52:55]
    ds_read_b64_tr_b16 v[184:185], v17 offset:45056
    v_mfma_f32_16x16x32_bf16 v[56:59], v[144:147], v[120:123], v[56:59]
    buffer_load_dwordx4 v6, s[12:15], s37 offen offset:1024 lds
    s_add_u32 s37, s37, 196608
    v_mfma_f32_16x16x32_bf16 v[60:63], v[120:123], v[148:151], v[60:63]
    ds_read_b64_tr_b16 v[186:187], v17 offset:46080
    v_mfma_f32_16x16x32_bf16 v[64:67], v[120:123], v[152:155], v[64:67]
    ds_read_b64_tr_b16 v[188:189], v16 offset:47104
    v_mfma_f32_16x16x32_bf16 v[68:71], v[132:135], v[124:127], v[68:71]
    ds_read_b64_tr_b16 v[190:191], v16 offset:48128
    v_mfma_f32_16x16x32_bf16 v[72:75], v[136:139], v[124:127], v[72:75]
    ds_read_b64_tr_b16 v[192:193], v17 offset:47104
    v_mfma_f32_16x16x32_bf16 v[76:79], v[140:143], v[124:127], v[76:79]
    v_mfma_f32_16x16x32_bf16 v[80:83], v[144:147], v[124:127], v[80:83]
    ds_read_b64_tr_b16 v[194:195], v17 offset:48128
    s_add_u32 m0, s46, 2048
    s_add_u32 s36, s36, 128
    buffer_load_dwordx4 v3, s[8:11], s34 offen lds
    v_mfma_f32_16x16x32_bf16 v[84:87], v[124:127], v[148:151], v[84:87]
    ds_read_b128 v[160:163], v9 offset:2048
    v_mfma_f32_16x16x32_bf16 v[88:91], v[124:127], v[152:155], v[88:91]
    ds_read_b128 v[164:167], v11 offset:0
    v_mfma_f32_16x16x32_bf16 v[92:95], v[132:135], v[128:131], v[92:95]
    ds_read_b128 v[168:171], v11 offset:2048
    v_mfma_f32_16x16x32_bf16 v[96:99], v[136:139], v[128:131], v[96:99]
    v_mfma_f32_16x16x32_bf16 v[100:103], v[140:143], v[128:131], v[100:103]
    v_mfma_f32_16x16x32_bf16 v[104:107], v[144:147], v[128:131], v[104:107]
    buffer_load_dwordx4 v4, s[8:11], s34 offen offset:1024 lds
    s_add_u32 s46, s46, 32768
    s_cmp_ge_u32 s46, 98304
    s_cselect_b32 s38, 98304, 0
    s_sub_u32 s46, s46, s38
    v_mfma_f32_16x16x32_bf16 v[108:111], v[128:131], v[148:151], v[108:111]
    v_add_u32 v8, s50, v8
    v_add_u32 v10, s50, v10
    v_mfma_f32_16x16x32_bf16 v[112:115], v[128:131], v[152:155], v[112:115]
    s_waitcnt vmcnt(8) lgkmcnt(0)
    s_barrier
    v_mfma_f32_16x16x32_bf16 v[20:23], v[172:175], v[156:159], v[20:23]
    ds_read_b128 v[116:119], v8 offset:0
    v_mfma_f32_16x16x32_bf16 v[24:27], v[176:179], v[156:159], v[24:27]
    ds_read_b64_tr_b16 v[132:133], v16 offset:0
    v_mfma_f32_16x16x32_bf16 v[28:31], v[180:183], v[156:159], v[28:31]
    ds_read_b64_tr_b16 v[134:135], v16 offset:1024
    v_mfma_f32_16x16x32_bf16 v[32:35], v[184:187], v[156:159], v[32:35]
    ds_read_b64_tr_b16 v[136:137], v17 offset:0
    s_add_u32 m0, s35, 43008
    s_nop 0
    buffer_load_dwordx4 v5, s[12:15], s37 offen lds
    v_mfma_f32_16x16x32_bf16 v[36:39], v[156:159], v[188:191], v[36:39]
    v_mfma_f32_16x16x32_bf16 v[40:43], v[156:159], v[192:195], v[40:43]
    ds_read_b64_tr_b16 v[138:139], v17 offset:1024
    v_mfma_f32_16x16x32_bf16 v[44:47], v[172:175], v[160:163], v[44:47]
    ds_read_b64_tr_b16 v[140:141], v16 offset:2048
    v_mfma_f32_16x16x32_bf16 v[48:51], v[176:179], v[160:163], v[48:51]
    ds_read_b64_tr_b16 v[142:143], v16 offset:3072
    v_mfma_f32_16x16x32_bf16 v[52:55], v[180:183], v[160:163], v[52:55]
    ds_read_b64_tr_b16 v[144:145], v17 offset:2048
    v_mfma_f32_16x16x32_bf16 v[56:59], v[184:187], v[160:163], v[56:59]
    buffer_load_dwordx4 v6, s[12:15], s37 offen offset:1024 lds
    s_add_u32 s37, s37, 196608
    v_mfma_f32_16x16x32_bf16 v[60:63], v[160:163], v[188:191], v[60:63]
    ds_read_b64_tr_b16 v[146:147], v17 offset:3072
    v_mfma_f32_16x16x32_bf16 v[64:67], v[160:163], v[192:195], v[64:67]
    ds_read_b64_tr_b16 v[148:149], v16 offset:4096
    v_mfma_f32_16x16x32_bf16 v[68:71], v[172:175], v[164:167], v[68:71]
    ds_read_b64_tr_b16 v[150:151], v16 offset:5120
    v_mfma_f32_16x16x32_bf16 v[72:75], v[176:179], v[164:167], v[72:75]
    ds_read_b64_tr_b16 v[152:153], v17 offset:4096
    v_mfma_f32_16x16x32_bf16 v[76:79], v[180:183], v[164:167], v[76:79]
    v_mfma_f32_16x16x32_bf16 v[80:83], v[184:187], v[164:167], v[80:83]
    ds_read_b64_tr_b16 v[154:155], v17 offset:5120
    s_mov_b32 m0, s46
    s_nop 0
    buffer_load_dwordx4 v3, s[8:11], s36 offen lds
    v_mfma_f32_16x16x32_bf16 v[84:87], v[164:167], v[188:191], v[84:87]
    ds_read_b128 v[120:123], v8 offset:2048
    v_mfma_f32_16x16x32_bf16 v[88:91], v[164:167], v[192:195], v[88:91]
    ds_read_b128 v[124:127], v10 offset:0
    v_mfma_f32_16x16x32_bf16 v[92:95], v[172:175], v[168:171], v[92:95]
    ds_read_b128 v[128:131], v10 offset:2048
    v_mfma_f32_16x16x32_bf16 v[96:99], v[176:179], v[168:171], v[96:99]
    v_mfma_f32_16x16x32_bf16 v[100:103], v[180:183], v[168:171], v[100:103]
    v_mfma_f32_16x16x32_bf16 v[104:107], v[184:187], v[168:171], v[104:107]
    buffer_load_dwordx4 v4, s[8:11], s36 offen offset:1024 lds
    s_add_u32 s34, s36, 32768
    v_mfma_f32_16x16x32_bf16 v[108:111], v[168:171], v[188:191], v[108:111]
    v_add_u32 v9, s50, v9
    v_add_u32 v11, s50, v11
    s_add_u32 s47, s47, s50
    s_cmp_eq_u32 s47, 65536
    s_cselect_b32 s50, 0xffff0000, s51
    v_mfma_f32_16x16x32_bf16 v[112:115], v[168:171], v[192:195], v[112:115]
    s_sub_u32 s44, s44, 1
    s_cmp_lg_u32 s44, 0
    s_cbranch_scc1 L_k1loop_1
    s_waitcnt vmcnt(8) lgkmcnt(0)
    s_barrier
    v_mfma_f32_16x16x32_bf16 v[20:23], v[132:135], v[116:119], v[20:23]
    ds_read_b128 v[156:159], v9 offset:0
    v_mfma_f32_16x16x32_bf16 v[24:27], v[136:139], v[116:119], v[24:27]
    ds_read_b64_tr_b16 v[172:173], v16 offset:14336
    v_mfma_f32_16x16x32_bf16 v[28:31], v[140:143], v[116:119], v[28:31]
    ds_read_b64_tr_b16 v[174:175], v16 offset:15360
    v_mfma_f32_16x16x32_bf16 v[32:35], v[144:147], v[116:119], v[32:35]
    ds_read_b64_tr_b16 v[176:177], v17 offset:14336
    v_mfma_f32_16x16x32_bf16 v[36:39], v[116:119], v[148:151], v[36:39]
    v_mfma_f32_16x16x32_bf16 v[40:43], v[116:119], v[152:155], v[40:43]
    ds_read_b64_tr_b16 v[178:179], v17 offset:15360
    v_mfma_f32_16x16x32_bf16 v[44:47], v[132:135], v[120:123], v[44:47]
    ds_read_b64_tr_b16 v[180:181], v16 offset:16384
    v_mfma_f32_16x16x32_bf16 v[48:51], v[136:139], v[120:123], v[48:51]
    ds_read_b64_tr_b16 v[182:183], v16 offset:17408
    v_mfma_f32_16x16x32_bf16 v[52:55], v[140:143], v[120:123], v[52:55]
    ds_read_b64_tr_b16 v[184:185], v17 offset:16384
    v_mfma_f32_16x16x32_bf16 v[56:59], v[144:147], v[120:123], v[56:59]
    v_mfma_f32_16x16x32_bf16 v[60:63], v[120:123], v[148:151], v[60:63]
    ds_read_b64_tr_b16 v[186:187], v17 offset:17408
    v_mfma_f32_16x16x32_bf16 v[64:67], v[120:123], v[152:155], v[64:67]
    ds_read_b64_tr_b16 v[188:189], v16 offset:18432
    v_mfma_f32_16x16x32_bf16 v[68:71], v[132:135], v[124:127], v[68:71]
    ds_read_b64_tr_b16 v[190:191], v16 offset:19456
    v_mfma_f32_16x16x32_bf16 v[72:75], v[136:139], v[124:127], v[72:75]
    ds_read_b64_tr_b16 v[192:193], v17 offset:18432
    v_mfma_f32_16x16x32_bf16 v[76:79], v[140:143], v[124:127], v[76:79]
    v_mfma_f32_16x16x32_bf16 v[80:83], v[144:147], v[124:127], v[80:83]
    ds_read_b64_tr_b16 v[194:195], v17 offset:19456
    v_mfma_f32_16x16x32_bf16 v[84:87], v[124:127], v[148:151], v[84:87]
    ds_read_b128 v[160:163], v9 offset:2048
    v_mfma_f32_16x16x32_bf16 v[88:91], v[124:127], v[152:155], v[88:91]
    ds_read_b128 v[164:167], v11 offset:0
    v_mfma_f32_16x16x32_bf16 v[92:95], v[132:135], v[128:131], v[92:95]
    ds_read_b128 v[168:171], v11 offset:2048
    v_mfma_f32_16x16x32_bf16 v[96:99], v[136:139], v[128:131], v[96:99]
    v_mfma_f32_16x16x32_bf16 v[100:103], v[140:143], v[128:131], v[100:103]
    v_mfma_f32_16x16x32_bf16 v[104:107], v[144:147], v[128:131], v[104:107]
    v_mfma_f32_16x16x32_bf16 v[108:111], v[128:131], v[148:151], v[108:111]
    v_add_u32 v8, s50, v8
    v_add_u32 v10, s50, v10
    v_mfma_f32_16x16x32_bf16 v[112:115], v[128:131], v[152:155], v[112:115]
    s_waitcnt vmcnt(4) lgkmcnt(0)
    s_barrier
    v_mfma_f32_16x16x32_bf16 v[20:23], v[172:175], v[156:159], v[20:23]
    ds_read_b128 v[116:119], v8 offset:0
    v_mfma_f32_16x16x32_bf16 v[24:27], v[176:179], v[156:159], v[24:27]
    ds_read_b64_tr_b16 v[132:133], v16 offset:28672
    v_mfma_f32_16x16x32_bf16 v[28:31], v[180:183], v[156:159], v[28:31]
    ds_read_b64_tr_b16 v[134:135], v16 offset:29696
    v_mfma_f32_16x16x32_bf16 v[32:35], v[184:187], v[156:159], v[32:35]
    ds_read_b64_tr_b16 v[136:137], v17 offset:28672
    v_mfma_f32_16x16x32_bf16 v[36:39], v[156:159], v[188:191], v[36:39]
    v_mfma_f32_16x16x32_bf16 v[40:43], v[156:159], v[192:195], v[40:43]
    ds_read_b64_tr_b16 v[138:139], v17 offset:29696
    v_mfma_f32_16x16x32_bf16 v[44:47], v[172:175], v[160:163], v[44:47]
    ds_read_b64_tr_b16 v[140:141], v16 offset:30720
    v_mfma_f32_16x16x32_bf16 v[48:51], v[176:179], v[160:163], v[48:51]
    ds_read_b64_tr_b16 v[142:143], v16 offset:31744
    v_mfma_f32_16x16x32_bf16 v[52:55], v[180:183], v[160:163], v[52:55]
    ds_read_b64_tr_b16 v[144:145], v17 offset:30720
    v_mfma_f32_16x16x32_bf16 v[56:59], v[184:187], v[160:163], v[56:59]
    v_mfma_f32_16x16x32_bf16 v[60:63], v[160:163], v[188:191], v[60:63]
    ds_read_b64_tr_b16 v[146:147], v17 offset:31744
    v_mfma_f32_16x16x32_bf16 v[64:67], v[160:163], v[192:195], v[64:67]
    ds_read_b64_tr_b16 v[148:149], v16 offset:32768
    v_mfma_f32_16x16x32_bf16 v[68:71], v[172:175], v[164:167], v[68:71]
    ds_read_b64_tr_b16 v[150:151], v16 offset:33792
    v_mfma_f32_16x16x32_bf16 v[72:75], v[176:179], v[164:167], v[72:75]
    ds_read_b64_tr_b16 v[152:153], v17 offset:32768
    v_mfma_f32_16x16x32_bf16 v[76:79], v[180:183], v[164:167], v[76:79]
    v_mfma_f32_16x16x32_bf16 v[80:83], v[184:187], v[164:167], v[80:83]
    ds_read_b64_tr_b16 v[154:155], v17 offset:33792
    v_mfma_f32_16x16x32_bf16 v[84:87], v[164:167], v[188:191], v[84:87]
    ds_read_b128 v[120:123], v8 offset:2048
    v_mfma_f32_16x16x32_bf16 v[88:91], v[164:167], v[192:195], v[88:91]
    ds_read_b128 v[124:127], v10 offset:0
    v_mfma_f32_16x16x32_bf16 v[92:95], v[172:175], v[168:171], v[92:95]
    ds_read_b128 v[128:131], v10 offset:2048
    v_mfma_f32_16x16x32_bf16 v[96:99], v[176:179], v[168:171], v[96:99]
    v_mfma_f32_16x16x32_bf16 v[100:103], v[180:183], v[168:171], v[100:103]
    v_mfma_f32_16x16x32_bf16 v[104:107], v[184:187], v[168:171], v[104:107]
    v_mfma_f32_16x16x32_bf16 v[108:111], v[168:171], v[188:191], v[108:111]
    v_add_u32 v9, s50, v9
    v_add_u32 v11, s50, v11
    s_add_u32 s47, s47, s50
    s_cmp_eq_u32 s47, 65536
    s_cselect_b32 s50, 0xffff0000, s51
    v_mfma_f32_16x16x32_bf16 v[112:115], v[168:171], v[192:195], v[112:115]
    s_waitcnt vmcnt(0) lgkmcnt(0)
    s_barrier
    v_lshlrev_b32 v7, 6, v1
    s_lshl_b32 s38, s31, 12
    s_mov_b32 s16, s90
    s_mov_b32 s17, s91
    s_mov_b32 s18, 0x700000
    s_mov_b32 s19, 0x00020000
    buffer_load_dword v3, v7, s[16:19], s38 offen
    s_mov_b32 s16, s92
    s_mov_b32 s17, s93
    s_mov_b32 s18, 0x200000
    s_mov_b32 s19, 0x00020000
    buffer_load_dword v4, v7, s[16:19], s38 offen
    s_lshl_b32 s38, s32, 7
    s_sub_u32 s39, 156544, s38
    s_add_u32 s38, s38, 155648
    v_and_b32 v2, 15, v1
    v_and_b32 v7, 48, v1
    v_lshl_add_u32 v12, v2, 2, s38
    v_lshl_add_u32 v13, v2, 2, s39
    v_add_u32 v14, s38, v7
    v_add_u32 v15, s39, v7
    s_lshl_b32 s38, s33, 7
    s_add_u32 s38, s38, 157696
    v_add_u32 v5, s38, v7
    v_lshl_add_u32 v6, v2, 2, s38
    v_mfma_f32_16x16x32_bf16 v[20:23], v[132:135], v[116:119], v[20:23]
    ds_read_b128 v[156:159], v9 offset:0
    v_mfma_f32_16x16x32_bf16 v[24:27], v[136:139], v[116:119], v[24:27]
    ds_read_b64_tr_b16 v[172:173], v16 offset:43008
    v_mfma_f32_16x16x32_bf16 v[28:31], v[140:143], v[116:119], v[28:31]
    ds_read_b64_tr_b16 v[174:175], v16 offset:44032
    v_mfma_f32_16x16x32_bf16 v[32:35], v[144:147], v[116:119], v[32:35]
    ds_read_b64_tr_b16 v[176:177], v17 offset:43008
    v_mfma_f32_16x16x32_bf16 v[36:39], v[116:119], v[148:151], v[36:39]
    v_mfma_f32_16x16x32_bf16 v[40:43], v[116:119], v[152:155], v[40:43]
    ds_read_b64_tr_b16 v[178:179], v17 offset:44032
    v_mfma_f32_16x16x32_bf16 v[44:47], v[132:135], v[120:123], v[44:47]
    ds_read_b64_tr_b16 v[180:181], v16 offset:45056
    v_mfma_f32_16x16x32_bf16 v[48:51], v[136:139], v[120:123], v[48:51]
    ds_read_b64_tr_b16 v[182:183], v16 offset:46080
    v_mfma_f32_16x16x32_bf16 v[52:55], v[140:143], v[120:123], v[52:55]
    ds_read_b64_tr_b16 v[184:185], v17 offset:45056
    v_mfma_f32_16x16x32_bf16 v[56:59], v[144:147], v[120:123], v[56:59]
    v_mfma_f32_16x16x32_bf16 v[60:63], v[120:123], v[148:151], v[60:63]
    ds_read_b64_tr_b16 v[186:187], v17 offset:46080
    v_mfma_f32_16x16x32_bf16 v[64:67], v[120:123], v[152:155], v[64:67]
    ds_read_b64_tr_b16 v[188:189], v16 offset:47104
    v_mfma_f32_16x16x32_bf16 v[68:71], v[132:135], v[124:127], v[68:71]
    ds_read_b64_tr_b16 v[190:191], v16 offset:48128
    v_mfma_f32_16x16x32_bf16 v[72:75], v[136:139], v[124:127], v[72:75]
    ds_read_b64_tr_b16 v[192:193], v17 offset:47104
    v_mfma_f32_16x16x32_bf16 v[76:79], v[140:143], v[124:127], v[76:79]
    v_mfma_f32_16x16x32_bf16 v[80:83], v[144:147], v[124:127], v[80:83]
    ds_read_b64_tr_b16 v[194:195], v17 offset:48128
    v_mfma_f32_16x16x32_bf16 v[84:87], v[124:127], v[148:151], v[84:87]
    ds_read_b128 v[160:163], v9 offset:2048
    v_mfma_f32_16x16x32_bf16 v[88:91], v[124:127], v[152:155], v[88:91]
    ds_read_b128 v[164:167], v11 offset:0
    v_mfma_f32_16x16x32_bf16 v[92:95], v[132:135], v[128:131], v[92:95]
    ds_read_b128 v[168:171], v11 offset:2048
    v_mfma_f32_16x16x32_bf16 v[96:99], v[136:139], v[128:131], v[96:99]
    v_mfma_f32_16x16x32_bf16 v[100:103], v[140:143], v[128:131], v[100:103]
    v_mfma_f32_16x16x32_bf16 v[104:107], v[144:147], v[128:131], v[104:107]
    v_mfma_f32_16x16x32_bf16 v[108:111], v[128:131], v[148:151], v[108:111]
    v_add_u32 v8, s50, v8
    v_add_u32 v10, s50, v10
    v_mfma_f32_16x16x32_bf16 v[112:115], v[128:131], v[152:155], v[112:115]
    s_waitcnt vmcnt(2) lgkmcnt(0)
    s_barrier
    v_mfma_f32_16x16x32_bf16 v[20:23], v[172:175], v[156:159], v[20:23]
    ds_read_b32 v196, v12 offset:0
    ds_read_b32 v197, v12 offset:1024
    v_mfma_f32_16x16x32_bf16 v[24:27], v[176:179], v[156:159], v[24:27]
    ds_read_b32 v198, v12 offset:64
    v_mfma_f32_16x16x32_bf16 v[28:31], v[180:183], v[156:159], v[28:31]
    ds_read_b32 v199, v12 offset:1088
    ds_read_b32 v200, v13 offset:0
    v_mfma_f32_16x16x32_bf16 v[32:35], v[184:187], v[156:159], v[32:35]
    ds_read_b32 v201, v13 offset:1024
    v_mfma_f32_16x16x32_bf16 v[36:39], v[156:159], v[188:191], v[36:39]
    ds_read_b32 v202, v13 offset:64
    v_mfma_f32_16x16x32_bf16 v[40:43], v[156:159], v[192:195], v[40:43]
    ds_read_b32 v203, v13 offset:1088
    ds_read_b128 v[116:119], v5 offset:0
    v_mfma_f32_16x16x32_bf16 v[44:47], v[172:175], v[160:163], v[44:47]
    ds_read_b128 v[120:123], v5 offset:64
    v_mfma_f32_16x16x32_bf16 v[48:51], v[176:179], v[160:163], v[48:51]
    ds_read_b128 v[124:127], v5 offset:256
    ds_read_b128 v[128:131], v5 offset:320
    v_mfma_f32_16x16x32_bf16 v[52:55], v[180:183], v[160:163], v[52:55]
    ds_read_b32 v132, v6 offset:512
    v_mfma_f32_16x16x32_bf16 v[56:59], v[184:187], v[160:163], v[56:59]
    ds_read_b32 v133, v6 offset:576
    v_mfma_f32_16x16x32_bf16 v[60:63], v[160:163], v[188:191], v[60:63]
    ds_read_b128 v[134:137], v5 offset:1024
    ds_read_b128 v[138:141], v5 offset:1088
    v_mfma_f32_16x16x32_bf16 v[64:67], v[160:163], v[192:195], v[64:67]
    ds_read_b128 v[142:145], v5 offset:1280
    v_mfma_f32_16x16x32_bf16 v[68:71], v[172:175], v[164:167], v[68:71]
    ds_read_b128 v[146:149], v5 offset:1344
    ds_read_b32 v150, v6 offset:1536
    v_mfma_f32_16x16x32_bf16 v[72:75], v[176:179], v[164:167], v[72:75]
    ds_read_b32 v151, v6 offset:1600
    v_mfma_f32_16x16x32_bf16 v[76:79], v[180:183], v[164:167], v[76:79]
    ds_read_b128 v[204:207], v14 offset:0
    v_mfma_f32_16x16x32_bf16 v[80:83], v[184:187], v[164:167], v[80:83]
    ds_read_b128 v[208:211], v14 offset:1024
    ds_read_b128 v[212:215], v14 offset:64
    v_mfma_f32_16x16x32_bf16 v[84:87], v[164:167], v[188:191], v[84:87]
    ds_read_b128 v[216:219], v14 offset:1088
    v_mfma_f32_16x16x32_bf16 v[88:91], v[164:167], v[192:195], v[88:91]
    ds_read_b128 v[220:223], v15 offset:0
    ds_read_b128 v[224:227], v15 offset:1024
    v_mfma_f32_16x16x32_bf16 v[92:95], v[172:175], v[168:171], v[92:95]
    ds_read_b128 v[228:231], v15 offset:64
    v_mfma_f32_16x16x32_bf16 v[96:99], v[176:179], v[168:171], v[96:99]
    ds_read_b128 v[232:235], v15 offset:1088
    v_mfma_f32_16x16x32_bf16 v[100:103], v[180:183], v[168:171], v[100:103]
    v_mfma_f32_16x16x32_bf16 v[104:107], v[184:187], v[168:171], v[104:107]
    v_mfma_f32_16x16x32_bf16 v[108:111], v[168:171], v[188:191], v[108:111]
    v_add_u32 v9, s50, v9
    v_add_u32 v11, s50, v11
    s_add_u32 s47, s47, s50
    s_cmp_eq_u32 s47, 65536
    s_cselect_b32 s50, 0xffff0000, s51
    v_mfma_f32_16x16x32_bf16 v[112:115], v[168:171], v[192:195], v[112:115]
    s_branch L_k1_qkv_epi
L_k1_qkv_role1:
    s_mov_b32 m0, s46
    s_nop 0
    buffer_load_dwordx4 v3, s[8:11], s36 offen lds
    buffer_load_dwordx4 v4, s[8:11], s36 offen offset:1024 lds
    s_add_u32 s34, s36, 32768
    s_add_u32 m0, s46, 2048
    s_add_u32 s36, s36, 128
    buffer_load_dwordx4 v3, s[8:11], s34 offen lds
    buffer_load_dwordx4 v4, s[8:11], s34 offen offset:1024 lds
    s_add_u32 s46, s46, 32768
    s_cmp_ge_u32 s46, 98304
    s_cselect_b32 s38, 98304, 0
    s_sub_u32 s46, s46, s38
    s_cmp_lt_u32 s2, 96
    s_cselect_b32 s16, s22, s24
    s_cselect_b32 s17, s23, s25
    s_cselect_b32 s38, 6144, s40
    s_cselect_b32 s39, 0, 96
    s_lshl_b32 s18, s38, 10
    s_cmp_ge_u32 s2, 208
    s_cselect_b32 s18, 0, s18
    s_mov_b32 s19, 0x00020000
    s_sub_u32 s39, s2, s39
    s_and_b32 s41, s39, 1
    s_lshl_b32 s41, s41, 3
    s_add_u32 s41, s41, s28
    s_lshl_b32 s41, s41, 6
    s_mul_i32 s41, s41, s38
    s_lshr_b32 s39, s39, 1
    s_lshl_b32 s39, s39, 7
    s_add_u32 s41, s41, s39
    v_lshrrev_b32 v18, 3, v1
    v_mul_lo_u32 v18, v18, s38
    v_and_b32 v2, 7, v1
    v_lshl_add_u32 v18, v2, 4, v18
    s_lshl_b32 s42, s38, 3
    v_and_b32 v2, 15, v1
    v_and_b32 v7, 1, v1
    v_lshlrev_b32 v7, 4, v7
    v_lshlrev_b32 v7, v7, s49
    v_lshrrev_b32 v2, 1, v2
    v_cmp_eq_u32 vcc, 0, v2
    s_nop 1
    v_cndmask_b32 v12, 0, v7, vcc
    v_cmp_eq_u32 vcc, 1, v2
    s_nop 1
    v_cndmask_b32 v13, 0, v7, vcc
    v_cmp_eq_u32 vcc, 2, v2
    s_nop 1
    v_cndmask_b32 v14, 0, v7, vcc
    v_cmp_eq_u32 vcc, 3, v2
    s_nop 1
    v_cndmask_b32 v15, 0, v7, vcc
    v_and_b32 v2, 15, v1
    v_lshlrev_b32 v8, 7, v2
    v_lshrrev_b32 v2, 1, v2
    v_lshrrev_b32 v7, 4, v1
    v_xor_b32 v2, v2, v7
    v_lshl_add_u32 v2, v2, 4, v8
    s_lshl_b32 s38, s32, 12
    s_sub_u32 s39, 28672, s38
    v_add_u32 v8, s38, v2
    v_add_u32 v10, s39, v2
    v_xor_b32 v9, 64, v8
    v_xor_b32 v11, 64, v10
    v_lshrrev_b32 v0, 2, v1
    v_lshlrev_b32 v0, 6, v0
    v_and_b32 v7, 16, v1
    v_lshl_add_u32 v0, v7, 1, v0
    v_and_b32 v7, 3, v1
    v_lshl_add_u32 v0, v7, 3, v0
    s_mul_i32 s40, s33, 6144
    s_add_u32 s40, s40, 98304
    v_add_u32 v16, s40, v0
    v_xor_b32 v17, 32, v16
    v_mov_b32 v20, 0
    v_mov_b32 v21, 0
    v_mov_b32 v22, 0
    v_mov_b32 v23, 0
    s_mov_b32 s47, 0
    s_mov_b32 s50, 32768
    s_mov_b32 s51, 32768
    s_add_u32 s52, s6, 0x3000000
    s_addc_u32 s53, s7, 0
    s_mov_b32 s54, 0x20000
    s_mov_b32 s55, 0x00020000
    s_mov_b32 s56, s4
    s_mov_b32 s57, s5
    s_mov_b32 s58, 0x100
    s_mov_b32 s59, 0x00020000
    s_waitcnt vmcnt(4)
    v_lshlrev_b32 v168, 16, v160
    v_and_b32 v169, 0xffff0000, v160
    v_lshlrev_b32 v170, 16, v161
    v_and_b32 v171, 0xffff0000, v161
    v_lshlrev_b32 v172, 16, v162
    v_and_b32 v173, 0xffff0000, v162
    v_lshlrev_b32 v174, 16, v163
    v_and_b32 v175, 0xffff0000, v163
    v_lshlrev_b32 v176, 16, v164
    v_and_b32 v177, 0xffff0000, v164
    v_lshlrev_b32 v178, 16, v165
    v_and_b32 v179, 0xffff0000, v165
    v_lshlrev_b32 v180, 16, v166
    v_and_b32 v181, 0xffff0000, v166
    v_lshlrev_b32 v182, 16, v167
    v_and_b32 v183, 0xffff0000, v167
    v_add_f32 v184, v168, v169
    v_add_f32 v185, v170, v171
    v_add_f32 v184, v184, v172
    v_add_f32 v185, v185, v173
    v_add_f32 v184, v184, v174
    v_add_f32 v185, v185, v175
    v_add_f32 v184, v184, v176
    v_add_f32 v185, v185, v177
    v_add_f32 v184, v184, v178
    v_add_f32 v185, v185, v179
    v_add_f32 v184, v184, v180
    v_add_f32 v185, v185, v181
    v_add_f32 v184, v184, v182
    v_add_f32 v185, v185, v183
    v_add_f32 v184, v184, v185
    s_nop 1
    v_add_f32_dpp v184, v184, v184 row_ror:8 row_mask:0xf bank_mask:0xf
    s_nop 1
    v_add_f32_dpp v184, v184, v184 row_ror:4 row_mask:0xf bank_mask:0xf
    s_nop 1
    v_add_f32_dpp v184, v184, v184 row_ror:2 row_mask:0xf bank_mask:0xf
    s_nop 1
    v_add_f32_dpp v184, v184, v184 row_ror:1 row_mask:0xf bank_mask:0xf
    v_mov_b32 v185, v184
    s_nop 1
    v_permlane16_swap_b32 v184, v185
    v_add_f32 v184, v184, v185
    v_mov_b32 v185, v184
    s_nop 1
    v_permlane32_swap_b32 v184, v185
    v_add_f32 v184, v184, v185
    v_mul_f32 v186, 0x3a800000, v184
    v_sub_f32 v168, v168, v186
    v_sub_f32 v169, v169, v186
    v_sub_f32 v170, v170, v186
    v_sub_f32 v171, v171, v186
    v_sub_f32 v172, v172, v186
    v_sub_f32 v173, v173, v186
    v_sub_f32 v174, v174, v186
    v_sub_f32 v175, v175, v186
    v_sub_f32 v176, v176, v186
    v_sub_f32 v177, v177, v186
    v_sub_f32 v178, v178, v186
    v_sub_f32 v179, v179, v186
    v_sub_f32 v180, v180, v186
    v_sub_f32 v181, v181, v186
    v_sub_f32 v182, v182, v186
    v_sub_f32 v183, v183, v186
    v_mul_f32 v184, v168, v168
    v_mul_f32 v185, v169, v169
    v_fmac_f32 v184, v170, v170
    v_fmac_f32 v185, v171, v171
    v_fmac_f32 v184, v172, v172
    v_fmac_f32 v185, v173, v173
    v_fmac_f32 v184, v174, v174
    v_fmac_f32 v185, v175, v175
    v_fmac_f32 v184, v176, v176
    v_fmac_f32 v185, v177, v177
    v_fmac_f32 v184, v178, v178
    v_fmac_f32 v185, v179, v179
    v_fmac_f32 v184, v180, v180
    v_fmac_f32 v185, v181, v181
    v_fmac_f32 v184, v182, v182
    v_fmac_f32 v185, v183, v183
    v_add_f32 v184, v184, v185
    s_nop 1
    v_add_f32_dpp v184, v184, v184 row_ror:8 row_mask:0xf bank_mask:0xf
    s_nop 1
    v_add_f32_dpp v184, v184, v184 row_ror:4 row_mask:0xf bank_mask:0xf
    s_nop 1
    v_add_f32_dpp v184, v184, v184 row_ror:2 row_mask:0xf bank_mask:0xf
    s_nop 1
    v_add_f32_dpp v184, v184, v184 row_ror:1 row_mask:0xf bank_mask:0xf
    v_mov_b32 v185, v184
    s_nop 1
    v_permlane16_swap_b32 v184, v185
    v_add_f32 v184, v184, v185
    v_mov_b32 v185, v184
    s_nop 1
    v_permlane32_swap_b32 v184, v185
    v_add_f32 v184, v184, v185
    v_mul_f32 v187, 0x3a800000, v184
    v_mov_b32 v168, v187
    v_cvt_pk_bf16_f32 v168, v168, v168
    v_lshlrev_b32 v168, 16, v168
    v_add_f32 v168, 0x3727c5ac, v168
    v_cvt_pk_bf16_f32 v168, v168, v168
    v_lshlrev_b32 v168, 16, v168
    v_sqrt_f32 v168, v168
    s_nop 0
    v_cvt_pk_bf16_f32 v168, v168, v168
    v_lshlrev_b32 v168, 16, v168
    v_rcp_f32 v160, v168
    v_mov_b32 v169, v186
    v_cvt_pk_bf16_f32 v169, v169, v169
    v_lshlrev_b32 v169, 16, v169
    v_mul_f32 v161, -v160, v169
    v_sub_f32 v171, v186, v169
    v_mul_f32 v171, v171, v160
    v_cvt_pk_bf16_f32 v171, v171, v171
    v_lshlrev_b32 v171, 16, v171
    v_mul_f32 v187, v187, v160
    v_mul_f32 v187, v187, v160
    v_mov_b32 v170, v187
    v_cvt_pk_bf16_f32 v170, v170, v170
    v_lshlrev_b32 v170, 16, v170
    v_add_f32 v170, 0x3727c5ac, v170
    v_cvt_pk_bf16_f32 v170, v170, v170
    v_lshlrev_b32 v170, 16, v170
    v_sqrt_f32 v170, v170
    s_nop 0
    v_cvt_pk_bf16_f32 v170, v170, v170
    v_lshlrev_b32 v170, 16, v170
    v_rcp_f32 v170, v170
    v_fma_f32 v171, v171, v168, v169
    v_mul_f32 v162, v160, v170
    v_mul_f32 v163, -v162, v171
    v_cmp_eq_u32 vcc, 1, v1
    s_nop 1
    v_cndmask_b32 v160, v160, v161, vcc
    v_cmp_eq_u32 vcc, 2, v1
    s_nop 1
    v_cndmask_b32 v160, v160, v162, vcc
    v_cmp_eq_u32 vcc, 3, v1
    s_nop 1
    v_cndmask_b32 v160, v160, v163, vcc
    v_lshlrev_b32 v2, 13, v1
    s_lshl_b32 s38, s31, 2
    s_add_u32 s39, s38, 32768
    s_lshl_b32 s38, s31, 4
    s_mov_b64 exec, 15
    buffer_store_dword v160, v2, s[52:55], s39 offen sc1
    s_mov_b64 exec, 1
    buffer_store_dwordx4 v[20:23], v20, s[52:55], s38 offen sc1
    s_mov_b64 exec, -1
    s_mov_b32 m0, s46
    s_nop 0
    buffer_load_dwordx4 v3, s[8:11], s36 offen lds
    buffer_load_dwordx4 v4, s[8:11], s36 offen offset:1024 lds
    s_add_u32 s34, s36, 32768
    s_add_u32 m0, s46, 2048
    s_add_u32 s36, s36, 128
    buffer_load_dwordx4 v3, s[8:11], s34 offen lds
    buffer_load_dwordx4 v4, s[8:11], s34 offen offset:1024 lds
    s_add_u32 s46, s46, 32768
    s_cmp_ge_u32 s46, 98304
    s_cselect_b32 s38, 98304, 0
    s_sub_u32 s46, s46, s38
    s_waitcnt vmcnt(6) lgkmcnt(0)
    s_barrier
    ds_read_b128 v[116:119], v8 offset:0
    ds_read_b64_tr_b16 v[132:133], v16 offset:0
    ds_read_b64_tr_b16 v[134:135], v16 offset:1024
    ds_read_b64_tr_b16 v[136:137], v17 offset:0
    ds_read_b64_tr_b16 v[138:139], v17 offset:1024
    ds_read_b64_tr_b16 v[140:141], v16 offset:2048
    ds_read_b64_tr_b16 v[142:143], v16 offset:3072
    ds_read_b64_tr_b16 v[144:145], v17 offset:2048
    ds_read_b64_tr_b16 v[146:147], v17 offset:3072
    ds_read_b64_tr_b16 v[148:149], v16 offset:4096
    ds_read_b64_tr_b16 v[150:151], v16 offset:5120
    ds_read_b64_tr_b16 v[152:153], v17 offset:4096
    ds_read_b64_tr_b16 v[154:155], v17 offset:5120
    ds_read_b128 v[120:123], v8 offset:2048
    ds_read_b128 v[124:127], v10 offset:0
    ds_read_b128 v[128:131], v10 offset:2048
    s_waitcnt vmcnt(6) lgkmcnt(0)
    s_barrier
    v_mfma_f32_16x16x32_bf16 v[20:23], v[132:135], v[116:119], 0
    ds_read_b128 v[156:159], v9 offset:0
    v_mfma_f32_16x16x32_bf16 v[24:27], v[136:139], v[116:119], 0
    ds_read_b64_tr_b16 v[172:173], v16 offset:14336
    v_mfma_f32_16x16x32_bf16 v[28:31], v[140:143], v[116:119], 0
    ds_read_b64_tr_b16 v[174:175], v16 offset:15360
    v_mfma_f32_16x16x32_bf16 v[32:35], v[144:147], v[116:119], 0
    ds_read_b64_tr_b16 v[176:177], v17 offset:14336
    s_mov_b32 m0, s46
    s_nop 0
    buffer_load_dwordx4 v3, s[8:11], s36 offen lds
    v_mfma_f32_16x16x32_bf16 v[36:39], v[116:119], v[148:151], 0
    v_mfma_f32_16x16x32_bf16 v[40:43], v[116:119], v[152:155], 0
    ds_read_b64_tr_b16 v[178:179], v17 offset:15360
    v_mfma_f32_16x16x32_bf16 v[44:47], v[132:135], v[120:123], 0
    ds_read_b64_tr_b16 v[180:181], v16 offset:16384
    v_mfma_f32_16x16x32_bf16 v[48:51], v[136:139], v[120:123], 0
    ds_read_b64_tr_b16 v[182:183], v16 offset:17408
    v_mfma_f32_16x16x32_bf16 v[52:55], v[140:143], v[120:123], 0
    ds_read_b64_tr_b16 v[184:185], v17 offset:16384
    v_mfma_f32_16x16x32_bf16 v[56:59], v[144:147], v[120:123], 0
    buffer_load_dwordx4 v4, s[8:11], s36 offen offset:1024 lds
    s_add_u32 s34, s36, 32768
    v_mfma_f32_16x16x32_bf16 v[60:63], v[120:123], v[148:151], 0
    ds_read_b64_tr_b16 v[186:187], v17 offset:17408
    v_mfma_f32_16x16x32_bf16 v[64:67], v[120:123], v[152:155], 0
    ds_read_b64_tr_b16 v[188:189], v16 offset:18432
    v_mfma_f32_16x16x32_bf16 v[68:71], v[132:135], v[124:127], 0
    ds_read_b64_tr_b16 v[190:191], v16 offset:19456
    v_mfma_f32_16x16x32_bf16 v[72:75], v[136:139], v[124:127], 0
    ds_read_b64_tr_b16 v[192:193], v17 offset:18432
    v_mfma_f32_16x16x32_bf16 v[76:79], v[140:143], v[124:127], 0
    v_mfma_f32_16x16x32_bf16 v[80:83], v[144:147], v[124:127], 0
    ds_read_b64_tr_b16 v[194:195], v17 offset:19456
    s_add_u32 m0, s46, 2048
    s_add_u32 s36, s36, 128
    buffer_load_dwordx4 v3, s[8:11], s34 offen lds
    v_mfma_f32_16x16x32_bf16 v[84:87], v[124:127], v[148:151], 0
    ds_read_b128 v[160:163], v9 offset:2048
    v_mfma_f32_16x16x32_bf16 v[88:91], v[124:127], v[152:155], 0
    ds_read_b128 v[164:167], v11 offset:0
    v_mfma_f32_16x16x32_bf16 v[92:95], v[132:135], v[128:131], 0
    ds_read_b128 v[168:171], v11 offset:2048
    v_mfma_f32_16x16x32_bf16 v[96:99], v[136:139], v[128:131], 0
    v_mfma_f32_16x16x32_bf16 v[100:103], v[140:143], v[128:131], 0
    v_mfma_f32_16x16x32_bf16 v[104:107], v[144:147], v[128:131], 0
    buffer_load_dwordx4 v4, s[8:11], s34 offen offset:1024 lds
    s_add_u32 s46, s46, 32768
    s_cmp_ge_u32 s46, 98304
    s_cselect_b32 s38, 98304, 0
    s_sub_u32 s46, s46, s38
    v_mfma_f32_16x16x32_bf16 v[108:111], v[128:131], v[148:151], 0
    v_add_u32 v8, s50, v8
    v_add_u32 v10, s50, v10
    v_mfma_f32_16x16x32_bf16 v[112:115], v[128:131], v[152:155], 0
    s_waitcnt vmcnt(4) lgkmcnt(0)
    s_barrier
    v_mfma_f32_16x16x32_bf16 v[20:23], v[172:175], v[156:159], v[20:23]
    ds_read_b128 v[116:119], v8 offset:0
    v_mfma_f32_16x16x32_bf16 v[24:27], v[176:179], v[156:159], v[24:27]
    ds_read_b64_tr_b16 v[132:133], v16 offset:28672
    v_mfma_f32_16x16x32_bf16 v[28:31], v[180:183], v[156:159], v[28:31]
    ds_read_b64_tr_b16 v[134:135], v16 offset:29696
    s_mov_b32 m0, s46
    s_nop 0
    buffer_load_dwordx4 v3, s[8:11], s36 offen lds
    v_mfma_f32_16x16x32_bf16 v[32:35], v[184:187], v[156:159], v[32:35]
    ds_read_b64_tr_b16 v[136:137], v17 offset:28672
    v_mfma_f32_16x16x32_bf16 v[36:39], v[156:159], v[188:191], v[36:39]
    v_mfma_f32_16x16x32_bf16 v[40:43], v[156:159], v[192:195], v[40:43]
    ds_read_b64_tr_b16 v[138:139], v17 offset:29696
    v_mfma_f32_16x16x32_bf16 v[44:47], v[172:175], v[160:163], v[44:47]
    ds_read_b64_tr_b16 v[140:141], v16 offset:30720
    buffer_load_dwordx4 v4, s[8:11], s36 offen offset:1024 lds
    s_add_u32 s34, s36, 32768
    v_mfma_f32_16x16x32_bf16 v[48:51], v[176:179], v[160:163], v[48:51]
    ds_read_b64_tr_b16 v[142:143], v16 offset:31744
    v_mfma_f32_16x16x32_bf16 v[52:55], v[180:183], v[160:163], v[52:55]
    ds_read_b64_tr_b16 v[144:145], v17 offset:30720
    v_mfma_f32_16x16x32_bf16 v[56:59], v[184:187], v[160:163], v[56:59]
    v_mfma_f32_16x16x32_bf16 v[60:63], v[160:163], v[188:191], v[60:63]
    ds_read_b64_tr_b16 v[146:147], v17 offset:31744
    buffer_load_dwordx4 v[224:227], v18, s[16:19], s41 offen
    s_add_u32 s41, s41, s42
    v_mfma_f32_16x16x32_bf16 v[64:67], v[160:163], v[192:195], v[64:67]
    ds_read_b64_tr_b16 v[148:149], v16 offset:32768
    v_mfma_f32_16x16x32_bf16 v[68:71], v[172:175], v[164:167], v[68:71]
    ds_read_b64_tr_b16 v[150:151], v16 offset:33792
    v_mfma_f32_16x16x32_bf16 v[72:75], v[176:179], v[164:167], v[72:75]
    ds_read_b64_tr_b16 v[152:153], v17 offset:32768
    v_mfma_f32_16x16x32_bf16 v[76:79], v[180:183], v[164:167], v[76:79]
    buffer_load_dwordx4 v[228:231], v18, s[16:19], s41 offen
    s_add_u32 s41, s41, s42
    v_mfma_f32_16x16x32_bf16 v[80:83], v[184:187], v[164:167], v[80:83]
    ds_read_b64_tr_b16 v[154:155], v17 offset:33792
    v_mfma_f32_16x16x32_bf16 v[84:87], v[164:167], v[188:191], v[84:87]
    ds_read_b128 v[120:123], v8 offset:2048
    v_mfma_f32_16x16x32_bf16 v[88:91], v[164:167], v[192:195], v[88:91]
    ds_read_b128 v[124:127], v10 offset:0
    v_mfma_f32_16x16x32_bf16 v[92:95], v[172:175], v[168:171], v[92:95]
    ds_read_b128 v[128:131], v10 offset:2048
    buffer_load_dwordx4 v[232:235], v18, s[16:19], s41 offen
    s_add_u32 s41, s41, s42
    v_mfma_f32_16x16x32_bf16 v[96:99], v[176:179], v[168:171], v[96:99]
    v_mfma_f32_16x16x32_bf16 v[100:103], v[180:183], v[168:171], v[100:103]
    v_mfma_f32_16x16x32_bf16 v[104:107], v[184:187], v[168:171], v[104:107]
    v_mfma_f32_16x16x32_bf16 v[108:111], v[168:171], v[188:191], v[108:111]
    buffer_load_dwordx4 v[236:239], v18, s[16:19], s41 offen
    s_add_u32 s41, s41, s42
    v_add_u32 v9, s50, v9
    v_add_u32 v11, s50, v11
    s_add_u32 s47, s47, s50
    s_cmp_eq_u32 s47, 65536
    s_cselect_b32 s50, 0xffff0000, s51
    v_mfma_f32_16x16x32_bf16 v[112:115], v[168:171], v[192:195], v[112:115]
    s_waitcnt vmcnt(10) lgkmcnt(0)
    s_barrier
    v_mfma_f32_16x16x32_bf16 v[20:23], v[132:135], v[116:119], v[20:23]
    ds_read_b128 v[156:159], v9 offset:0
    v_mfma_f32_16x16x32_bf16 v[24:27], v[136:139], v[116:119], v[24:27]
    ds_read_b64_tr_b16 v[172:173], v16 offset:43008
    v_mfma_f32_16x16x32_bf16 v[28:31], v[140:143], v[116:119], v[28:31]
    ds_read_b64_tr_b16 v[174:175], v16 offset:44032
    s_add_u32 m0, s46, 2048
    s_add_u32 s36, s36, 128
    buffer_load_dwordx4 v3, s[8:11], s34 offen lds
    v_mfma_f32_16x16x32_bf16 v[32:35], v[144:147], v[116:119], v[32:35]
    ds_read_b64_tr_b16 v[176:177], v17 offset:43008
    v_mfma_f32_16x16x32_bf16 v[36:39], v[116:119], v[148:151], v[36:39]
    v_mfma_f32_16x16x32_bf16 v[40:43], v[116:119], v[152:155], v[40:43]
    ds_read_b64_tr_b16 v[178:179], v17 offset:44032
    v_mfma_f32_16x16x32_bf16 v[44:47], v[132:135], v[120:123], v[44:47]
    ds_read_b64_tr_b16 v[180:181], v16 offset:45056
    buffer_load_dwordx4 v4, s[8:11], s34 offen offset:1024 lds
    s_add_u32 s46, s46, 32768
    s_cmp_ge_u32 s46, 98304
    s_cselect_b32 s38, 98304, 0
    s_sub_u32 s46, s46, s38
    v_mfma_f32_16x16x32_bf16 v[48:51], v[136:139], v[120:123], v[48:51]
    ds_read_b64_tr_b16 v[182:183], v16 offset:46080
    v_mfma_f32_16x16x32_bf16 v[52:55], v[140:143], v[120:123], v[52:55]
    ds_read_b64_tr_b16 v[184:185], v17 offset:45056
    v_mfma_f32_16x16x32_bf16 v[56:59], v[144:147], v[120:123], v[56:59]
    v_mfma_f32_16x16x32_bf16 v[60:63], v[120:123], v[148:151], v[60:63]
    ds_read_b64_tr_b16 v[186:187], v17 offset:46080
    buffer_load_dwordx4 v[240:243], v18, s[16:19], s41 offen
    s_add_u32 s41, s41, s42
    v_mfma_f32_16x16x32_bf16 v[64:67], v[120:123], v[152:155], v[64:67]
    ds_read_b64_tr_b16 v[188:189], v16 offset:47104
    v_mfma_f32_16x16x32_bf16 v[68:71], v[132:135], v[124:127], v[68:71]
    ds_read_b64_tr_b16 v[190:191], v16 offset:48128
    v_mfma_f32_16x16x32_bf16 v[72:75], v[136:139], v[124:127], v[72:75]
    ds_read_b64_tr_b16 v[192:193], v17 offset:47104
    v_mfma_f32_16x16x32_bf16 v[76:79], v[140:143], v[124:127], v[76:79]
    buffer_load_dwordx4 v[244:247], v18, s[16:19], s41 offen
    s_add_u32 s41, s41, s42
    v_mfma_f32_16x16x32_bf16 v[80:83], v[144:147], v[124:127], v[80:83]
    ds_read_b64_tr_b16 v[194:195], v17 offset:48128
    v_mfma_f32_16x16x32_bf16 v[84:87], v[124:127], v[148:151], v[84:87]
    ds_read_b128 v[160:163], v9 offset:2048
    v_mfma_f32_16x16x32_bf16 v[88:91], v[124:127], v[152:155], v[88:91]
    ds_read_b128 v[164:167], v11 offset:0
    v_mfma_f32_16x16x32_bf16 v[92:95], v[132:135], v[128:131], v[92:95]
    ds_read_b128 v[168:171], v11 offset:2048
    buffer_load_dwordx4 v[248:251], v18, s[16:19], s41 offen
    s_add_u32 s41, s41, s42
    v_mfma_f32_16x16x32_bf16 v[96:99], v[136:139], v[128:131], v[96:99]
    v_mfma_f32_16x16x32_bf16 v[100:103], v[140:143], v[128:131], v[100:103]
    v_mfma_f32_16x16x32_bf16 v[104:107], v[144:147], v[128:131], v[104:107]
    v_mfma_f32_16x16x32_bf16 v[108:111], v[128:131], v[148:151], v[108:111]
    buffer_load_dwordx4 v[252:255], v18, s[16:19], s41 offen
    s_add_u32 s41, s41, s42
    v_add_u32 v8, s50, v8
    v_add_u32 v10, s50, v10
    v_mfma_f32_16x16x32_bf16 v[112:115], v[128:131], v[152:155], v[112:115]
    s_waitcnt vmcnt(12) lgkmcnt(0)
    s_barrier
    v_mfma_f32_16x16x32_bf16 v[20:23], v[172:175], v[156:159], v[20:23]
    ds_read_b128 v[116:119], v8 offset:0
    v_mfma_f32_16x16x32_bf16 v[24:27], v[176:179], v[156:159], v[24:27]
    ds_read_b64_tr_b16 v[132:133], v16 offset:0
    v_mfma_f32_16x16x32_bf16 v[28:31], v[180:183], v[156:159], v[28:31]
    ds_read_b64_tr_b16 v[134:135], v16 offset:1024
    v_mfma_f32_16x16x32_bf16 v[32:35], v[184:187], v[156:159], v[32:35]
    ds_read_b64_tr_b16 v[136:137], v17 offset:0
    v_mfma_f32_16x16x32_bf16 v[36:39], v[156:159], v[188:191], v[36:39]
    v_mfma_f32_16x16x32_bf16 v[40:43], v[156:159], v[192:195], v[40:43]
    ds_read_b64_tr_b16 v[138:139], v17 offset:1024
    v_mfma_f32_16x16x32_bf16 v[44:47], v[172:175], v[160:163], v[44:47]
    ds_read_b64_tr_b16 v[140:141], v16 offset:2048
    s_mov_b32 m0, s46
    s_nop 0
    buffer_load_dwordx4 v3, s[8:11], s36 offen lds
    v_mfma_f32_16x16x32_bf16 v[48:51], v[176:179], v[160:163], v[48:51]
    ds_read_b64_tr_b16 v[142:143], v16 offset:3072
    v_mfma_f32_16x16x32_bf16 v[52:55], v[180:183], v[160:163], v[52:55]
    ds_read_b64_tr_b16 v[144:145], v17 offset:2048
    v_mfma_f32_16x16x32_bf16 v[56:59], v[184:187], v[160:163], v[56:59]
    v_mfma_f32_16x16x32_bf16 v[60:63], v[160:163], v[188:191], v[60:63]
    ds_read_b64_tr_b16 v[146:147], v17 offset:3072
    v_mfma_f32_16x16x32_bf16 v[64:67], v[160:163], v[192:195], v[64:67]
    ds_read_b64_tr_b16 v[148:149], v16 offset:4096
    v_mfma_f32_16x16x32_bf16 v[68:71], v[172:175], v[164:167], v[68:71]
    ds_read_b64_tr_b16 v[150:151], v16 offset:5120
    v_mfma_f32_16x16x32_bf16 v[72:75], v[176:179], v[164:167], v[72:75]
    ds_read_b64_tr_b16 v[152:153], v17 offset:4096
    v_mfma_f32_16x16x32_bf16 v[76:79], v[180:183], v[164:167], v[76:79]
    v_mfma_f32_16x16x32_bf16 v[80:83], v[184:187], v[164:167], v[80:83]
    ds_read_b64_tr_b16 v[154:155], v17 offset:5120
    v_mfma_f32_16x16x32_bf16 v[84:87], v[164:167], v[188:191], v[84:87]
    ds_read_b128 v[120:123], v8 offset:2048
    v_mfma_f32_16x16x32_bf16 v[88:91], v[164:167], v[192:195], v[88:91]
    ds_read_b128 v[124:127], v10 offset:0
    v_mfma_f32_16x16x32_bf16 v[92:95], v[172:175], v[168:171], v[92:95]
    ds_read_b128 v[128:131], v10 offset:2048
    buffer_load_dwordx4 v4, s[8:11], s36 offen offset:1024 lds
    s_add_u32 s34, s36, 32768
    v_mfma_f32_16x16x32_bf16 v[96:99], v[176:179], v[168:171], v[96:99]
    v_mfma_f32_16x16x32_bf16 v[100:103], v[180:183], v[168:171], v[100:103]
    v_mfma_f32_16x16x32_bf16 v[104:107], v[184:187], v[168:171], v[104:107]
    v_mfma_f32_16x16x32_bf16 v[108:111], v[168:171], v[188:191], v[108:111]
    v_add_u32 v9, s50, v9
    v_add_u32 v11, s50, v11
    s_add_u32 s47, s47, s50
    s_cmp_eq_u32 s47, 65536
    s_cselect_b32 s50, 0xffff0000, s51
    v_mfma_f32_16x16x32_bf16 v[112:115], v[168:171], v[192:195], v[112:115]
    s_waitcnt vmcnt(14) lgkmcnt(0)
    s_barrier
    v_mfma_f32_16x16x32_bf16 v[20:23], v[132:135], v[116:119], v[20:23]
    ds_read_b128 v[156:159], v9 offset:0
    v_mfma_f32_16x16x32_bf16 v[24:27], v[136:139], v[116:119], v[24:27]
    ds_read_b64_tr_b16 v[172:173], v16 offset:14336
    v_mfma_f32_16x16x32_bf16 v[28:31], v[140:143], v[116:119], v[28:31]
    ds_read_b64_tr_b16 v[174:175], v16 offset:15360
    v_mfma_f32_16x16x32_bf16 v[32:35], v[144:147], v[116:119], v[32:35]
    ds_read_b64_tr_b16 v[176:177], v17 offset:14336
    v_mfma_f32_16x16x32_bf16 v[36:39], v[116:119], v[148:151], v[36:39]
    v_mfma_f32_16x16x32_bf16 v[40:43], v[116:119], v[152:155], v[40:43]
    ds_read_b64_tr_b16 v[178:179], v17 offset:15360
    v_mfma_f32_16x16x32_bf16 v[44:47], v[132:135], v[120:123], v[44:47]
    ds_read_b64_tr_b16 v[180:181], v16 offset:16384
    s_add_u32 m0, s46, 2048
    s_add_u32 s36, s36, 128
    buffer_load_dwordx4 v3, s[8:11], s34 offen lds
    v_mfma_f32_16x16x32_bf16 v[48:51], v[136:139], v[120:123], v[48:51]
    ds_read_b64_tr_b16 v[182:183], v16 offset:17408
    v_mfma_f32_16x16x32_bf16 v[52:55], v[140:143], v[120:123], v[52:55]
    ds_read_b64_tr_b16 v[184:185], v17 offset:16384
    v_mfma_f32_16x16x32_bf16 v[56:59], v[144:147], v[120:123], v[56:59]
    v_mfma_f32_16x16x32_bf16 v[60:63], v[120:123], v[148:151], v[60:63]
    ds_read_b64_tr_b16 v[186:187], v17 offset:17408
    v_mfma_f32_16x16x32_bf16 v[64:67], v[120:123], v[152:155], v[64:67]
    ds_read_b64_tr_b16 v[188:189], v16 offset:18432
    v_mfma_f32_16x16x32_bf16 v[68:71], v[132:135], v[124:127], v[68:71]
    ds_read_b64_tr_b16 v[190:191], v16 offset:19456
    v_mfma_f32_16x16x32_bf16 v[72:75], v[136:139], v[124:127], v[72:75]
    ds_read_b64_tr_b16 v[192:193], v17 offset:18432
    v_mfma_f32_16x16x32_bf16 v[76:79], v[140:143], v[124:127], v[76:79]
    v_mfma_f32_16x16x32_bf16 v[80:83], v[144:147], v[124:127], v[80:83]
    ds_read_b64_tr_b16 v[194:195], v17 offset:19456
    v_mfma_f32_16x16x32_bf16 v[84:87], v[124:127], v[148:151], v[84:87]
    ds_read_b128 v[160:163], v9 offset:2048
    v_mfma_f32_16x16x32_bf16 v[88:91], v[124:127], v[152:155], v[88:91]
    ds_read_b128 v[164:167], v11 offset:0
    v_mfma_f32_16x16x32_bf16 v[92:95], v[132:135], v[128:131], v[92:95]
    ds_read_b128 v[168:171], v11 offset:2048
    buffer_load_dwordx4 v4, s[8:11], s34 offen offset:1024 lds
    s_add_u32 s46, s46, 32768
    s_cmp_ge_u32 s46, 98304
    s_cselect_b32 s38, 98304, 0
    s_sub_u32 s46, s46, s38
    v_mfma_f32_16x16x32_bf16 v[96:99], v[136:139], v[128:131], v[96:99]
    v_mfma_f32_16x16x32_bf16 v[100:103], v[140:143], v[128:131], v[100:103]
    v_mfma_f32_16x16x32_bf16 v[104:107], v[144:147], v[128:131], v[104:107]
    v_mfma_f32_16x16x32_bf16 v[108:111], v[128:131], v[148:151], v[108:111]
    v_add_u32 v8, s50, v8
    v_add_u32 v10, s50, v10
    v_mfma_f32_16x16x32_bf16 v[112:115], v[128:131], v[152:155], v[112:115]
    s_waitcnt vmcnt(8) lgkmcnt(0)
    s_barrier
    v_mfma_f32_16x16x32_bf16 v[20:23], v[172:175], v[156:159], v[20:23]
    ds_read_b128 v[116:119], v8 offset:0
    v_mfma_f32_16x16x32_bf16 v[24:27], v[176:179], v[156:159], v[24:27]
    ds_read_b64_tr_b16 v[132:133], v16 offset:28672
    v_mfma_f32_16x16x32_bf16 v[28:31], v[180:183], v[156:159], v[28:31]
    ds_read_b64_tr_b16 v[134:135], v16 offset:29696
    v_mfma_f32_16x16x32_bf16 v[32:35], v[184:187], v[156:159], v[32:35]
    ds_read_b64_tr_b16 v[136:137], v17 offset:28672
    v_mfma_f32_16x16x32_bf16 v[36:39], v[156:159], v[188:191], v[36:39]
    v_mfma_f32_16x16x32_bf16 v[40:43], v[156:159], v[192:195], v[40:43]
    ds_read_b64_tr_b16 v[138:139], v17 offset:29696
    v_mfma_f32_16x16x32_bf16 v[44:47], v[172:175], v[160:163], v[44:47]
    ds_read_b64_tr_b16 v[140:141], v16 offset:30720
    s_mov_b32 m0, s46
    s_nop 0
    buffer_load_dwordx4 v3, s[8:11], s36 offen lds
    v_mfma_f32_16x16x32_bf16 v[48:51], v[176:179], v[160:163], v[48:51]
    ds_read_b64_tr_b16 v[142:143], v16 offset:31744
    v_mfma_f32_16x16x32_bf16 v[52:55], v[180:183], v[160:163], v[52:55]
    ds_read_b64_tr_b16 v[144:145], v17 offset:30720
    v_mfma_f32_16x16x32_bf16 v[56:59], v[184:187], v[160:163], v[56:59]
    v_mfma_f32_16x16x32_bf16 v[60:63], v[160:163], v[188:191], v[60:63]
    ds_read_b64_tr_b16 v[146:147], v17 offset:31744
    v_mfma_f32_16x16x32_bf16 v[64:67], v[160:163], v[192:195], v[64:67]
    ds_read_b64_tr_b16 v[148:149], v16 offset:32768
    v_mfma_f32_16x16x32_bf16 v[68:71], v[172:175], v[164:167], v[68:71]
    ds_read_b64_tr_b16 v[150:151], v16 offset:33792
    v_mfma_f32_16x16x32_bf16 v[72:75], v[176:179], v[164:167], v[72:75]
    ds_read_b64_tr_b16 v[152:153], v17 offset:32768
    v_mfma_f32_16x16x32_bf16 v[76:79], v[180:183], v[164:167], v[76:79]
    v_mfma_f32_16x16x32_bf16 v[80:83], v[184:187], v[164:167], v[80:83]
    ds_read_b64_tr_b16 v[154:155], v17 offset:33792
    v_mfma_f32_16x16x32_bf16 v[84:87], v[164:167], v[188:191], v[84:87]
    ds_read_b128 v[120:123], v8 offset:2048
    v_mfma_f32_16x16x32_bf16 v[88:91], v[164:167], v[192:195], v[88:91]
    ds_read_b128 v[124:127], v10 offset:0
    v_mfma_f32_16x16x32_bf16 v[92:95], v[172:175], v[168:171], v[92:95]
    ds_read_b128 v[128:131], v10 offset:2048
    buffer_load_dwordx4 v4, s[8:11], s36 offen offset:1024 lds
    s_add_u32 s34, s36, 32768
    v_mfma_f32_16x16x32_bf16 v[96:99], v[176:179], v[168:171], v[96:99]
    v_mfma_f32_16x16x32_bf16 v[100:103], v[180:183], v[168:171], v[100:103]
    v_mfma_f32_16x16x32_bf16 v[104:107], v[184:187], v[168:171], v[104:107]
    v_mfma_f32_16x16x32_bf16 v[108:111], v[168:171], v[188:191], v[108:111]
    v_add_u32 v9, s50, v9
    v_add_u32 v11, s50, v11
    s_add_u32 s47, s47, s50
    s_cmp_eq_u32 s47, 65536
    s_cselect_b32 s50, 0xffff0000, s51
    v_mfma_f32_16x16x32_bf16 v[112:115], v[168:171], v[192:195], v[112:115]
    s_waitcnt vmcnt(6) lgkmcnt(0)
    s_barrier
    v_mfma_f32_16x16x32_bf16 v[220:223], v[12:15], v[224:227], 0
    v_mfma_f32_16x16x32_bf16 v[220:223], v[12:15], v[228:231], v[220:223]
    v_mfma_f32_16x16x32_bf16 v[220:223], v[12:15], v[232:235], v[220:223]
    v_mfma_f32_16x16x32_bf16 v[220:223], v[12:15], v[236:239], v[220:223]
    v_mfma_f32_16x16x32_bf16 v[220:223], v[12:15], v[240:243], v[220:223]
    v_mfma_f32_16x16x32_bf16 v[220:223], v[12:15], v[244:247], v[220:223]
    v_mfma_f32_16x16x32_bf16 v[220:223], v[12:15], v[248:251], v[220:223]
    v_mfma_f32_16x16x32_bf16 v[220:223], v[12:15], v[252:255], v[220:223]
    s_lshl_b32 s38, s28, 10
    s_add_u32 s38, s38, 155648
    v_add_u32 v2, s38, v19
    v_mfma_f32_16x16x32_bf16 v[20:23], v[132:135], v[116:119], v[20:23]
    ds_read_b128 v[156:159], v9 offset:0
    v_mfma_f32_16x16x32_bf16 v[24:27], v[136:139], v[116:119], v[24:27]
    ds_read_b64_tr_b16 v[172:173], v16 offset:43008
    v_mfma_f32_16x16x32_bf16 v[28:31], v[140:143], v[116:119], v[28:31]
    ds_read_b64_tr_b16 v[174:175], v16 offset:44032
    v_mfma_f32_16x16x32_bf16 v[32:35], v[144:147], v[116:119], v[32:35]
    ds_read_b64_tr_b16 v[176:177], v17 offset:43008
    v_mfma_f32_16x16x32_bf16 v[36:39], v[116:119], v[148:151], v[36:39]
    v_mfma_f32_16x16x32_bf16 v[40:43], v[116:119], v[152:155], v[40:43]
    ds_read_b64_tr_b16 v[178:179], v17 offset:44032
    v_mfma_f32_16x16x32_bf16 v[44:47], v[132:135], v[120:123], v[44:47]
    ds_read_b64_tr_b16 v[180:181], v16 offset:45056
    s_add_u32 m0, s46, 2048
    s_add_u32 s36, s36, 128
    buffer_load_dwordx4 v3, s[8:11], s34 offen lds
    v_mfma_f32_16x16x32_bf16 v[48:51], v[136:139], v[120:123], v[48:51]
    ds_read_b64_tr_b16 v[182:183], v16 offset:46080
    v_mfma_f32_16x16x32_bf16 v[52:55], v[140:143], v[120:123], v[52:55]
    ds_read_b64_tr_b16 v[184:185], v17 offset:45056
    v_mfma_f32_16x16x32_bf16 v[56:59], v[144:147], v[120:123], v[56:59]
    v_mfma_f32_16x16x32_bf16 v[60:63], v[120:123], v[148:151], v[60:63]
    ds_read_b64_tr_b16 v[186:187], v17 offset:46080
    v_mfma_f32_16x16x32_bf16 v[64:67], v[120:123], v[152:155], v[64:67]
    ds_read_b64_tr_b16 v[188:189], v16 offset:47104
    v_mfma_f32_16x16x32_bf16 v[68:71], v[132:135], v[124:127], v[68:71]
    ds_read_b64_tr_b16 v[190:191], v16 offset:48128
    v_mfma_f32_16x16x32_bf16 v[72:75], v[136:139], v[124:127], v[72:75]
    ds_read_b64_tr_b16 v[192:193], v17 offset:47104
    v_mfma_f32_16x16x32_bf16 v[76:79], v[140:143], v[124:127], v[76:79]
    v_mfma_f32_16x16x32_bf16 v[80:83], v[144:147], v[124:127], v[80:83]
    ds_read_b64_tr_b16 v[194:195], v17 offset:48128
    v_mfma_f32_16x16x32_bf16 v[84:87], v[124:127], v[148:151], v[84:87]
    ds_read_b128 v[160:163], v9 offset:2048
    v_mfma_f32_16x16x32_bf16 v[88:91], v[124:127], v[152:155], v[88:91]
    ds_read_b128 v[164:167], v11 offset:0
    v_mfma_f32_16x16x32_bf16 v[92:95], v[132:135], v[128:131], v[92:95]
    ds_read_b128 v[168:171], v11 offset:2048
    buffer_load_dwordx4 v4, s[8:11], s34 offen offset:1024 lds
    s_add_u32 s46, s46, 32768
    s_cmp_ge_u32 s46, 98304
    s_cselect_b32 s38, 98304, 0
    s_sub_u32 s46, s46, s38
    v_mfma_f32_16x16x32_bf16 v[96:99], v[136:139], v[128:131], v[96:99]
    v_mfma_f32_16x16x32_bf16 v[100:103], v[140:143], v[128:131], v[100:103]
    v_mfma_f32_16x16x32_bf16 v[104:107], v[144:147], v[128:131], v[104:107]
    v_mfma_f32_16x16x32_bf16 v[108:111], v[128:131], v[148:151], v[108:111]
    v_add_u32 v8, s50, v8
    v_add_u32 v10, s50, v10
    v_mfma_f32_16x16x32_bf16 v[112:115], v[128:131], v[152:155], v[112:115]
    ds_write_b128 v2, v[220:223]
    s_waitcnt vmcnt(4) lgkmcnt(0)
    s_barrier
    s_cmp_lg_u32 s28, 7
    s_cbranch_scc1 L_csr_2
    v_lshrrev_b32 v2, 3, v1
    v_lshlrev_b32 v2, 4, v2
    v_bfe_u32 v7, v1, 2, 1
    v_lshl_add_u32 v2, v7, 8, v2
    v_and_b32 v7, 3, v1
    v_lshl_add_u32 v2, v7, 2, v2
    v_add_u32 v2, 155648, v2
    ds_read_b32 v224, v2 offset:0
    ds_read_b32 v225, v2 offset:128
    ds_read_b32 v226, v2 offset:1024
    ds_read_b32 v227, v2 offset:1152
    ds_read_b32 v228, v2 offset:2048
    ds_read_b32 v229, v2 offset:2176
    ds_read_b32 v230, v2 offset:3072
    ds_read_b32 v231, v2 offset:3200
    ds_read_b32 v232, v2 offset:4096
    ds_read_b32 v233, v2 offset:4224
    ds_read_b32 v234, v2 offset:5120
    ds_read_b32 v235, v2 offset:5248
    ds_read_b32 v236, v2 offset:6144
    ds_read_b32 v237, v2 offset:6272
    ds_read_b32 v238, v2 offset:7168
    ds_read_b32 v239, v2 offset:7296
    s_lshr_b32 s38, s2, 1
    s_lshl_b32 s38, s38, 8
    s_and_b32 s39, s2, 1
    s_mul_i32 s39, s39, 32768
    s_add_u32 s38, s38, s39
    s_add_u32 s38, s38, 65536
    v_lshlrev_b32 v2, 2, v1
    s_waitcnt lgkmcnt(0)
    v_add_f32 v224, v224, v232
    v_add_f32 v225, v225, v233
    v_add_f32 v226, v226, v234
    v_add_f32 v227, v227, v235
    v_add_f32 v228, v228, v236
    v_add_f32 v229, v229, v237
    v_add_f32 v230, v230, v238
    v_add_f32 v231, v231, v239
    v_add_f32 v224, v224, v228
    v_add_f32 v225, v225, v229
    v_add_f32 v226, v226, v230
    v_add_f32 v227, v227, v231
    v_add_f32 v224, v224, v226
    v_add_f32 v225, v225, v227
    v_add_f32 v224, v224, v225
    buffer_store_dword v224, v2, s[52:55], s38 offen sc1
L_csr_2:
    v_mfma_f32_16x16x32_bf16 v[20:23], v[172:175], v[156:159], v[20:23]
    ds_read_b128 v[116:119], v8 offset:0
    v_mfma_f32_16x16x32_bf16 v[24:27], v[176:179], v[156:159], v[24:27]
    ds_read_b64_tr_b16 v[132:133], v16 offset:0
    v_mfma_f32_16x16x32_bf16 v[28:31], v[180:183], v[156:159], v[28:31]
    ds_read_b64_tr_b16 v[134:135], v16 offset:1024
    v_mfma_f32_16x16x32_bf16 v[32:35], v[184:187], v[156:159], v[32:35]
    ds_read_b64_tr_b16 v[136:137], v17 offset:0
    v_mfma_f32_16x16x32_bf16 v[36:39], v[156:159], v[188:191], v[36:39]
    v_mfma_f32_16x16x32_bf16 v[40:43], v[156:159], v[192:195], v[40:43]
    ds_read_b64_tr_b16 v[138:139], v17 offset:1024
    v_mfma_f32_16x16x32_bf16 v[44:47], v[172:175], v[160:163], v[44:47]
    ds_read_b64_tr_b16 v[140:141], v16 offset:2048
    s_mov_b32 m0, s46
    s_nop 0
    buffer_load_dwordx4 v3, s[8:11], s36 offen lds
    v_mfma_f32_16x16x32_bf16 v[48:51], v[176:179], v[160:163], v[48:51]
    ds_read_b64_tr_b16 v[142:143], v16 offset:3072
    v_mfma_f32_16x16x32_bf16 v[52:55], v[180:183], v[160:163], v[52:55]
    ds_read_b64_tr_b16 v[144:145], v17 offset:2048
    v_mfma_f32_16x16x32_bf16 v[56:59], v[184:187], v[160:163], v[56:59]
    v_mfma_f32_16x16x32_bf16 v[60:63], v[160:163], v[188:191], v[60:63]
    ds_read_b64_tr_b16 v[146:147], v17 offset:3072
    v_mfma_f32_16x16x32_bf16 v[64:67], v[160:163], v[192:195], v[64:67]
    ds_read_b64_tr_b16 v[148:149], v16 offset:4096
    v_mfma_f32_16x16x32_bf16 v[68:71], v[172:175], v[164:167], v[68:71]
    ds_read_b64_tr_b16 v[150:151], v16 offset:5120
    v_mfma_f32_16x16x32_bf16 v[72:75], v[176:179], v[164:167], v[72:75]
    ds_read_b64_tr_b16 v[152:153], v17 offset:4096
    v_mfma_f32_16x16x32_bf16 v[76:79], v[180:183], v[164:167], v[76:79]
    v_mfma_f32_16x16x32_bf16 v[80:83], v[184:187], v[164:167], v[80:83]
    ds_read_b64_tr_b16 v[154:155], v17 offset:5120
    v_mfma_f32_16x16x32_bf16 v[84:87], v[164:167], v[188:191], v[84:87]
    ds_read_b128 v[120:123], v8 offset:2048
    v_mfma_f32_16x16x32_bf16 v[88:91], v[164:167], v[192:195], v[88:91]
    ds_read_b128 v[124:127], v10 offset:0
    v_mfma_f32_16x16x32_bf16 v[92:95], v[172:175], v[168:171], v[92:95]
    ds_read_b128 v[128:131], v10 offset:2048
    buffer_load_dwordx4 v4, s[8:11], s36 offen offset:1024 lds
    s_add_u32 s34, s36, 32768
    v_mfma_f32_16x16x32_bf16 v[96:99], v[176:179], v[168:171], v[96:99]
    v_mfma_f32_16x16x32_bf16 v[100:103], v[180:183], v[168:171], v[100:103]
    v_mfma_f32_16x16x32_bf16 v[104:107], v[184:187], v[168:171], v[104:107]
    v_mfma_f32_16x16x32_bf16 v[108:111], v[168:171], v[188:191], v[108:111]
    v_add_u32 v9, s50, v9
    v_add_u32 v11, s50, v11
    s_add_u32 s47, s47, s50
    s_cmp_eq_u32 s47, 65536
    s_cselect_b32 s50, 0xffff0000, s51
    v_mfma_f32_16x16x32_bf16 v[112:115], v[168:171], v[192:195], v[112:115]
    s_mov_b32 s44, 5
L_k1loop_3:
    s_waitcnt vmcnt(4) lgkmcnt(0)
    s_barrier
    v_mfma_f32_16x16x32_bf16 v[20:23], v[132:135], v[116:119], v[20:23]
    ds_read_b128 v[156:159], v9 offset:0
    v_mfma_f32_16x16x32_bf16 v[24:27], v[136:139], v[116:119], v[24:27]
    ds_read_b64_tr_b16 v[172:173], v16 offset:14336
    v_mfma_f32_16x16x32_bf16 v[28:31], v[140:143], v[116:119], v[28:31]
    ds_read_b64_tr_b16 v[174:175], v16 offset:15360
    v_mfma_f32_16x16x32_bf16 v[32:35], v[144:147], v[116:119], v[32:35]
    ds_read_b64_tr_b16 v[176:177], v17 offset:14336
    v_mfma_f32_16x16x32_bf16 v[36:39], v[116:119], v[148:151], v[36:39]
    v_mfma_f32_16x16x32_bf16 v[40:43], v[116:119], v[152:155], v[40:43]
    ds_read_b64_tr_b16 v[178:179], v17 offset:15360
    v_mfma_f32_16x16x32_bf16 v[44:47], v[132:135], v[120:123], v[44:47]
    ds_read_b64_tr_b16 v[180:181], v16 offset:16384
    s_add_u32 m0, s46, 2048
    s_add_u32 s36, s36, 128
    buffer_load_dwordx4 v3, s[8:11], s34 offen lds
    v_mfma_f32_16x16x32_bf16 v[48:51], v[136:139], v[120:123], v[48:51]
    ds_read_b64_tr_b16 v[182:183], v16 offset:17408
    v_mfma_f32_16x16x32_bf16 v[52:55], v[140:143], v[120:123], v[52:55]
    ds_read_b64_tr_b16 v[184:185], v17 offset:16384
    v_mfma_f32_16x16x32_bf16 v[56:59], v[144:147], v[120:123], v[56:59]
    v_mfma_f32_16x16x32_bf16 v[60:63], v[120:123], v[148:151], v[60:63]
    ds_read_b64_tr_b16 v[186:187], v17 offset:17408
    v_mfma_f32_16x16x32_bf16 v[64:67], v[120:123], v[152:155], v[64:67]
    ds_read_b64_tr_b16 v[188:189], v16 offset:18432
    v_mfma_f32_16x16x32_bf16 v[68:71], v[132:135], v[124:127], v[68:71]
    ds_read_b64_tr_b16 v[190:191], v16 offset:19456
    v_mfma_f32_16x16x32_bf16 v[72:75], v[136:139], v[124:127], v[72:75]
    ds_read_b64_tr_b16 v[192:193], v17 offset:18432
    v_mfma_f32_16x16x32_bf16 v[76:79], v[140:143], v[124:127], v[76:79]
    v_mfma_f32_16x16x32_bf16 v[80:83], v[144:147], v[124:127], v[80:83]
    ds_read_b64_tr_b16 v[194:195], v17 offset:19456
    v_mfma_f32_16x16x32_bf16 v[84:87], v[124:127], v[148:151], v[84:87]
    ds_read_b128 v[160:163], v9 offset:2048
    v_mfma_f32_16x16x32_bf16 v[88:91], v[124:127], v[152:155], v[88:91]
    ds_read_b128 v[164:167], v11 offset:0
    v_mfma_f32_16x16x32_bf16 v[92:95], v[132:135], v[128:131], v[92:95]
    ds_read_b128 v[168:171], v11 offset:2048
    buffer_load_dwordx4 v4, s[8:11], s34 offen offset:1024 lds
    s_add_u32 s46, s46, 32768
    s_cmp_ge_u32 s46, 98304
    s_cselect_b32 s38, 98304, 0
    s_sub_u32 s46, s46, s38
    v_mfma_f32_16x16x32_bf16 v[96:99], v[136:139], v[128:131], v[96:99]
    v_mfma_f32_16x16x32_bf16 v[100:103], v[140:143], v[128:131], v[100:103]
    v_mfma_f32_16x16x32_bf16 v[104:107], v[144:147], v[128:131], v[104:107]
    v_mfma_f32_16x16x32_bf16 v[108:111], v[128:131], v[148:151], v[108:111]
    v_add_u32 v8, s50, v8
    v_add_u32 v10, s50, v10
    v_mfma_f32_16x16x32_bf16 v[112:115], v[128:131], v[152:155], v[112:115]
    s_waitcnt vmcnt(4) lgkmcnt(0)
    s_barrier
    v_mfma_f32_16x16x32_bf16 v[20:23], v[172:175], v[156:159], v[20:23]
    ds_read_b128 v[116:119], v8 offset:0
    v_mfma_f32_16x16x32_bf16 v[24:27], v[176:179], v[156:159], v[24:27]
    ds_read_b64_tr_b16 v[132:133], v16 offset:28672
    v_mfma_f32_16x16x32_bf16 v[28:31], v[180:183], v[156:159], v[28:31]
    ds_read_b64_tr_b16 v[134:135], v16 offset:29696
    v_mfma_f32_16x16x32_bf16 v[32:35], v[184:187], v[156:159], v[32:35]
    ds_read_b64_tr_b16 v[136:137], v17 offset:28672
    v_mfma_f32_16x16x32_bf16 v[36:39], v[156:159], v[188:191], v[36:39]
    v_mfma_f32_16x16x32_bf16 v[40:43], v[156:159], v[192:195], v[40:43]
    ds_read_b64_tr_b16 v[138:139], v17 offset:29696
    v_mfma_f32_16x16x32_bf16 v[44:47], v[172:175], v[160:163], v[44:47]
    ds_read_b64_tr_b16 v[140:141], v16 offset:30720
    s_mov_b32 m0, s46
    s_nop 0
    buffer_load_dwordx4 v3, s[8:11], s36 offen lds
    v_mfma_f32_16x16x32_bf16 v[48:51], v[176:179], v[160:163], v[48:51]
    ds_read_b64_tr_b16 v[142:143], v16 offset:31744
    v_mfma_f32_16x16x32_bf16 v[52:55], v[180:183], v[160:163], v[52:55]
    ds_read_b64_tr_b16 v[144:145], v17 offset:30720
    v_mfma_f32_16x16x32_bf16 v[56:59], v[184:187], v[160:163], v[56:59]
    v_mfma_f32_16x16x32_bf16 v[60:63], v[160:163], v[188:191], v[60:63]
    ds_read_b64_tr_b16 v[146:147], v17 offset:31744
    v_mfma_f32_16x16x32_bf16 v[64:67], v[160:163], v[192:195], v[64:67]
    ds_read_b64_tr_b16 v[148:149], v16 offset:32768
    v_mfma_f32_16x16x32_bf16 v[68:71], v[172:175], v[164:167], v[68:71]
    ds_read_b64_tr_b16 v[150:151], v16 offset:33792
    v_mfma_f32_16x16x32_bf16 v[72:75], v[176:179], v[164:167], v[72:75]
    ds_read_b64_tr_b16 v[152:153], v17 offset:32768
    v_mfma_f32_16x16x32_bf16 v[76:79], v[180:183], v[164:167], v[76:79]
    v_mfma_f32_16x16x32_bf16 v[80:83], v[184:187], v[164:167], v[80:83]
    ds_read_b64_tr_b16 v[154:155], v17 offset:33792
    v_mfma_f32_16x16x32_bf16 v[84:87], v[164:167], v[188:191], v[84:87]
    ds_read_b128 v[120:123], v8 offset:2048
    v_mfma_f32_16x16x32_bf16 v[88:91], v[164:167], v[192:195], v[88:91]
    ds_read_b128 v[124:127], v10 offset:0
    v_mfma_f32_16x16x32_bf16 v[92:95], v[172:175], v[168:171], v[92:95]
    ds_read_b128 v[128:131], v10 offset:2048
    buffer_load_dwordx4 v4, s[8:11], s36 offen offset:1024 lds
    s_add_u32 s34, s36, 32768
    v_mfma_f32_16x16x32_bf16 v[96:99], v[176:179], v[168:171], v[96:99]
    v_mfma_f32_16x16x32_bf16 v[100:103], v[180:183], v[168:171], v[100:103]
    v_mfma_f32_16x16x32_bf16 v[104:107], v[184:187], v[168:171], v[104:107]
    v_mfma_f32_16x16x32_bf16 v[108:111], v[168:171], v[188:191], v[108:111]
    v_add_u32 v9, s50, v9
    v_add_u32 v11, s50, v11
    s_add_u32 s47, s47, s50
    s_cmp_eq_u32 s47, 65536
    s_cselect_b32 s50, 0xffff0000, s51
    v_mfma_f32_16x16x32_bf16 v[112:115], v[168:171], v[192:195], v[112:115]
    s_waitcnt vmcnt(4) lgkmcnt(0)
    s_barrier
    v_mfma_f32_16x16x32_bf16 v[20:23], v[132:135], v[116:119], v[20:23]
    ds_read_b128 v[156:159], v9 offset:0
    v_mfma_f32_16x16x32_bf16 v[24:27], v[136:139], v[116:119], v[24:27]
    ds_read_b64_tr_b16 v[172:173], v16 offset:43008
    v_mfma_f32_16x16x32_bf16 v[28:31], v[140:143], v[116:119], v[28:31]
    ds_read_b64_tr_b16 v[174:175], v16 offset:44032
    v_mfma_f32_16x16x32_bf16 v[32:35], v[144:147], v[116:119], v[32:35]
    ds_read_b64_tr_b16 v[176:177], v17 offset:43008
    v_mfma_f32_16x16x32_bf16 v[36:39], v[116:119], v[148:151], v[36:39]
    v_mfma_f32_16x16x32_bf16 v[40:43], v[116:119], v[152:155], v[40:43]
    ds_read_b64_tr_b16 v[178:179], v17 offset:44032
    v_mfma_f32_16x16x32_bf16 v[44:47], v[132:135], v[120:123], v[44:47]
    ds_read_b64_tr_b16 v[180:181], v16 offset:45056
    s_add_u32 m0, s46, 2048
    s_add_u32 s36, s36, 128
    buffer_load_dwordx4 v3, s[8:11], s34 offen lds
    v_mfma_f32_16x16x32_bf16 v[48:51], v[136:139], v[120:123], v[48:51]
    ds_read_b64_tr_b16 v[182:183], v16 offset:46080
    v_mfma_f32_16x16x32_bf16 v[52:55], v[140:143], v[120:123], v[52:55]
    ds_read_b64_tr_b16 v[184:185], v17 offset:45056
    v_mfma_f32_16x16x32_bf16 v[56:59], v[144:147], v[120:123], v[56:59]
    v_mfma_f32_16x16x32_bf16 v[60:63], v[120:123], v[148:151], v[60:63]
    ds_read_b64_tr_b16 v[186:187], v17 offset:46080
    v_mfma_f32_16x16x32_bf16 v[64:67], v[120:123], v[152:155], v[64:67]
    ds_read_b64_tr_b16 v[188:189], v16 offset:47104
    v_mfma_f32_16x16x32_bf16 v[68:71], v[132:135], v[124:127], v[68:71]
    ds_read_b64_tr_b16 v[190:191], v16 offset:48128
    v_mfma_f32_16x16x32_bf16 v[72:75], v[136:139], v[124:127], v[72:75]
    ds_read_b64_tr_b16 v[192:193], v17 offset:47104
    v_mfma_f32_16x16x32_bf16 v[76:79], v[140:143], v[124:127], v[76:79]
    v_mfma_f32_16x16x32_bf16 v[80:83], v[144:147], v[124:127], v[80:83]
    ds_read_b64_tr_b16 v[194:195], v17 offset:48128
    v_mfma_f32_16x16x32_bf16 v[84:87], v[124:127], v[148:151], v[84:87]
    ds_read_b128 v[160:163], v9 offset:2048
    v_mfma_f32_16x16x32_bf16 v[88:91], v[124:127], v[152:155], v[88:91]
    ds_read_b128 v[164:167], v11 offset:0
    v_mfma_f32_16x16x32_bf16 v[92:95], v[132:135], v[128:131], v[92:95]
    ds_read_b128 v[168:171], v11 offset:2048
    buffer_load_dwordx4 v4, s[8:11], s34 offen offset:1024 lds
    s_add_u32 s46, s46, 32768
    s_cmp_ge_u32 s46, 98304
    s_cselect_b32 s38, 98304, 0
    s_sub_u32 s46, s46, s38
    v_mfma_f32_16x16x32_bf16 v[96:99], v[136:139], v[128:131], v[96:99]
    v_mfma_f32_16x16x32_bf16 v[100:103], v[140:143], v[128:131], v[100:103]
    v_mfma_f32_16x16x32_bf16 v[104:107], v[144:147], v[128:131], v[104:107]
    v_mfma_f32_16x16x32_bf16 v[108:111], v[128:131], v[148:151], v[108:111]
    v_add_u32 v8, s50, v8
    v_add_u32 v10, s50, v10
    v_mfma_f32_16x16x32_bf16 v[112:115], v[128:131], v[152:155], v[112:115]
    s_waitcnt vmcnt(4) lgkmcnt(0)
    s_barrier
    v_mfma_f32_16x16x32_bf16 v[20:23], v[172:175], v[156:159], v[20:23]
    ds_read_b128 v[116:119], v8 offset:0
    v_mfma_f32_16x16x32_bf16 v[24:27], v[176:179], v[156:159], v[24:27]
    ds_read_b64_tr_b16 v[132:133], v16 offset:0
    v_mfma_f32_16x16x32_bf16 v[28:31], v[180:183], v[156:159], v[28:31]
    ds_read_b64_tr_b16 v[134:135], v16 offset:1024
    v_mfma_f32_16x16x32_bf16 v[32:35], v[184:187], v[156:159], v[32:35]
    ds_read_b64_tr_b16 v[136:137], v17 offset:0
    v_mfma_f32_16x16x32_bf16 v[36:39], v[156:159], v[188:191], v[36:39]
    v_mfma_f32_16x16x32_bf16 v[40:43], v[156:159], v[192:195], v[40:43]
    ds_read_b64_tr_b16 v[138:139], v17 offset:1024
    v_mfma_f32_16x16x32_bf16 v[44:47], v[172:175], v[160:163], v[44:47]
    ds_read_b64_tr_b16 v[140:141], v16 offset:2048
    s_mov_b32 m0, s46
    s_nop 0
    buffer_load_dwordx4 v3, s[8:11], s36 offen lds
    v_mfma_f32_16x16x32_bf16 v[48:51], v[176:179], v[160:163], v[48:51]
    ds_read_b64_tr_b16 v[142:143], v16 offset:3072
    v_mfma_f32_16x16x32_bf16 v[52:55], v[180:183], v[160:163], v[52:55]
    ds_read_b64_tr_b16 v[144:145], v17 offset:2048
    v_mfma_f32_16x16x32_bf16 v[56:59], v[184:187], v[160:163], v[56:59]
    v_mfma_f32_16x16x32_bf16 v[60:63], v[160:163], v[188:191], v[60:63]
    ds_read_b64_tr_b16 v[146:147], v17 offset:3072
    v_mfma_f32_16x16x32_bf16 v[64:67], v[160:163], v[192:195], v[64:67]
    ds_read_b64_tr_b16 v[148:149], v16 offset:4096
    v_mfma_f32_16x16x32_bf16 v[68:71], v[172:175], v[164:167], v[68:71]
    ds_read_b64_tr_b16 v[150:151], v16 offset:5120
    v_mfma_f32_16x16x32_bf16 v[72:75], v[176:179], v[164:167], v[72:75]
    ds_read_b64_tr_b16 v[152:153], v17 offset:4096
    v_mfma_f32_16x16x32_bf16 v[76:79], v[180:183], v[164:167], v[76:79]
    v_mfma_f32_16x16x32_bf16 v[80:83], v[184:187], v[164:167], v[80:83]
    ds_read_b64_tr_b16 v[154:155], v17 offset:5120
    v_mfma_f32_16x16x32_bf16 v[84:87], v[164:167], v[188:191], v[84:87]
    ds_read_b128 v[120:123], v8 offset:2048
    v_mfma_f32_16x16x32_bf16 v[88:91], v[164:167], v[192:195], v[88:91]
    ds_read_b128 v[124:127], v10 offset:0
    v_mfma_f32_16x16x32_bf16 v[92:95], v[172:175], v[168:171], v[92:95]
    ds_read_b128 v[128:131], v10 offset:2048
    buffer_load_dwordx4 v4, s[8:11], s36 offen offset:1024 lds
    s_add_u32 s34, s36, 32768
    v_mfma_f32_16x16x32_bf16 v[96:99], v[176:179], v[168:171], v[96:99]
    v_mfma_f32_16x16x32_bf16 v[100:103], v[180:183], v[168:171], v[100:103]
    v_mfma_f32_16x16x32_bf16 v[104:107], v[184:187], v[168:171], v[104:107]
    v_mfma_f32_16x16x32_bf16 v[108:111], v[168:171], v[188:191], v[108:111]
    v_add_u32 v9, s50, v9
    v_add_u32 v11, s50, v11
    s_add_u32 s47, s47, s50
    s_cmp_eq_u32 s47, 65536
    s_cselect_b32 s50, 0xffff0000, s51
    v_mfma_f32_16x16x32_bf16 v[112:115], v[168:171], v[192:195], v[112:115]
    s_lshl_b32 s38, s44, 3
    s_add_u32 s38, s38, s28
    s_cmp_lg_u32 s38, 47
    s_cbranch_scc1 L_sig_4
    v_mov_b32 v12, 1
    v_mov_b32 v13, 0
    s_mov_b64 exec, 1
    buffer_atomic_add v12, v13, s[56:59], 0 offen sc1
    s_mov_b64 exec, -1
L_sig_4:
    s_sub_u32 s44, s44, 1
    s_cmp_lg_u32 s44, 0
    s_cbranch_scc1 L_k1loop_3
    s_waitcnt vmcnt(4) lgkmcnt(0)
    s_barrier
    v_mov_b32 v3, 0
    buffer_load_dword v4, v3, s[56:59], 0 offen sc1
    v_mfma_f32_16x16x32_bf16 v[20:23], v[132:135], v[116:119], v[20:23]
    ds_read_b128 v[156:159], v9 offset:0
    v_mfma_f32_16x16x32_bf16 v[24:27], v[136:139], v[116:119], v[24:27]
    ds_read_b64_tr_b16 v[172:173], v16 offset:14336
    v_mfma_f32_16x16x32_bf16 v[28:31], v[140:143], v[116:119], v[28:31]
    ds_read_b64_tr_b16 v[174:175], v16 offset:15360
    v_mfma_f32_16x16x32_bf16 v[32:35], v[144:147], v[116:119], v[32:35]
    ds_read_b64_tr_b16 v[176:177], v17 offset:14336
    v_mfma_f32_16x16x32_bf16 v[36:39], v[116:119], v[148:151], v[36:39]
    v_mfma_f32_16x16x32_bf16 v[40:43], v[116:119], v[152:155], v[40:43]
    ds_read_b64_tr_b16 v[178:179], v17 offset:15360
    v_mfma_f32_16x16x32_bf16 v[44:47], v[132:135], v[120:123], v[44:47]
    ds_read_b64_tr_b16 v[180:181], v16 offset:16384
    v_mfma_f32_16x16x32_bf16 v[48:51], v[136:139], v[120:123], v[48:51]
    ds_read_b64_tr_b16 v[182:183], v16 offset:17408
    v_mfma_f32_16x16x32_bf16 v[52:55], v[140:143], v[120:123], v[52:55]
    ds_read_b64_tr_b16 v[184:185], v17 offset:16384
    v_mfma_f32_16x16x32_bf16 v[56:59], v[144:147], v[120:123], v[56:59]
    v_mfma_f32_16x16x32_bf16 v[60:63], v[120:123], v[148:151], v[60:63]
    ds_read_b64_tr_b16 v[186:187], v17 offset:17408
    v_mfma_f32_16x16x32_bf16 v[64:67], v[120:123], v[152:155], v[64:67]
    ds_read_b64_tr_b16 v[188:189], v16 offset:18432
    v_mfma_f32_16x16x32_bf16 v[68:71], v[132:135], v[124:127], v[68:71]
    ds_read_b64_tr_b16 v[190:191], v16 offset:19456
    v_mfma_f32_16x16x32_bf16 v[72:75], v[136:139], v[124:127], v[72:75]
    ds_read_b64_tr_b16 v[192:193], v17 offset:18432
    v_mfma_f32_16x16x32_bf16 v[76:79], v[140:143], v[124:127], v[76:79]
    v_mfma_f32_16x16x32_bf16 v[80:83], v[144:147], v[124:127], v[80:83]
    ds_read_b64_tr_b16 v[194:195], v17 offset:19456
    v_mfma_f32_16x16x32_bf16 v[84:87], v[124:127], v[148:151], v[84:87]
    ds_read_b128 v[160:163], v9 offset:2048
    v_mfma_f32_16x16x32_bf16 v[88:91], v[124:127], v[152:155], v[88:91]
    ds_read_b128 v[164:167], v11 offset:0
    v_mfma_f32_16x16x32_bf16 v[92:95], v[132:135], v[128:131], v[92:95]
    ds_read_b128 v[168:171], v11 offset:2048
    v_mfma_f32_16x16x32_bf16 v[96:99], v[136:139], v[128:131], v[96:99]
    v_mfma_f32_16x16x32_bf16 v[100:103], v[140:143], v[128:131], v[100:103]
    v_mfma_f32_16x16x32_bf16 v[104:107], v[144:147], v[128:131], v[104:107]
    v_mfma_f32_16x16x32_bf16 v[108:111], v[128:131], v[148:151], v[108:111]
    v_add_u32 v8, s50, v8
    v_add_u32 v10, s50, v10
    v_mfma_f32_16x16x32_bf16 v[112:115], v[128:131], v[152:155], v[112:115]
    s_waitcnt vmcnt(0) lgkmcnt(0)
    s_barrier
    s_cmp_lg_u32 s28, 7
    s_cbranch_scc1 L_pc_7
L_pa_5:
    v_readfirstlane_b32 s38, v4
    s_cmp_ge_u32 s38, 256
    s_cbranch_scc1 L_pb_6
    buffer_load_dword v4, v3, s[56:59], 0 offen sc1
    s_waitcnt vmcnt(0)
    s_branch L_pa_5
L_pb_6:
    s_lshl_b32 s38, s29, 10
    s_add_u32 s38, s38, 32768
    s_add_u32 s41, s38, 7168
    s_mov_b32 m0, 155648
    v_lshrrev_b32 v2, 4, v1
    v_and_b32 v7, 0xf0, v19
    v_lshl_add_u32 v2, v2, 12, v7
    s_lshl_b32 s39, s30, 8
    s_add_u32 s39, s39, 63488
    s_add_u32 s40, s39, 31744
    buffer_load_dwordx4 v19, s[52:55], s38 offen sc1 lds
    buffer_load_dwordx4 v19, s[52:55], s41 offen offset:1024 sc1 lds
    buffer_load_dwordx4 v2, s[52:55], s39 offen offset:2048 sc1 lds
    buffer_load_dwordx4 v2, s[52:55], s40 offen offset:3072 sc1 lds
L_pc_7:
    v_mfma_f32_16x16x32_bf16 v[20:23], v[172:175], v[156:159], v[20:23]
    ds_read_b128 v[116:119], v8 offset:0
    v_mfma_f32_16x16x32_bf16 v[24:27], v[176:179], v[156:159], v[24:27]
    ds_read_b64_tr_b16 v[132:133], v16 offset:28672
    v_mfma_f32_16x16x32_bf16 v[28:31], v[180:183], v[156:159], v[28:31]
    ds_read_b64_tr_b16 v[134:135], v16 offset:29696
    v_mfma_f32_16x16x32_bf16 v[32:35], v[184:187], v[156:159], v[32:35]
    ds_read_b64_tr_b16 v[136:137], v17 offset:28672
    v_mfma_f32_16x16x32_bf16 v[36:39], v[156:159], v[188:191], v[36:39]
    v_mfma_f32_16x16x32_bf16 v[40:43], v[156:159], v[192:195], v[40:43]
    ds_read_b64_tr_b16 v[138:139], v17 offset:29696
    v_mfma_f32_16x16x32_bf16 v[44:47], v[172:175], v[160:163], v[44:47]
    ds_read_b64_tr_b16 v[140:141], v16 offset:30720
    v_mfma_f32_16x16x32_bf16 v[48:51], v[176:179], v[160:163], v[48:51]
    ds_read_b64_tr_b16 v[142:143], v16 offset:31744
    v_mfma_f32_16x16x32_bf16 v[52:55], v[180:183], v[160:163], v[52:55]
    ds_read_b64_tr_b16 v[144:145], v17 offset:30720
    v_mfma_f32_16x16x32_bf16 v[56:59], v[184:187], v[160:163], v[56:59]
    v_mfma_f32_16x16x32_bf16 v[60:63], v[160:163], v[188:191], v[60:63]
    ds_read_b64_tr_b16 v[146:147], v17 offset:31744
    v_mfma_f32_16x16x32_bf16 v[64:67], v[160:163], v[192:195], v[64:67]
    ds_read_b64_tr_b16 v[148:149], v16 offset:32768
    v_mfma_f32_16x16x32_bf16 v[68:71], v[172:175], v[164:167], v[68:71]
    ds_read_b64_tr_b16 v[150:151], v16 offset:33792
    v_mfma_f32_16x16x32_bf16 v[72:75], v[176:179], v[164:167], v[72:75]
    ds_read_b64_tr_b16 v[152:153], v17 offset:32768
    v_mfma_f32_16x16x32_bf16 v[76:79], v[180:183], v[164:167], v[76:79]
    v_mfma_f32_16x16x32_bf16 v[80:83], v[184:187], v[164:167], v[80:83]
    ds_read_b64_tr_b16 v[154:155], v17 offset:33792
    v_mfma_f32_16x16x32_bf16 v[84:87], v[164:167], v[188:191], v[84:87]
    ds_read_b128 v[120:123], v8 offset:2048
    v_mfma_f32_16x16x32_bf16 v[88:91], v[164:167], v[192:195], v[88:91]
    ds_read_b128 v[124:127], v10 offset:0
    v_mfma_f32_16x16x32_bf16 v[92:95], v[172:175], v[168:171], v[92:95]
    ds_read_b128 v[128:131], v10 offset:2048
    v_mfma_f32_16x16x32_bf16 v[96:99], v[176:179], v[168:171], v[96:99]
    v_mfma_f32_16x16x32_bf16 v[100:103], v[180:183], v[168:171], v[100:103]
    v_mfma_f32_16x16x32_bf16 v[104:107], v[184:187], v[168:171], v[104:107]
    v_mfma_f32_16x16x32_bf16 v[108:111], v[168:171], v[188:191], v[108:111]
    v_add_u32 v9, s50, v9
    v_add_u32 v11, s50, v11
    s_add_u32 s47, s47, s50
    s_cmp_eq_u32 s47, 65536
    s_cselect_b32 s50, 0xffff0000, s51
    v_mfma_f32_16x16x32_bf16 v[112:115], v[168:171], v[192:195], v[112:115]
    s_waitcnt vmcnt(63) lgkmcnt(0)
    s_barrier
    v_lshlrev_b32 v7, 6, v1
    s_lshl_b32 s38, s31, 12
    s_mov_b32 s16, s90
    s_mov_b32 s17, s91
    s_mov_b32 s18, 0x700000
    s_mov_b32 s19, 0x00020000
    buffer_load_dword v3, v7, s[16:19], s38 offen
    s_mov_b32 s16, s92
    s_mov_b32 s17, s93
    s_mov_b32 s18, 0x200000
    s_mov_b32 s19, 0x00020000
    buffer_load_dword v4, v7, s[16:19], s38 offen
    s_lshl_b32 s38, s32, 7
    s_sub_u32 s39, 156544, s38
    s_add_u32 s38, s38, 155648
    v_and_b32 v2, 15, v1
    v_and_b32 v7, 48, v1
    v_lshl_add_u32 v12, v2, 2, s38
    v_lshl_add_u32 v13, v2, 2, s39
    v_add_u32 v14, s38, v7
    v_add_u32 v15, s39, v7
    s_lshl_b32 s38, s33, 7
    s_add_u32 s38, s38, 157696
    v_add_u32 v5, s38, v7
    v_lshl_add_u32 v6, v2, 2, s38
    v_mfma_f32_16x16x32_bf16 v[20:23], v[132:135], v[116:119], v[20:23]
    ds_read_b128 v[156:159], v9 offset:0
    v_mfma_f32_16x16x32_bf16 v[24:27], v[136:139], v[116:119], v[24:27]
    ds_read_b64_tr_b16 v[172:173], v16 offset:43008
    v_mfma_f32_16x16x32_bf16 v[28:31], v[140:143], v[116:119], v[28:31]
    ds_read_b64_tr_b16 v[174:175], v16 offset:44032
    v_mfma_f32_16x16x32_bf16 v[32:35], v[144:147], v[116:119], v[32:35]
    ds_read_b64_tr_b16 v[176:177], v17 offset:43008
    v_mfma_f32_16x16x32_bf16 v[36:39], v[116:119], v[148:151], v[36:39]
    v_mfma_f32_16x16x32_bf16 v[40:43], v[116:119], v[152:155], v[40:43]
    ds_read_b64_tr_b16 v[178:179], v17 offset:44032
    v_mfma_f32_16x16x32_bf16 v[44:47], v[132:135], v[120:123], v[44:47]
    ds_read_b64_tr_b16 v[180:181], v16 offset:45056
    v_mfma_f32_16x16x32_bf16 v[48:51], v[136:139], v[120:123], v[48:51]
    ds_read_b64_tr_b16 v[182:183], v16 offset:46080
    v_mfma_f32_16x16x32_bf16 v[52:55], v[140:143], v[120:123], v[52:55]
    ds_read_b64_tr_b16 v[184:185], v17 offset:45056
    v_mfma_f32_16x16x32_bf16 v[56:59], v[144:147], v[120:123], v[56:59]
    v_mfma_f32_16x16x32_bf16 v[60:63], v[120:123], v[148:151], v[60:63]
    ds_read_b64_tr_b16 v[186:187], v17 offset:46080
    v_mfma_f32_16x16x32_bf16 v[64:67], v[120:123], v[152:155], v[64:67]
    ds_read_b64_tr_b16 v[188:189], v16 offset:47104
    v_mfma_f32_16x16x32_bf16 v[68:71], v[132:135], v[124:127], v[68:71]
    ds_read_b64_tr_b16 v[190:191], v16 offset:48128
    v_mfma_f32_16x16x32_bf16 v[72:75], v[136:139], v[124:127], v[72:75]
    ds_read_b64_tr_b16 v[192:193], v17 offset:47104
    v_mfma_f32_16x16x32_bf16 v[76:79], v[140:143], v[124:127], v[76:79]
    v_mfma_f32_16x16x32_bf16 v[80:83], v[144:147], v[124:127], v[80:83]
    ds_read_b64_tr_b16 v[194:195], v17 offset:48128
    v_mfma_f32_16x16x32_bf16 v[84:87], v[124:127], v[148:151], v[84:87]
    ds_read_b128 v[160:163], v9 offset:2048
    v_mfma_f32_16x16x32_bf16 v[88:91], v[124:127], v[152:155], v[88:91]
    ds_read_b128 v[164:167], v11 offset:0
    v_mfma_f32_16x16x32_bf16 v[92:95], v[132:135], v[128:131], v[92:95]
    ds_read_b128 v[168:171], v11 offset:2048
    v_mfma_f32_16x16x32_bf16 v[96:99], v[136:139], v[128:131], v[96:99]
    v_mfma_f32_16x16x32_bf16 v[100:103], v[140:143], v[128:131], v[100:103]
    v_mfma_f32_16x16x32_bf16 v[104:107], v[144:147], v[128:131], v[104:107]
    v_mfma_f32_16x16x32_bf16 v[108:111], v[128:131], v[148:151], v[108:111]
    v_add_u32 v8, s50, v8
    v_add_u32 v10, s50, v10
    v_mfma_f32_16x16x32_bf16 v[112:115], v[128:131], v[152:155], v[112:115]
    s_waitcnt vmcnt(2) lgkmcnt(0)
    s_barrier
    v_mfma_f32_16x16x32_bf16 v[20:23], v[172:175], v[156:159], v[20:23]
    ds_read_b32 v196, v12 offset:0
    ds_read_b32 v197, v12 offset:1024
    v_mfma_f32_16x16x32_bf16 v[24:27], v[176:179], v[156:159], v[24:27]
    ds_read_b32 v198, v12 offset:64
    v_mfma_f32_16x16x32_bf16 v[28:31], v[180:183], v[156:159], v[28:31]
    ds_read_b32 v199, v12 offset:1088
    ds_read_b32 v200, v13 offset:0
    v_mfma_f32_16x16x32_bf16 v[32:35], v[184:187], v[156:159], v[32:35]
    ds_read_b32 v201, v13 offset:1024
    v_mfma_f32_16x16x32_bf16 v[36:39], v[156:159], v[188:191], v[36:39]
    ds_read_b32 v202, v13 offset:64
    v_mfma_f32_16x16x32_bf16 v[40:43], v[156:159], v[192:195], v[40:43]
    ds_read_b32 v203, v13 offset:1088
    ds_read_b128 v[116:119], v5 offset:0
    v_mfma_f32_16x16x32_bf16 v[44:47], v[172:175], v[160:163], v[44:47]
    ds_read_b128 v[120:123], v5 offset:64
    v_mfma_f32_16x16x32_bf16 v[48:51], v[176:179], v[160:163], v[48:51]
    ds_read_b128 v[124:127], v5 offset:256
    ds_read_b128 v[128:131], v5 offset:320
    v_mfma_f32_16x16x32_bf16 v[52:55], v[180:183], v[160:163], v[52:55]
    ds_read_b32 v132, v6 offset:512
    v_mfma_f32_16x16x32_bf16 v[56:59], v[184:187], v[160:163], v[56:59]
    ds_read_b32 v133, v6 offset:576
    v_mfma_f32_16x16x32_bf16 v[60:63], v[160:163], v[188:191], v[60:63]
    ds_read_b128 v[134:137], v5 offset:1024
    ds_read_b128 v[138:141], v5 offset:1088
    v_mfma_f32_16x16x32_bf16 v[64:67], v[160:163], v[192:195], v[64:67]
    ds_read_b128 v[142:145], v5 offset:1280
    v_mfma_f32_16x16x32_bf16 v[68:71], v[172:175], v[164:167], v[68:71]
    ds_read_b128 v[146:149], v5 offset:1344
    ds_read_b32 v150, v6 offset:1536
    v_mfma_f32_16x16x32_bf16 v[72:75], v[176:179], v[164:167], v[72:75]
    ds_read_b32 v151, v6 offset:1600
    v_mfma_f32_16x16x32_bf16 v[76:79], v[180:183], v[164:167], v[76:79]
    ds_read_b128 v[204:207], v14 offset:0
    v_mfma_f32_16x16x32_bf16 v[80:83], v[184:187], v[164:167], v[80:83]
    ds_read_b128 v[208:211], v14 offset:1024
    ds_read_b128 v[212:215], v14 offset:64
    v_mfma_f32_16x16x32_bf16 v[84:87], v[164:167], v[188:191], v[84:87]
    ds_read_b128 v[216:219], v14 offset:1088
    v_mfma_f32_16x16x32_bf16 v[88:91], v[164:167], v[192:195], v[88:91]
    ds_read_b128 v[220:223], v15 offset:0
    ds_read_b128 v[224:227], v15 offset:1024
    v_mfma_f32_16x16x32_bf16 v[92:95], v[172:175], v[168:171], v[92:95]
    ds_read_b128 v[228:231], v15 offset:64
    v_mfma_f32_16x16x32_bf16 v[96:99], v[176:179], v[168:171], v[96:99]
    ds_read_b128 v[232:235], v15 offset:1088
    v_mfma_f32_16x16x32_bf16 v[100:103], v[180:183], v[168:171], v[100:103]
    v_mfma_f32_16x16x32_bf16 v[104:107], v[184:187], v[168:171], v[104:107]
    v_mfma_f32_16x16x32_bf16 v[108:111], v[168:171], v[188:191], v[108:111]
    v_add_u32 v9, s50, v9
    v_add_u32 v11, s50, v11
    s_add_u32 s47, s47, s50
    s_cmp_eq_u32 s47, 65536
    s_cselect_b32 s50, 0xffff0000, s51
    v_mfma_f32_16x16x32_bf16 v[112:115], v[168:171], v[192:195], v[112:115]
L_k1_qkv_epi:
    s_waitcnt lgkmcnt(0)
    v_pk_add_f32 v[116:117], v[116:117], v[134:135]
    v_pk_add_f32 v[118:119], v[118:119], v[136:137]
    v_pk_add_f32 v[120:121], v[120:121], v[138:139]
    v_pk_add_f32 v[122:123], v[122:123], v[140:141]
    v_pk_add_f32 v[124:125], v[124:125], v[142:143]
    v_pk_add_f32 v[126:127], v[126:127], v[144:145]
    v_pk_add_f32 v[128:129], v[128:129], v[146:147]
    v_pk_add_f32 v[130:131], v[130:131], v[148:149]
    v_pk_add_f32 v[132:133], v[132:133], v[150:151]
    v_mov_b32 v240, v197
    v_mov_b32 v241, v197
    v_mov_b32 v197, v196
    v_mov_b32 v242, v199
    v_mov_b32 v243, v199
    v_mov_b32 v199, v198
    v_mov_b32 v244, v201
    v_mov_b32 v245, v201
    v_mov_b32 v201, v200
    v_mov_b32 v246, v203
    v_mov_b32 v247, v203
    v_mov_b32 v203, v202
    v_mov_b32 v248, v132
    v_mov_b32 v249, v132
    v_mov_b32 v250, v133
    v_mov_b32 v251, v133
    s_add_u32 s12, s6, 0x1400000
    s_addc_u32 s13, s7, 0
    s_mov_b32 s14, 0x1200000
    s_mov_b32 s15, 0x00020000
    s_lshl_b32 s39, s29, 14
    s_lshl_b32 s40, s32, 11
    s_sub_u32 s41, 14336, s40
    s_add_u32 s40, s40, s39
    s_add_u32 s41, s41, s39
    s_add_u32 s16, s6, 0x800000
    s_addc_u32 s17, s7, 0
    s_mov_b32 s18, 0x800000
    s_mov_b32 s19, 0x00020000
    s_lshl_b32 s34, s29, 4
    s_add_u32 s34, s34, s30
    s_lshl_b32 s35, s34, 16
    s_lshl_b32 s38, s33, 15
    s_add_u32 s38, s38, s35
    s_lshl_b32 s39, s32, 12
    s_sub_u32 s43, 28672, s39
    s_add_u32 s42, s38, s39
    s_add_u32 s38, s38, s43
    s_lshl_b32 s36, s33, 16
    s_add_u32 s39, s39, s36
    s_add_u32 s43, s43, s36
    v_add_u32 v12, s43, v19
    v_add_u32 v13, s39, v19
    v_pk_mul_f32 v[152:153], v[124:125], v[240:241]
    v_pk_mul_f32 v[154:155], v[126:127], v[240:241]
    v_pk_fma_f32 v[28:29], v[28:29], v[196:197], v[152:153]
    v_pk_fma_f32 v[30:31], v[30:31], v[196:197], v[154:155]
    v_pk_mul_f32 v[152:153], v[128:129], v[240:241]
    v_pk_mul_f32 v[154:155], v[130:131], v[240:241]
    v_pk_fma_f32 v[32:33], v[32:33], v[196:197], v[152:153]
    v_pk_fma_f32 v[34:35], v[34:35], v[196:197], v[154:155]
    v_cvt_pk_bf16_f32 v156, v28, v29
    v_cvt_pk_bf16_f32 v157, v30, v31
    v_cvt_pk_bf16_f32 v158, v32, v33
    v_cvt_pk_bf16_f32 v159, v34, v35
    buffer_store_dwordx4 v[156:159], v19, s[16:19], s42 offen offset:0 sc1
    ds_write_b128 v12, v[156:159] offset:0
    v_pk_mul_f32 v[152:153], v[124:125], v[242:243]
    v_pk_mul_f32 v[154:155], v[126:127], v[242:243]
    v_pk_fma_f32 v[52:53], v[52:53], v[198:199], v[152:153]
    v_pk_fma_f32 v[54:55], v[54:55], v[198:199], v[154:155]
    v_pk_mul_f32 v[152:153], v[128:129], v[242:243]
    v_pk_mul_f32 v[154:155], v[130:131], v[242:243]
    v_pk_fma_f32 v[56:57], v[56:57], v[198:199], v[152:153]
    v_pk_fma_f32 v[58:59], v[58:59], v[198:199], v[154:155]
    v_cvt_pk_bf16_f32 v160, v52, v53
    v_cvt_pk_bf16_f32 v161, v54, v55
    v_cvt_pk_bf16_f32 v162, v56, v57
    v_cvt_pk_bf16_f32 v163, v58, v59
    buffer_store_dwordx4 v[160:163], v19, s[16:19], s42 offen offset:1024 sc1
    ds_write_b128 v12, v[160:163] offset:1024
    v_pk_mul_f32 v[152:153], v[208:209], v[248:249]
    v_pk_mul_f32 v[154:155], v[210:211], v[248:249]
    v_pk_fma_f32 v[36:37], v[36:37], v[204:205], v[152:153]
    v_pk_fma_f32 v[38:39], v[38:39], v[206:207], v[154:155]
    v_pk_mul_f32 v[152:153], v[216:217], v[248:249]
    v_pk_mul_f32 v[154:155], v[218:219], v[248:249]
    v_pk_fma_f32 v[60:61], v[60:61], v[212:213], v[152:153]
    v_pk_fma_f32 v[62:63], v[62:63], v[214:215], v[154:155]
    v_cvt_pk_bf16_f32 v164, v36, v37
    v_cvt_pk_bf16_f32 v165, v38, v39
    v_cvt_pk_bf16_f32 v166, v60, v61
    v_cvt_pk_bf16_f32 v167, v62, v63
    buffer_store_dwordx4 v[164:167], v19, s[16:19], s42 offen offset:2048 sc1
    ds_write_b128 v12, v[164:167] offset:2048
    v_pk_mul_f32 v[152:153], v[208:209], v[250:251]
    v_pk_mul_f32 v[154:155], v[210:211], v[250:251]
    v_pk_fma_f32 v[40:41], v[40:41], v[204:205], v[152:153]
    v_pk_fma_f32 v[42:43], v[42:43], v[206:207], v[154:155]
    v_pk_mul_f32 v[152:153], v[216:217], v[250:251]
    v_pk_mul_f32 v[154:155], v[218:219], v[250:251]
    v_pk_fma_f32 v[64:65], v[64:65], v[212:213], v[152:153]
    v_pk_fma_f32 v[66:67], v[66:67], v[214:215], v[154:155]
    v_cvt_pk_bf16_f32 v168, v40, v41
    v_cvt_pk_bf16_f32 v169, v42, v43
    v_cvt_pk_bf16_f32 v170, v64, v65
    v_cvt_pk_bf16_f32 v171, v66, v67
    buffer_store_dwordx4 v[168:171], v19, s[16:19], s42 offen offset:3072 sc1
    ds_write_b128 v12, v[168:171] offset:3072
    v_pk_mul_f32 v[152:153], v[124:125], v[244:245]
    v_pk_mul_f32 v[154:155], v[126:127], v[244:245]
    v_pk_fma_f32 v[76:77], v[76:77], v[200:201], v[152:153]
    v_pk_fma_f32 v[78:79], v[78:79], v[200:201], v[154:155]
    v_pk_mul_f32 v[152:153], v[128:129], v[244:245]
    v_pk_mul_f32 v[154:155], v[130:131], v[244:245]
    v_pk_fma_f32 v[80:81], v[80:81], v[200:201], v[152:153]
    v_pk_fma_f32 v[82:83], v[82:83], v[200:201], v[154:155]
    v_cvt_pk_bf16_f32 v172, v76, v77
    v_cvt_pk_bf16_f32 v173, v78, v79
    v_cvt_pk_bf16_f32 v174, v80, v81
    v_cvt_pk_bf16_f32 v175, v82, v83
    buffer_store_dwordx4 v[172:175], v19, s[16:19], s38 offen offset:0 sc1
    ds_write_b128 v13, v[172:175] offset:0
    v_pk_mul_f32 v[152:153], v[124:125], v[246:247]
    v_pk_mul_f32 v[154:155], v[126:127], v[246:247]
    v_pk_fma_f32 v[100:101], v[100:101], v[202:203], v[152:153]
    v_pk_fma_f32 v[102:103], v[102:103], v[202:203], v[154:155]
    v_pk_mul_f32 v[152:153], v[128:129], v[246:247]
    v_pk_mul_f32 v[154:155], v[130:131], v[246:247]
    v_pk_fma_f32 v[104:105], v[104:105], v[202:203], v[152:153]
    v_pk_fma_f32 v[106:107], v[106:107], v[202:203], v[154:155]
    v_cvt_pk_bf16_f32 v176, v100, v101
    v_cvt_pk_bf16_f32 v177, v102, v103
    v_cvt_pk_bf16_f32 v178, v104, v105
    v_cvt_pk_bf16_f32 v179, v106, v107
    buffer_store_dwordx4 v[176:179], v19, s[16:19], s38 offen offset:1024 sc1
    ds_write_b128 v13, v[176:179] offset:1024
    v_pk_mul_f32 v[152:153], v[224:225], v[248:249]
    v_pk_mul_f32 v[154:155], v[226:227], v[248:249]
    v_pk_fma_f32 v[84:85], v[84:85], v[220:221], v[152:153]
    v_pk_fma_f32 v[86:87], v[86:87], v[222:223], v[154:155]
    v_pk_mul_f32 v[152:153], v[232:233], v[248:249]
    v_pk_mul_f32 v[154:155], v[234:235], v[248:249]
    v_pk_fma_f32 v[108:109], v[108:109], v[228:229], v[152:153]
    v_pk_fma_f32 v[110:111], v[110:111], v[230:231], v[154:155]
    v_cvt_pk_bf16_f32 v180, v84, v85
    v_cvt_pk_bf16_f32 v181, v86, v87
    v_cvt_pk_bf16_f32 v182, v108, v109
    v_cvt_pk_bf16_f32 v183, v110, v111
    buffer_store_dwordx4 v[180:183], v19, s[16:19], s38 offen offset:2048 sc1
    ds_write_b128 v13, v[180:183] offset:2048
    v_pk_mul_f32 v[152:153], v[224:225], v[250:251]
    v_pk_mul_f32 v[154:155], v[226:227], v[250:251]
    v_pk_fma_f32 v[88:89], v[88:89], v[220:221], v[152:153]
    v_pk_fma_f32 v[90:91], v[90:91], v[222:223], v[154:155]
    v_pk_mul_f32 v[152:153], v[232:233], v[250:251]
    v_pk_mul_f32 v[154:155], v[234:235], v[250:251]
    v_pk_fma_f32 v[112:113], v[112:113], v[228:229], v[152:153]
    v_pk_fma_f32 v[114:115], v[114:115], v[230:231], v[154:155]
    v_cvt_pk_bf16_f32 v184, v88, v89
    v_cvt_pk_bf16_f32 v185, v90, v91
    v_cvt_pk_bf16_f32 v186, v112, v113
    v_cvt_pk_bf16_f32 v187, v114, v115
    buffer_store_dwordx4 v[184:187], v19, s[16:19], s38 offen offset:3072 sc1
    ds_write_b128 v13, v[184:187] offset:3072
    v_pk_mul_f32 v[152:153], v[116:117], v[240:241]
    v_pk_mul_f32 v[154:155], v[118:119], v[240:241]
    v_pk_fma_f32 v[20:21], v[20:21], v[196:197], v[152:153]
    v_pk_fma_f32 v[22:23], v[22:23], v[196:197], v[154:155]
    v_pk_mul_f32 v[152:153], v[120:121], v[240:241]
    v_pk_mul_f32 v[154:155], v[122:123], v[240:241]
    v_pk_fma_f32 v[24:25], v[24:25], v[196:197], v[152:153]
    v_pk_fma_f32 v[26:27], v[26:27], v[196:197], v[154:155]
    v_pk_mul_f32 v[152:153], v[116:117], v[242:243]
    v_pk_mul_f32 v[154:155], v[118:119], v[242:243]
    v_pk_fma_f32 v[44:45], v[44:45], v[198:199], v[152:153]
    v_pk_fma_f32 v[46:47], v[46:47], v[198:199], v[154:155]
    v_pk_mul_f32 v[152:153], v[120:121], v[242:243]
    v_pk_mul_f32 v[154:155], v[122:123], v[242:243]
    v_pk_fma_f32 v[48:49], v[48:49], v[198:199], v[152:153]
    v_pk_fma_f32 v[50:51], v[50:51], v[198:199], v[154:155]
    v_pk_mul_f32 v[152:153], v[116:117], v[244:245]
    v_pk_mul_f32 v[154:155], v[118:119], v[244:245]
    v_pk_fma_f32 v[68:69], v[68:69], v[200:201], v[152:153]
    v_pk_fma_f32 v[70:71], v[70:71], v[200:201], v[154:155]
    v_pk_mul_f32 v[152:153], v[120:121], v[244:245]
    v_pk_mul_f32 v[154:155], v[122:123], v[244:245]
    v_pk_fma_f32 v[72:73], v[72:73], v[200:201], v[152:153]
    v_pk_fma_f32 v[74:75], v[74:75], v[200:201], v[154:155]
    v_pk_mul_f32 v[152:153], v[116:117], v[246:247]
    v_pk_mul_f32 v[154:155], v[118:119], v[246:247]
    v_pk_fma_f32 v[92:93], v[92:93], v[202:203], v[152:153]
    v_pk_fma_f32 v[94:95], v[94:95], v[202:203], v[154:155]
    v_pk_mul_f32 v[152:153], v[120:121], v[246:247]
    v_pk_mul_f32 v[154:155], v[122:123], v[246:247]
    v_pk_fma_f32 v[96:97], v[96:97], v[202:203], v[152:153]
    v_pk_fma_f32 v[98:99], v[98:99], v[202:203], v[154:155]
    v_cvt_pk_bf16_f32 v192, v20, v21
    v_cvt_pk_bf16_f32 v193, v22, v23
    v_cvt_pk_bf16_f32 v194, v24, v25
    v_cvt_pk_bf16_f32 v195, v26, v27
    v_cvt_pk_bf16_f32 v196, v44, v45
    v_cvt_pk_bf16_f32 v197, v46, v47
    v_cvt_pk_bf16_f32 v198, v48, v49
    v_cvt_pk_bf16_f32 v199, v50, v51
    v_cvt_pk_bf16_f32 v200, v68, v69
    v_cvt_pk_bf16_f32 v201, v70, v71
    v_cvt_pk_bf16_f32 v202, v72, v73
    v_cvt_pk_bf16_f32 v203, v74, v75
    v_cvt_pk_bf16_f32 v204, v92, v93
    v_cvt_pk_bf16_f32 v205, v94, v95
    v_cvt_pk_bf16_f32 v206, v96, v97
    v_cvt_pk_bf16_f32 v207, v98, v99
    s_waitcnt lgkmcnt(0)
    s_barrier
    v_and_b32 v2, 15, v1
    v_lshrrev_b32 v7, 4, v1
    v_lshlrev_b32 v7, 2, v7
    s_mov_b64 s[50:51], s[40:41]
    v_add_u32 v8, 0, v7
    v_cmp_lt_u32 s[36:37], v2, v8
    v_add_u32 v8, 1, v7
    v_cmp_lt_u32 s[38:39], v2, v8
    v_add_u32 v8, 2, v7
    v_cmp_lt_u32 s[40:41], v2, v8
    v_add_u32 v8, 3, v7
    v_cmp_lt_u32 s[42:43], v2, v8
    s_mov_b64 s[44:45], -1
    s_mov_b64 s[46:47], 0
    v_mov_b32 v7, 0xff800000
    v_mov_b32 v188, 0x3f803f80
    v_mov_b32 v14, v7
    v_mov_b32 v189, 0x3f803f80
    v_mov_b32 v15, v7
    v_mov_b32 v190, 0x3f803f80
    v_mov_b32 v16, v7
    v_mov_b32 v191, 0x3f803f80
    v_mov_b32 v17, v7
    v_mov_b32 v208, 0
    v_mov_b32 v209, 0
    v_mov_b32 v210, 0
    v_mov_b32 v211, 0
    v_mov_b32 v212, 0
    v_mov_b32 v213, 0
    v_mov_b32 v214, 0
    v_mov_b32 v215, 0
    v_mov_b32 v216, 0
    v_mov_b32 v217, 0
    v_mov_b32 v218, 0
    v_mov_b32 v219, 0
    v_mov_b32 v220, 0
    v_mov_b32 v221, 0
    v_mov_b32 v222, 0
    v_mov_b32 v223, 0
    v_mov_b32 v224, 0
    v_mov_b32 v225, 0
    v_mov_b32 v226, 0
    v_mov_b32 v227, 0
    v_mov_b32 v228, 0
    v_mov_b32 v229, 0
    v_mov_b32 v230, 0
    v_mov_b32 v231, 0
    v_mov_b32 v232, 0
    v_mov_b32 v233, 0
    v_mov_b32 v234, 0
    v_mov_b32 v235, 0
    v_mov_b32 v236, 0
    v_mov_b32 v237, 0
    v_mov_b32 v238, 0
    v_mov_b32 v239, 0
    v_mov_b32 v240, 0
    v_mov_b32 v241, 0
    v_mov_b32 v242, 0
    v_mov_b32 v243, 0
    v_mov_b32 v244, 0
    v_mov_b32 v245, 0
    v_mov_b32 v246, 0
    v_mov_b32 v247, 0
    v_mov_b32 v248, 0
    v_mov_b32 v249, 0
    v_mov_b32 v250, 0
    v_mov_b32 v251, 0
    v_mov_b32 v252, 0
    v_mov_b32 v253, 0
    v_mov_b32 v254, 0
    v_mov_b32 v255, 0
    s_mov_b32 s48, 0x3e8293ee
    s_mov_b32 s49, s48
    s_add_u32 s20, s32, 1
    s_sub_u32 s21, 8, s32
    s_mov_b32 s22, 0
    s_mov_b32 s31, 1
    s_mov_b32 s68, 0
    s_lshl_b32 s27, s29, 11
    s_add_u32 s27, s27, 16448
    s_lshl_b32 s23, s34, 7
    s_add_u32 s23, s23, 16384
    v_mov_b32 v18, 0
    v_mov_b32 v20, 1
    s_waitcnt vmcnt(0)
    s_mov_b64 exec, 1
    buffer_atomic_add v20, v18, s[52:55], s23 offen sc1
    s_mov_b64 exec, -1
L_k1_part:
    ds_read_b128 v[156:159], v13 offset:0
    ds_read_b128 v[160:163], v13 offset:1024
    ds_read_b128 v[172:175], v13 offset:2048
    ds_read_b128 v[176:179], v13 offset:3072
    ds_read_b128 v[164:167], v13 offset:4096
    ds_read_b128 v[168:171], v13 offset:5120
    s_waitcnt lgkmcnt(4)
    v_mfma_f32_16x16x32_bf16 v[28:31], v[156:159], v[200:203], 0
    v_mfma_f32_16x16x32_bf16 v[32:35], v[160:163], v[200:203], 0
    v_mfma_f32_16x16x32_bf16 v[36:39], v[156:159], v[204:207], 0
    v_mfma_f32_16x16x32_bf16 v[40:43], v[160:163], v[204:207], 0
    s_cmp_eq_u32 s21, 1
    s_cbranch_scc1 L_atBx_10
    ds_read_b128 v[156:159], v13 offset:8192
    ds_read_b128 v[160:163], v13 offset:9216
    s_waitcnt lgkmcnt(2)
    v_mfma_f32_16x16x32_bf16 v[44:47], v[164:167], v[200:203], 0
    v_cndmask_b32 v28, v28, v7, s[36:37]
    v_cndmask_b32 v29, v29, v7, s[38:39]
    v_cndmask_b32 v30, v30, v7, s[40:41]
    v_cndmask_b32 v31, v31, v7, s[42:43]
    v_max3_f32 v8, v16, v28, v29
    v_max3_f32 v8, v8, v30, v31
    v_mfma_f32_16x16x32_bf16 v[48:51], v[168:171], v[200:203], 0
    v_cndmask_b32 v32, v32, v7, s[44:45]
    v_cndmask_b32 v33, v33, v7, s[44:45]
    v_cndmask_b32 v34, v34, v7, s[44:45]
    v_cndmask_b32 v35, v35, v7, s[44:45]
    v_max3_f32 v8, v8, v32, v33
    v_max3_f32 v8, v8, v34, v35
    v_mfma_f32_16x16x32_bf16 v[52:55], v[164:167], v[204:207], 0
    v_cndmask_b32 v36, v36, v7, s[46:47]
    v_cndmask_b32 v37, v37, v7, s[46:47]
    v_cndmask_b32 v38, v38, v7, s[46:47]
    v_cndmask_b32 v39, v39, v7, s[46:47]
    v_max3_f32 v9, v17, v36, v37
    v_max3_f32 v9, v9, v38, v39
    v_mfma_f32_16x16x32_bf16 v[56:59], v[168:171], v[204:207], 0
    v_cndmask_b32 v40, v40, v7, s[36:37]
    v_cndmask_b32 v41, v41, v7, s[38:39]
    v_cndmask_b32 v42, v42, v7, s[40:41]
    v_cndmask_b32 v43, v43, v7, s[42:43]
    v_max3_f32 v9, v9, v40, v41
    v_max3_f32 v9, v9, v42, v43
    s_cmp_eq_u32 s21, 2
    s_cbranch_scc1 L_atBx_11
    ds_read_b128 v[164:167], v13 offset:12288
    ds_read_b128 v[168:171], v13 offset:13312
    s_waitcnt lgkmcnt(2)
    v_mfma_f32_16x16x32_bf16 v[60:63], v[156:159], v[200:203], 0
    v_max3_f32 v8, v8, v44, v45
    v_max3_f32 v8, v8, v46, v47
    v_mfma_f32_16x16x32_bf16 v[64:67], v[160:163], v[200:203], 0
    v_max3_f32 v8, v8, v48, v49
    v_max3_f32 v8, v8, v50, v51
    v_mfma_f32_16x16x32_bf16 v[68:71], v[156:159], v[204:207], 0
    v_max3_f32 v9, v9, v52, v53
    v_max3_f32 v9, v9, v54, v55
    v_mfma_f32_16x16x32_bf16 v[72:75], v[160:163], v[204:207], 0
    v_max3_f32 v9, v9, v56, v57
    v_max3_f32 v9, v9, v58, v59
    s_cmp_eq_u32 s21, 3
    s_cbranch_scc1 L_atBx_12
    ds_read_b128 v[156:159], v13 offset:16384
    ds_read_b128 v[160:163], v13 offset:17408
    s_waitcnt lgkmcnt(2)
    v_mfma_f32_16x16x32_bf16 v[76:79], v[164:167], v[200:203], 0
    v_max3_f32 v8, v8, v60, v61
    v_max3_f32 v8, v8, v62, v63
    v_mfma_f32_16x16x32_bf16 v[80:83], v[168:171], v[200:203], 0
    v_max3_f32 v8, v8, v64, v65
    v_max3_f32 v8, v8, v66, v67
    v_mfma_f32_16x16x32_bf16 v[84:87], v[164:167], v[204:207], 0
    v_max3_f32 v9, v9, v68, v69
    v_max3_f32 v9, v9, v70, v71
    v_mfma_f32_16x16x32_bf16 v[88:91], v[168:171], v[204:207], 0
    v_max3_f32 v9, v9, v72, v73
    v_max3_f32 v9, v9, v74, v75
    s_cmp_eq_u32 s21, 4
    s_cbranch_scc1 L_atBx_13
    ds_read_b128 v[164:167], v13 offset:20480
    ds_read_b128 v[168:171], v13 offset:21504
    s_waitcnt lgkmcnt(2)
    v_mfma_f32_16x16x32_bf16 v[92:95], v[156:159], v[200:203], 0
    v_max3_f32 v8, v8, v76, v77
    v_max3_f32 v8, v8, v78, v79
    v_mfma_f32_16x16x32_bf16 v[96:99], v[160:163], v[200:203], 0
    v_max3_f32 v8, v8, v80, v81
    v_max3_f32 v8, v8, v82, v83
    v_mfma_f32_16x16x32_bf16 v[100:103], v[156:159], v[204:207], 0
    v_max3_f32 v9, v9, v84, v85
    v_max3_f32 v9, v9, v86, v87
    v_mfma_f32_16x16x32_bf16 v[104:107], v[160:163], v[204:207], 0
    v_max3_f32 v9, v9, v88, v89
    v_max3_f32 v9, v9, v90, v91
    s_cmp_eq_u32 s21, 5
    s_cbranch_scc1 L_atBx_14
    ds_read_b128 v[156:159], v13 offset:24576
    ds_read_b128 v[160:163], v13 offset:25600
    s_waitcnt lgkmcnt(2)
    v_mfma_f32_16x16x32_bf16 v[108:111], v[164:167], v[200:203], 0
    v_max3_f32 v8, v8, v92, v93
    v_max3_f32 v8, v8, v94, v95
    v_mfma_f32_16x16x32_bf16 v[112:115], v[168:171], v[200:203], 0
    v_max3_f32 v8, v8, v96, v97
    v_max3_f32 v8, v8, v98, v99
    v_mfma_f32_16x16x32_bf16 v[116:119], v[164:167], v[204:207], 0
    v_max3_f32 v9, v9, v100, v101
    v_max3_f32 v9, v9, v102, v103
    v_mfma_f32_16x16x32_bf16 v[120:123], v[168:171], v[204:207], 0
    v_max3_f32 v9, v9, v104, v105
    v_max3_f32 v9, v9, v106, v107
    s_cmp_eq_u32 s21, 6
    s_cbranch_scc1 L_atBx_15
    ds_read_b128 v[164:167], v13 offset:28672
    ds_read_b128 v[168:171], v13 offset:29696
    s_waitcnt lgkmcnt(2)
    v_mfma_f32_16x16x32_bf16 v[124:127], v[156:159], v[200:203], 0
    v_max3_f32 v8, v8, v108, v109
    v_max3_f32 v8, v8, v110, v111
    v_mfma_f32_16x16x32_bf16 v[128:131], v[160:163], v[200:203], 0
    v_max3_f32 v8, v8, v112, v113
    v_max3_f32 v8, v8, v114, v115
    v_mfma_f32_16x16x32_bf16 v[132:135], v[156:159], v[204:207], 0
    v_max3_f32 v9, v9, v116, v117
    v_max3_f32 v9, v9, v118, v119
    v_mfma_f32_16x16x32_bf16 v[136:139], v[160:163], v[204:207], 0
    v_max3_f32 v9, v9, v120, v121
    v_max3_f32 v9, v9, v122, v123
    s_cmp_eq_u32 s21, 7
    s_cbranch_scc1 L_atBx_16
    s_waitcnt lgkmcnt(0)
    v_mfma_f32_16x16x32_bf16 v[140:143], v[164:167], v[200:203], 0
    v_max3_f32 v8, v8, v124, v125
    v_max3_f32 v8, v8, v126, v127
    v_mfma_f32_16x16x32_bf16 v[144:147], v[168:171], v[200:203], 0
    v_max3_f32 v8, v8, v128, v129
    v_max3_f32 v8, v8, v130, v131
    v_mfma_f32_16x16x32_bf16 v[148:151], v[164:167], v[204:207], 0
    v_max3_f32 v9, v9, v132, v133
    v_max3_f32 v9, v9, v134, v135
    v_mfma_f32_16x16x32_bf16 v[152:155], v[168:171], v[204:207], 0
    v_max3_f32 v9, v9, v136, v137
    v_max3_f32 v9, v9, v138, v139
    s_nop 5
    v_max3_f32 v8, v8, v140, v141
    v_max3_f32 v8, v8, v142, v143
    v_max3_f32 v8, v8, v144, v145
    v_max3_f32 v8, v8, v146, v147
    v_max3_f32 v9, v9, v148, v149
    v_max3_f32 v9, v9, v150, v151
    v_max3_f32 v9, v9, v152, v153
    v_max3_f32 v9, v9, v154, v155
L_atBb_8:
    v_mov_b32 v10, v8
    v_mov_b32 v11, v9
    s_nop 0
    v_permlane16_swap_b32 v8, v10
    v_permlane16_swap_b32 v9, v11
    v_max_f32 v8, v8, v10
    v_max_f32 v9, v9, v11
    v_mov_b32 v10, v8
    v_mov_b32 v11, v9
    s_nop 0
    v_permlane32_swap_b32 v8, v10
    v_permlane32_swap_b32 v9, v11
    v_max_f32 v8, v8, v10
    v_max_f32 v9, v9, v11
    v_sub_f32 v10, v16, v8
    v_mul_f32 v10, s48, v10
    v_exp_f32 v10, v10
    v_mov_b32 v16, v8
    v_mul_f32 v8, s48, v8
    v_sub_f32 v11, v17, v9
    v_mul_f32 v11, s48, v11
    v_exp_f32 v11, v11
    v_mov_b32 v17, v9
    v_mul_f32 v9, s48, v9
    v_mul_f32 v232, v232, v10
    v_mul_f32 v233, v233, v10
    v_mul_f32 v234, v234, v10
    v_mul_f32 v235, v235, v10
    v_mul_f32 v236, v236, v10
    v_mul_f32 v237, v237, v10
    v_mul_f32 v238, v238, v10
    v_mul_f32 v239, v239, v10
    v_mul_f32 v240, v240, v10
    v_mul_f32 v241, v241, v10
    v_mul_f32 v242, v242, v10
    v_mul_f32 v243, v243, v10
    v_mul_f32 v244, v244, v11
    v_mul_f32 v245, v245, v11
    v_mul_f32 v246, v246, v11
    v_mul_f32 v247, v247, v11
    v_mul_f32 v248, v248, v11
    v_mul_f32 v249, v249, v11
    v_mul_f32 v250, v250, v11
    v_mul_f32 v251, v251, v11
    v_mul_f32 v252, v252, v11
    v_mul_f32 v253, v253, v11
    v_mul_f32 v254, v254, v11
    v_mul_f32 v255, v255, v11
    v_fma_f32 v28, v28, s48, -v8
    v_fma_f32 v29, v29, s48, -v8
    v_fma_f32 v30, v30, s48, -v8
    v_fma_f32 v31, v31, s48, -v8
    v_exp_f32 v28, v28
    v_exp_f32 v29, v29
    v_fma_f32 v32, v32, s48, -v8
    v_fma_f32 v33, v33, s48, -v8
    v_exp_f32 v30, v30
    v_exp_f32 v31, v31
    v_fma_f32 v34, v34, s48, -v8
    v_fma_f32 v35, v35, s48, -v8
    v_cvt_pk_bf16_f32 v28, v28, v29
    v_exp_f32 v32, v32
    v_exp_f32 v33, v33
    v_fma_f32 v36, v36, s48, -v9
    v_fma_f32 v37, v37, s48, -v9
    v_cvt_pk_bf16_f32 v29, v30, v31
    v_exp_f32 v34, v34
    v_exp_f32 v35, v35
    v_fma_f32 v38, v38, s48, -v9
    v_fma_f32 v39, v39, s48, -v9
    v_cvt_pk_bf16_f32 v30, v32, v33
    v_exp_f32 v36, v36
    v_exp_f32 v37, v37
    v_fma_f32 v40, v40, s48, -v9
    v_fma_f32 v41, v41, s48, -v9
    v_cvt_pk_bf16_f32 v31, v34, v35
    v_exp_f32 v38, v38
    v_exp_f32 v39, v39
    v_fma_f32 v42, v42, s48, -v9
    v_fma_f32 v43, v43, s48, -v9
    v_cvt_pk_bf16_f32 v36, v36, v37
    v_exp_f32 v40, v40
    v_exp_f32 v41, v41
    v_cvt_pk_bf16_f32 v37, v38, v39
    v_exp_f32 v42, v42
    v_exp_f32 v43, v43
    v_cvt_pk_bf16_f32 v38, v40, v41
    s_nop 0
    v_cvt_pk_bf16_f32 v39, v42, v43
    s_cmp_eq_u32 s21, 1
    s_cbranch_scc1 L_atBy_17
    ds_read_b128 v[180:183], v13 offset:6144
    ds_read_b128 v[184:187], v13 offset:7168
    v_fma_f32 v44, v44, s48, -v8
    v_fma_f32 v45, v45, s48, -v8
    v_fma_f32 v46, v46, s48, -v8
    v_fma_f32 v47, v47, s48, -v8
    s_waitcnt lgkmcnt(2)
    v_exp_f32 v44, v44
    v_exp_f32 v45, v45
    v_fma_f32 v48, v48, s48, -v8
    v_fma_f32 v49, v49, s48, -v8
    v_mfma_f32_16x16x32_bf16 v[232:235], v[172:175], v[28:31], v[232:235]
    v_exp_f32 v46, v46
    v_exp_f32 v47, v47
    v_fma_f32 v50, v50, s48, -v8
    v_fma_f32 v51, v51, s48, -v8
    v_cvt_pk_bf16_f32 v44, v44, v45
    v_mfma_f32_16x16x32_bf16 v[244:247], v[172:175], v[36:39], v[244:247]
    v_exp_f32 v48, v48
    v_exp_f32 v49, v49
    v_fma_f32 v52, v52, s48, -v9
    v_fma_f32 v53, v53, s48, -v9
    v_cvt_pk_bf16_f32 v45, v46, v47
    v_mfma_f32_16x16x32_bf16 v[236:239], v[176:179], v[28:31], v[236:239]
    v_exp_f32 v50, v50
    v_exp_f32 v51, v51
    v_fma_f32 v54, v54, s48, -v9
    v_fma_f32 v55, v55, s48, -v9
    v_cvt_pk_bf16_f32 v46, v48, v49
    v_mfma_f32_16x16x32_bf16 v[248:251], v[176:179], v[36:39], v[248:251]
    v_exp_f32 v52, v52
    v_exp_f32 v53, v53
    v_fma_f32 v56, v56, s48, -v9
    v_fma_f32 v57, v57, s48, -v9
    v_cvt_pk_bf16_f32 v47, v50, v51
    v_mfma_f32_16x16x32_bf16 v[240:243], v[188:191], v[28:31], v[240:243]
    v_exp_f32 v54, v54
    v_exp_f32 v55, v55
    v_fma_f32 v58, v58, s48, -v9
    v_fma_f32 v59, v59, s48, -v9
    v_cvt_pk_bf16_f32 v52, v52, v53
    v_mfma_f32_16x16x32_bf16 v[252:255], v[188:191], v[36:39], v[252:255]
    v_exp_f32 v56, v56
    v_exp_f32 v57, v57
    v_cvt_pk_bf16_f32 v53, v54, v55
    v_exp_f32 v58, v58
    v_exp_f32 v59, v59
    v_cvt_pk_bf16_f32 v54, v56, v57
    s_nop 0
    v_cvt_pk_bf16_f32 v55, v58, v59
    s_cmp_eq_u32 s21, 2
    s_cbranch_scc1 L_atBy_18
    ds_read_b128 v[172:175], v13 offset:10240
    ds_read_b128 v[176:179], v13 offset:11264
    v_fma_f32 v60, v60, s48, -v8
    v_fma_f32 v61, v61, s48, -v8
    v_fma_f32 v62, v62, s48, -v8
    v_fma_f32 v63, v63, s48, -v8
    s_waitcnt lgkmcnt(2)
    v_exp_f32 v60, v60
    v_exp_f32 v61, v61
    v_fma_f32 v64, v64, s48, -v8
    v_fma_f32 v65, v65, s48, -v8
    v_mfma_f32_16x16x32_bf16 v[232:235], v[180:183], v[44:47], v[232:235]
    v_exp_f32 v62, v62
    v_exp_f32 v63, v63
    v_fma_f32 v66, v66, s48, -v8
    v_fma_f32 v67, v67, s48, -v8
    v_cvt_pk_bf16_f32 v60, v60, v61
    v_mfma_f32_16x16x32_bf16 v[244:247], v[180:183], v[52:55], v[244:247]
    v_exp_f32 v64, v64
    v_exp_f32 v65, v65
    v_fma_f32 v68, v68, s48, -v9
    v_fma_f32 v69, v69, s48, -v9
    v_cvt_pk_bf16_f32 v61, v62, v63
    v_mfma_f32_16x16x32_bf16 v[236:239], v[184:187], v[44:47], v[236:239]
    v_exp_f32 v66, v66
    v_exp_f32 v67, v67
    v_fma_f32 v70, v70, s48, -v9
    v_fma_f32 v71, v71, s48, -v9
    v_cvt_pk_bf16_f32 v62, v64, v65
    v_mfma_f32_16x16x32_bf16 v[248:251], v[184:187], v[52:55], v[248:251]
    v_exp_f32 v68, v68
    v_exp_f32 v69, v69
    v_fma_f32 v72, v72, s48, -v9
    v_fma_f32 v73, v73, s48, -v9
    v_cvt_pk_bf16_f32 v63, v66, v67
    v_mfma_f32_16x16x32_bf16 v[240:243], v[188:191], v[44:47], v[240:243]
    v_exp_f32 v70, v70
    v_exp_f32 v71, v71
    v_fma_f32 v74, v74, s48, -v9
    v_fma_f32 v75, v75, s48, -v9
    v_cvt_pk_bf16_f32 v68, v68, v69
    v_mfma_f32_16x16x32_bf16 v[252:255], v[188:191], v[52:55], v[252:255]
    v_exp_f32 v72, v72
    v_exp_f32 v73, v73
    v_cvt_pk_bf16_f32 v69, v70, v71
    v_exp_f32 v74, v74
    v_exp_f32 v75, v75
    v_cvt_pk_bf16_f32 v70, v72, v73
    s_nop 0
    v_cvt_pk_bf16_f32 v71, v74, v75
    s_cmp_eq_u32 s21, 3
    s_cbranch_scc1 L_atBy_19
    ds_read_b128 v[180:183], v13 offset:14336
    ds_read_b128 v[184:187], v13 offset:15360
    v_fma_f32 v76, v76, s48, -v8
    v_fma_f32 v77, v77, s48, -v8
    v_fma_f32 v78, v78, s48, -v8
    v_fma_f32 v79, v79, s48, -v8
    s_waitcnt lgkmcnt(2)
    v_exp_f32 v76, v76
    v_exp_f32 v77, v77
    v_fma_f32 v80, v80, s48, -v8
    v_fma_f32 v81, v81, s48, -v8
    v_mfma_f32_16x16x32_bf16 v[232:235], v[172:175], v[60:63], v[232:235]
    v_exp_f32 v78, v78
    v_exp_f32 v79, v79
    v_fma_f32 v82, v82, s48, -v8
    v_fma_f32 v83, v83, s48, -v8
    v_cvt_pk_bf16_f32 v76, v76, v77
    v_mfma_f32_16x16x32_bf16 v[244:247], v[172:175], v[68:71], v[244:247]
    v_exp_f32 v80, v80
    v_exp_f32 v81, v81
    v_fma_f32 v84, v84, s48, -v9
    v_fma_f32 v85, v85, s48, -v9
    v_cvt_pk_bf16_f32 v77, v78, v79
    v_mfma_f32_16x16x32_bf16 v[236:239], v[176:179], v[60:63], v[236:239]
    v_exp_f32 v82, v82
    v_exp_f32 v83, v83
    v_fma_f32 v86, v86, s48, -v9
    v_fma_f32 v87, v87, s48, -v9
    v_cvt_pk_bf16_f32 v78, v80, v81
    v_mfma_f32_16x16x32_bf16 v[248:251], v[176:179], v[68:71], v[248:251]
    v_exp_f32 v84, v84
    v_exp_f32 v85, v85
    v_fma_f32 v88, v88, s48, -v9
    v_fma_f32 v89, v89, s48, -v9
    v_cvt_pk_bf16_f32 v79, v82, v83
    v_mfma_f32_16x16x32_bf16 v[240:243], v[188:191], v[60:63], v[240:243]
    v_exp_f32 v86, v86
    v_exp_f32 v87, v87
    v_fma_f32 v90, v90, s48, -v9
    v_fma_f32 v91, v91, s48, -v9
    v_cvt_pk_bf16_f32 v84, v84, v85
    v_mfma_f32_16x16x32_bf16 v[252:255], v[188:191], v[68:71], v[252:255]
    v_exp_f32 v88, v88
    v_exp_f32 v89, v89
    v_cvt_pk_bf16_f32 v85, v86, v87
    v_exp_f32 v90, v90
    v_exp_f32 v91, v91
    v_cvt_pk_bf16_f32 v86, v88, v89
    s_nop 0
    v_cvt_pk_bf16_f32 v87, v90, v91
    s_cmp_eq_u32 s21, 4
    s_cbranch_scc1 L_atBy_20
    ds_read_b128 v[172:175], v13 offset:18432
    ds_read_b128 v[176:179], v13 offset:19456
    v_fma_f32 v92, v92, s48, -v8
    v_fma_f32 v93, v93, s48, -v8
    v_fma_f32 v94, v94, s48, -v8
    v_fma_f32 v95, v95, s48, -v8
    s_waitcnt lgkmcnt(2)
    v_exp_f32 v92, v92
    v_exp_f32 v93, v93
    v_fma_f32 v96, v96, s48, -v8
    v_fma_f32 v97, v97, s48, -v8
    v_mfma_f32_16x16x32_bf16 v[232:235], v[180:183], v[76:79], v[232:235]
    v_exp_f32 v94, v94
    v_exp_f32 v95, v95
    v_fma_f32 v98, v98, s48, -v8
    v_fma_f32 v99, v99, s48, -v8
    v_cvt_pk_bf16_f32 v92, v92, v93
    v_mfma_f32_16x16x32_bf16 v[244:247], v[180:183], v[84:87], v[244:247]
    v_exp_f32 v96, v96
    v_exp_f32 v97, v97
    v_fma_f32 v100, v100, s48, -v9
    v_fma_f32 v101, v101, s48, -v9
    v_cvt_pk_bf16_f32 v93, v94, v95
    v_mfma_f32_16x16x32_bf16 v[236:239], v[184:187], v[76:79], v[236:239]
    v_exp_f32 v98, v98
    v_exp_f32 v99, v99
    v_fma_f32 v102, v102, s48, -v9
    v_fma_f32 v103, v103, s48, -v9
    v_cvt_pk_bf16_f32 v94, v96, v97
    v_mfma_f32_16x16x32_bf16 v[248:251], v[184:187], v[84:87], v[248:251]
    v_exp_f32 v100, v100
    v_exp_f32 v101, v101
    v_fma_f32 v104, v104, s48, -v9
    v_fma_f32 v105, v105, s48, -v9
    v_cvt_pk_bf16_f32 v95, v98, v99
    v_mfma_f32_16x16x32_bf16 v[240:243], v[188:191], v[76:79], v[240:243]
    v_exp_f32 v102, v102
    v_exp_f32 v103, v103
    v_fma_f32 v106, v106, s48, -v9
    v_fma_f32 v107, v107, s48, -v9
    v_cvt_pk_bf16_f32 v100, v100, v101
    v_mfma_f32_16x16x32_bf16 v[252:255], v[188:191], v[84:87], v[252:255]
    v_exp_f32 v104, v104
    v_exp_f32 v105, v105
    v_cvt_pk_bf16_f32 v101, v102, v103
    v_exp_f32 v106, v106
    v_exp_f32 v107, v107
    v_cvt_pk_bf16_f32 v102, v104, v105
    s_nop 0
    v_cvt_pk_bf16_f32 v103, v106, v107
    s_cmp_eq_u32 s21, 5
    s_cbranch_scc1 L_atBy_21
    ds_read_b128 v[180:183], v13 offset:22528
    ds_read_b128 v[184:187], v13 offset:23552
    v_fma_f32 v108, v108, s48, -v8
    v_fma_f32 v109, v109, s48, -v8
    v_fma_f32 v110, v110, s48, -v8
    v_fma_f32 v111, v111, s48, -v8
    s_waitcnt lgkmcnt(2)
    v_exp_f32 v108, v108
    v_exp_f32 v109, v109
    v_fma_f32 v112, v112, s48, -v8
    v_fma_f32 v113, v113, s48, -v8
    v_mfma_f32_16x16x32_bf16 v[232:235], v[172:175], v[92:95], v[232:235]
    v_exp_f32 v110, v110
    v_exp_f32 v111, v111
    v_fma_f32 v114, v114, s48, -v8
    v_fma_f32 v115, v115, s48, -v8
    v_cvt_pk_bf16_f32 v108, v108, v109
    v_mfma_f32_16x16x32_bf16 v[244:247], v[172:175], v[100:103], v[244:247]
    v_exp_f32 v112, v112
    v_exp_f32 v113, v113
    v_fma_f32 v116, v116, s48, -v9
    v_fma_f32 v117, v117, s48, -v9
    v_cvt_pk_bf16_f32 v109, v110, v111
    v_mfma_f32_16x16x32_bf16 v[236:239], v[176:179], v[92:95], v[236:239]
    v_exp_f32 v114, v114
    v_exp_f32 v115, v115
    v_fma_f32 v118, v118, s48, -v9
    v_fma_f32 v119, v119, s48, -v9
    v_cvt_pk_bf16_f32 v110, v112, v113
    v_mfma_f32_16x16x32_bf16 v[248:251], v[176:179], v[100:103], v[248:251]
    v_exp_f32 v116, v116
    v_exp_f32 v117, v117
    v_fma_f32 v120, v120, s48, -v9
    v_fma_f32 v121, v121, s48, -v9
    v_cvt_pk_bf16_f32 v111, v114, v115
    v_mfma_f32_16x16x32_bf16 v[240:243], v[188:191], v[92:95], v[240:243]
    v_exp_f32 v118, v118
    v_exp_f32 v119, v119
    v_fma_f32 v122, v122, s48, -v9
    v_fma_f32 v123, v123, s48, -v9
    v_cvt_pk_bf16_f32 v116, v116, v117
    v_mfma_f32_16x16x32_bf16 v[252:255], v[188:191], v[100:103], v[252:255]
    v_exp_f32 v120, v120
    v_exp_f32 v121, v121
    v_cvt_pk_bf16_f32 v117, v118, v119
    v_exp_f32 v122, v122
    v_exp_f32 v123, v123
    v_cvt_pk_bf16_f32 v118, v120, v121
    s_nop 0
    v_cvt_pk_bf16_f32 v119, v122, v123
    s_cmp_eq_u32 s21, 6
    s_cbranch_scc1 L_atBy_22
    ds_read_b128 v[172:175], v13 offset:26624
    ds_read_b128 v[176:179], v13 offset:27648
    v_fma_f32 v124, v124, s48, -v8
    v_fma_f32 v125, v125, s48, -v8
    v_fma_f32 v126, v126, s48, -v8
    v_fma_f32 v127, v127, s48, -v8
    s_waitcnt lgkmcnt(2)
    v_exp_f32 v124, v124
    v_exp_f32 v125, v125
    v_fma_f32 v128, v128, s48, -v8
    v_fma_f32 v129, v129, s48, -v8
    v_mfma_f32_16x16x32_bf16 v[232:235], v[180:183], v[108:111], v[232:235]
    v_exp_f32 v126, v126
    v_exp_f32 v127, v127
    v_fma_f32 v130, v130, s48, -v8
    v_fma_f32 v131, v131, s48, -v8
    v_cvt_pk_bf16_f32 v124, v124, v125
    v_mfma_f32_16x16x32_bf16 v[244:247], v[180:183], v[116:119], v[244:247]
    v_exp_f32 v128, v128
    v_exp_f32 v129, v129
    v_fma_f32 v132, v132, s48, -v9
    v_fma_f32 v133, v133, s48, -v9
    v_cvt_pk_bf16_f32 v125, v126, v127
    v_mfma_f32_16x16x32_bf16 v[236:239], v[184:187], v[108:111], v[236:239]
    v_exp_f32 v130, v130
    v_exp_f32 v131, v131
    v_fma_f32 v134, v134, s48, -v9
    v_fma_f32 v135, v135, s48, -v9
    v_cvt_pk_bf16_f32 v126, v128, v129
    v_mfma_f32_16x16x32_bf16 v[248:251], v[184:187], v[116:119], v[248:251]
    v_exp_f32 v132, v132
    v_exp_f32 v133, v133
    v_fma_f32 v136, v136, s48, -v9
    v_fma_f32 v137, v137, s48, -v9
    v_cvt_pk_bf16_f32 v127, v130, v131
    v_mfma_f32_16x16x32_bf16 v[240:243], v[188:191], v[108:111], v[240:243]
    v_exp_f32 v134, v134
    v_exp_f32 v135, v135
    v_fma_f32 v138, v138, s48, -v9
    v_fma_f32 v139, v139, s48, -v9
    v_cvt_pk_bf16_f32 v132, v132, v133
    v_mfma_f32_16x16x32_bf16 v[252:255], v[188:191], v[116:119], v[252:255]
    v_exp_f32 v136, v136
    v_exp_f32 v137, v137
    v_cvt_pk_bf16_f32 v133, v134, v135
    v_exp_f32 v138, v138
    v_exp_f32 v139, v139
    v_cvt_pk_bf16_f32 v134, v136, v137
    s_nop 0
    v_cvt_pk_bf16_f32 v135, v138, v139
    s_cmp_eq_u32 s21, 7
    s_cbranch_scc1 L_atBy_23
    ds_read_b128 v[180:183], v13 offset:30720
    ds_read_b128 v[184:187], v13 offset:31744
    v_fma_f32 v140, v140, s48, -v8
    v_fma_f32 v141, v141, s48, -v8
    v_fma_f32 v142, v142, s48, -v8
    v_fma_f32 v143, v143, s48, -v8
    s_waitcnt lgkmcnt(2)
    v_exp_f32 v140, v140
    v_exp_f32 v141, v141
    v_fma_f32 v144, v144, s48, -v8
    v_fma_f32 v145, v145, s48, -v8
    v_mfma_f32_16x16x32_bf16 v[232:235], v[172:175], v[124:127], v[232:235]
    v_exp_f32 v142, v142
    v_exp_f32 v143, v143
    v_fma_f32 v146, v146, s48, -v8
    v_fma_f32 v147, v147, s48, -v8
    v_cvt_pk_bf16_f32 v140, v140, v141
    v_mfma_f32_16x16x32_bf16 v[244:247], v[172:175], v[132:135], v[244:247]
    v_exp_f32 v144, v144
    v_exp_f32 v145, v145
    v_fma_f32 v148, v148, s48, -v9
    v_fma_f32 v149, v149, s48, -v9
    v_cvt_pk_bf16_f32 v141, v142, v143
    v_mfma_f32_16x16x32_bf16 v[236:239], v[176:179], v[124:127], v[236:239]
    v_exp_f32 v146, v146
    v_exp_f32 v147, v147
    v_fma_f32 v150, v150, s48, -v9
    v_fma_f32 v151, v151, s48, -v9
    v_cvt_pk_bf16_f32 v142, v144, v145
    v_mfma_f32_16x16x32_bf16 v[248:251], v[176:179], v[132:135], v[248:251]
    v_exp_f32 v148, v148
    v_exp_f32 v149, v149
    v_fma_f32 v152, v152, s48, -v9
    v_fma_f32 v153, v153, s48, -v9
    v_cvt_pk_bf16_f32 v143, v146, v147
    v_mfma_f32_16x16x32_bf16 v[240:243], v[188:191], v[124:127], v[240:243]
    v_exp_f32 v150, v150
    v_exp_f32 v151, v151
    v_fma_f32 v154, v154, s48, -v9
    v_fma_f32 v155, v155, s48, -v9
    v_cvt_pk_bf16_f32 v148, v148, v149
    v_mfma_f32_16x16x32_bf16 v[252:255], v[188:191], v[132:135], v[252:255]
    v_exp_f32 v152, v152
    v_exp_f32 v153, v153
    v_cvt_pk_bf16_f32 v149, v150, v151
    v_exp_f32 v154, v154
    v_exp_f32 v155, v155
    v_cvt_pk_bf16_f32 v150, v152, v153
    s_nop 0
    v_cvt_pk_bf16_f32 v151, v154, v155
    s_waitcnt lgkmcnt(0)
    s_nop 0
    v_mfma_f32_16x16x32_bf16 v[232:235], v[180:183], v[140:143], v[232:235]
    v_mfma_f32_16x16x32_bf16 v[244:247], v[180:183], v[148:151], v[244:247]
    v_mfma_f32_16x16x32_bf16 v[236:239], v[184:187], v[140:143], v[236:239]
    v_mfma_f32_16x16x32_bf16 v[248:251], v[184:187], v[148:151], v[248:251]
    v_mfma_f32_16x16x32_bf16 v[240:243], v[188:191], v[140:143], v[240:243]
    v_mfma_f32_16x16x32_bf16 v[252:255], v[188:191], v[148:151], v[252:255]
L_atBc_9:
    s_cmp_lg_u32 s22, 0
    s_cbranch_scc1 L_k1_g2pf
    s_cmp_eq_u32 s29, 0
    s_cbranch_scc1 L_k1_nofetch
    s_sub_u32 s23, s23, 2048
L_k1_kvpoll:
    buffer_load_dword v20, v18, s[52:55], s23 offen sc1
    s_waitcnt vmcnt(0)
    v_readfirstlane_b32 s24, v20
    s_cmp_lt_u32 s24, 8
    s_cbranch_scc1 L_k1_kvpoll
    s_lshl_b32 s24, s28, 13
    s_add_u32 s25, s35, s24
    s_sub_u32 s25, s25, 0x100000
    s_lshl_b32 s26, s33, 15
    s_add_u32 s24, s24, s26
    s_add_u32 m0, s24, 32768
    s_add_u32 s26, s25, 0
    buffer_load_dwordx4 v19, s[16:19], s26 offen offset:0 sc1 lds
    buffer_load_dwordx4 v19, s[16:19], s26 offen offset:1024 sc1 lds
    buffer_load_dwordx4 v19, s[16:19], s26 offen offset:2048 sc1 lds
    buffer_load_dwordx4 v19, s[16:19], s26 offen offset:3072 sc1 lds
    s_add_u32 m0, s24, 36864
    s_add_u32 s26, s25, 4096
    buffer_load_dwordx4 v19, s[16:19], s26 offen offset:0 sc1 lds
    buffer_load_dwordx4 v19, s[16:19], s26 offen offset:1024 sc1 lds
    buffer_load_dwordx4 v19, s[16:19], s26 offen offset:2048 sc1 lds
    buffer_load_dwordx4 v19, s[16:19], s26 offen offset:3072 sc1 lds
L_k1_nofetch:
    buffer_load_dword v22, v18, s[52:55], s27 offen sc1
    ds_read_b128 v[156:159], v12 offset:0
    ds_read_b128 v[160:163], v12 offset:1024
    ds_read_b128 v[172:175], v12 offset:2048
    ds_read_b128 v[176:179], v12 offset:3072
    ds_read_b128 v[164:167], v12 offset:4096
    ds_read_b128 v[168:171], v12 offset:5120
    s_waitcnt lgkmcnt(4)
    v_mfma_f32_16x16x32_bf16 v[28:31], v[156:159], v[192:195], 0
    v_mfma_f32_16x16x32_bf16 v[32:35], v[160:163], v[192:195], 0
    v_mfma_f32_16x16x32_bf16 v[36:39], v[156:159], v[196:199], 0
    v_mfma_f32_16x16x32_bf16 v[40:43], v[160:163], v[196:199], 0
    s_cmp_eq_u32 s20, 1
    s_cbranch_scc1 L_atAx_26
    ds_read_b128 v[156:159], v12 offset:8192
    ds_read_b128 v[160:163], v12 offset:9216
    s_waitcnt lgkmcnt(2)
    v_mfma_f32_16x16x32_bf16 v[44:47], v[164:167], v[192:195], 0
    v_cndmask_b32 v28, v28, v7, s[36:37]
    v_cndmask_b32 v29, v29, v7, s[38:39]
    v_cndmask_b32 v30, v30, v7, s[40:41]
    v_cndmask_b32 v31, v31, v7, s[42:43]
    v_max3_f32 v8, v14, v28, v29
    v_max3_f32 v8, v8, v30, v31
    v_mfma_f32_16x16x32_bf16 v[48:51], v[168:171], v[192:195], 0
    v_cndmask_b32 v32, v32, v7, s[44:45]
    v_cndmask_b32 v33, v33, v7, s[44:45]
    v_cndmask_b32 v34, v34, v7, s[44:45]
    v_cndmask_b32 v35, v35, v7, s[44:45]
    v_max3_f32 v8, v8, v32, v33
    v_max3_f32 v8, v8, v34, v35
    v_mfma_f32_16x16x32_bf16 v[52:55], v[164:167], v[196:199], 0
    v_cndmask_b32 v36, v36, v7, s[46:47]
    v_cndmask_b32 v37, v37, v7, s[46:47]
    v_cndmask_b32 v38, v38, v7, s[46:47]
    v_cndmask_b32 v39, v39, v7, s[46:47]
    v_max3_f32 v9, v15, v36, v37
    v_max3_f32 v9, v9, v38, v39
    v_mfma_f32_16x16x32_bf16 v[56:59], v[168:171], v[196:199], 0
    v_cndmask_b32 v40, v40, v7, s[36:37]
    v_cndmask_b32 v41, v41, v7, s[38:39]
    v_cndmask_b32 v42, v42, v7, s[40:41]
    v_cndmask_b32 v43, v43, v7, s[42:43]
    v_max3_f32 v9, v9, v40, v41
    v_max3_f32 v9, v9, v42, v43
    s_cmp_eq_u32 s20, 2
    s_cbranch_scc1 L_atAx_27
    ds_read_b128 v[164:167], v12 offset:12288
    ds_read_b128 v[168:171], v12 offset:13312
    s_waitcnt lgkmcnt(2)
    v_mfma_f32_16x16x32_bf16 v[60:63], v[156:159], v[192:195], 0
    v_max3_f32 v8, v8, v44, v45
    v_max3_f32 v8, v8, v46, v47
    v_mfma_f32_16x16x32_bf16 v[64:67], v[160:163], v[192:195], 0
    v_max3_f32 v8, v8, v48, v49
    v_max3_f32 v8, v8, v50, v51
    v_mfma_f32_16x16x32_bf16 v[68:71], v[156:159], v[196:199], 0
    v_max3_f32 v9, v9, v52, v53
    v_max3_f32 v9, v9, v54, v55
    v_mfma_f32_16x16x32_bf16 v[72:75], v[160:163], v[196:199], 0
    v_max3_f32 v9, v9, v56, v57
    v_max3_f32 v9, v9, v58, v59
    s_cmp_eq_u32 s20, 3
    s_cbranch_scc1 L_atAx_28
    ds_read_b128 v[156:159], v12 offset:16384
    ds_read_b128 v[160:163], v12 offset:17408
    s_waitcnt lgkmcnt(2)
    v_mfma_f32_16x16x32_bf16 v[76:79], v[164:167], v[192:195], 0
    v_max3_f32 v8, v8, v60, v61
    v_max3_f32 v8, v8, v62, v63
    v_mfma_f32_16x16x32_bf16 v[80:83], v[168:171], v[192:195], 0
    v_max3_f32 v8, v8, v64, v65
    v_max3_f32 v8, v8, v66, v67
    v_mfma_f32_16x16x32_bf16 v[84:87], v[164:167], v[196:199], 0
    v_max3_f32 v9, v9, v68, v69
    v_max3_f32 v9, v9, v70, v71
    v_mfma_f32_16x16x32_bf16 v[88:91], v[168:171], v[196:199], 0
    v_max3_f32 v9, v9, v72, v73
    v_max3_f32 v9, v9, v74, v75
    s_cmp_eq_u32 s20, 4
    s_cbranch_scc1 L_atAx_29
    ds_read_b128 v[164:167], v12 offset:20480
    ds_read_b128 v[168:171], v12 offset:21504
    s_waitcnt lgkmcnt(2)
    v_mfma_f32_16x16x32_bf16 v[92:95], v[156:159], v[192:195], 0
    v_max3_f32 v8, v8, v76, v77
    v_max3_f32 v8, v8, v78, v79
    v_mfma_f32_16x16x32_bf16 v[96:99], v[160:163], v[192:195], 0
    v_max3_f32 v8, v8, v80, v81
    v_max3_f32 v8, v8, v82, v83
    v_mfma_f32_16x16x32_bf16 v[100:103], v[156:159], v[196:199], 0
    v_max3_f32 v9, v9, v84, v85
    v_max3_f32 v9, v9, v86, v87
    v_mfma_f32_16x16x32_bf16 v[104:107], v[160:163], v[196:199], 0
    v_max3_f32 v9, v9, v88, v89
    v_max3_f32 v9, v9, v90, v91
    s_cmp_eq_u32 s20, 5
    s_cbranch_scc1 L_atAx_30
    ds_read_b128 v[156:159], v12 offset:24576
    ds_read_b128 v[160:163], v12 offset:25600
    s_waitcnt lgkmcnt(2)
    v_mfma_f32_16x16x32_bf16 v[108:111], v[164:167], v[192:195], 0
    v_max3_f32 v8, v8, v92, v93
    v_max3_f32 v8, v8, v94, v95
    v_mfma_f32_16x16x32_bf16 v[112:115], v[168:171], v[192:195], 0
    v_max3_f32 v8, v8, v96, v97
    v_max3_f32 v8, v8, v98, v99
    v_mfma_f32_16x16x32_bf16 v[116:119], v[164:167], v[196:199], 0
    v_max3_f32 v9, v9, v100, v101
    v_max3_f32 v9, v9, v102, v103
    v_mfma_f32_16x16x32_bf16 v[120:123], v[168:171], v[196:199], 0
    v_max3_f32 v9, v9, v104, v105
    v_max3_f32 v9, v9, v106, v107
    s_cmp_eq_u32 s20, 6
    s_cbranch_scc1 L_atAx_31
    ds_read_b128 v[164:167], v12 offset:28672
    ds_read_b128 v[168:171], v12 offset:29696
    s_waitcnt lgkmcnt(2)
    v_mfma_f32_16x16x32_bf16 v[124:127], v[156:159], v[192:195], 0
    v_max3_f32 v8, v8, v108, v109
    v_max3_f32 v8, v8, v110, v111
    v_mfma_f32_16x16x32_bf16 v[128:131], v[160:163], v[192:195], 0
    v_max3_f32 v8, v8, v112, v113
    v_max3_f32 v8, v8, v114, v115
    v_mfma_f32_16x16x32_bf16 v[132:135], v[156:159], v[196:199], 0
    v_max3_f32 v9, v9, v116, v117
    v_max3_f32 v9, v9, v118, v119
    v_mfma_f32_16x16x32_bf16 v[136:139], v[160:163], v[196:199], 0
    v_max3_f32 v9, v9, v120, v121
    v_max3_f32 v9, v9, v122, v123
    s_cmp_eq_u32 s20, 7
    s_cbranch_scc1 L_atAx_32
    s_waitcnt lgkmcnt(0)
    v_mfma_f32_16x16x32_bf16 v[140:143], v[164:167], v[192:195], 0
    v_max3_f32 v8, v8, v124, v125
    v_max3_f32 v8, v8, v126, v127
    v_mfma_f32_16x16x32_bf16 v[144:147], v[168:171], v[192:195], 0
    v_max3_f32 v8, v8, v128, v129
    v_max3_f32 v8, v8, v130, v131
    v_mfma_f32_16x16x32_bf16 v[148:151], v[164:167], v[196:199], 0
    v_max3_f32 v9, v9, v132, v133
    v_max3_f32 v9, v9, v134, v135
    v_mfma_f32_16x16x32_bf16 v[152:155], v[168:171], v[196:199], 0
    v_max3_f32 v9, v9, v136, v137
    v_max3_f32 v9, v9, v138, v139
    s_nop 5
    v_max3_f32 v8, v8, v140, v141
    v_max3_f32 v8, v8, v142, v143
    v_max3_f32 v8, v8, v144, v145
    v_max3_f32 v8, v8, v146, v147
    v_max3_f32 v9, v9, v148, v149
    v_max3_f32 v9, v9, v150, v151
    v_max3_f32 v9, v9, v152, v153
    v_max3_f32 v9, v9, v154, v155
L_atAb_24:
    v_mov_b32 v10, v8
    v_mov_b32 v11, v9
    s_nop 0
    v_permlane16_swap_b32 v8, v10
    v_permlane16_swap_b32 v9, v11
    v_max_f32 v8, v8, v10
    v_max_f32 v9, v9, v11
    v_mov_b32 v10, v8
    v_mov_b32 v11, v9
    s_nop 0
    v_permlane32_swap_b32 v8, v10
    v_permlane32_swap_b32 v9, v11
    v_max_f32 v8, v8, v10
    v_max_f32 v9, v9, v11
    v_sub_f32 v10, v14, v8
    v_mul_f32 v10, s48, v10
    v_exp_f32 v10, v10
    v_mov_b32 v14, v8
    v_mul_f32 v8, s48, v8
    v_sub_f32 v11, v15, v9
    v_mul_f32 v11, s48, v11
    v_exp_f32 v11, v11
    v_mov_b32 v15, v9
    v_mul_f32 v9, s48, v9
    v_mul_f32 v208, v208, v10
    v_mul_f32 v209, v209, v10
    v_mul_f32 v210, v210, v10
    v_mul_f32 v211, v211, v10
    v_mul_f32 v212, v212, v10
    v_mul_f32 v213, v213, v10
    v_mul_f32 v214, v214, v10
    v_mul_f32 v215, v215, v10
    v_mul_f32 v216, v216, v10
    v_mul_f32 v217, v217, v10
    v_mul_f32 v218, v218, v10
    v_mul_f32 v219, v219, v10
    v_mul_f32 v220, v220, v11
    v_mul_f32 v221, v221, v11
    v_mul_f32 v222, v222, v11
    v_mul_f32 v223, v223, v11
    v_mul_f32 v224, v224, v11
    v_mul_f32 v225, v225, v11
    v_mul_f32 v226, v226, v11
    v_mul_f32 v227, v227, v11
    v_mul_f32 v228, v228, v11
    v_mul_f32 v229, v229, v11
    v_mul_f32 v230, v230, v11
    v_mul_f32 v231, v231, v11
    v_fma_f32 v28, v28, s48, -v8
    v_fma_f32 v29, v29, s48, -v8
    v_fma_f32 v30, v30, s48, -v8
    v_fma_f32 v31, v31, s48, -v8
    v_exp_f32 v28, v28
    v_exp_f32 v29, v29
    v_fma_f32 v32, v32, s48, -v8
    v_fma_f32 v33, v33, s48, -v8
    v_exp_f32 v30, v30
    v_exp_f32 v31, v31
    v_fma_f32 v34, v34, s48, -v8
    v_fma_f32 v35, v35, s48, -v8
    v_cvt_pk_bf16_f32 v28, v28, v29
    v_exp_f32 v32, v32
    v_exp_f32 v33, v33
    v_fma_f32 v36, v36, s48, -v9
    v_fma_f32 v37, v37, s48, -v9
    v_cvt_pk_bf16_f32 v29, v30, v31
    v_exp_f32 v34, v34
    v_exp_f32 v35, v35
    v_fma_f32 v38, v38, s48, -v9
    v_fma_f32 v39, v39, s48, -v9
    v_cvt_pk_bf16_f32 v30, v32, v33
    v_exp_f32 v36, v36
    v_exp_f32 v37, v37
    v_fma_f32 v40, v40, s48, -v9
    v_fma_f32 v41, v41, s48, -v9
    v_cvt_pk_bf16_f32 v31, v34, v35
    v_exp_f32 v38, v38
    v_exp_f32 v39, v39
    v_fma_f32 v42, v42, s48, -v9
    v_fma_f32 v43, v43, s48, -v9
    v_cvt_pk_bf16_f32 v36, v36, v37
    v_exp_f32 v40, v40
    v_exp_f32 v41, v41
    v_cvt_pk_bf16_f32 v37, v38, v39
    v_exp_f32 v42, v42
    v_exp_f32 v43, v43
    v_cvt_pk_bf16_f32 v38, v40, v41
    s_nop 0
    v_cvt_pk_bf16_f32 v39, v42, v43
    s_cmp_eq_u32 s20, 1
    s_cbranch_scc1 L_atAy_33
    ds_read_b128 v[180:183], v12 offset:6144
    ds_read_b128 v[184:187], v12 offset:7168
    v_fma_f32 v44, v44, s48, -v8
    v_fma_f32 v45, v45, s48, -v8
    v_fma_f32 v46, v46, s48, -v8
    v_fma_f32 v47, v47, s48, -v8
    s_waitcnt lgkmcnt(2)
    v_exp_f32 v44, v44
    v_exp_f32 v45, v45
    v_fma_f32 v48, v48, s48, -v8
    v_fma_f32 v49, v49, s48, -v8
    v_mfma_f32_16x16x32_bf16 v[208:211], v[172:175], v[28:31], v[208:211]
    v_exp_f32 v46, v46
    v_exp_f32 v47, v47
    v_fma_f32 v50, v50, s48, -v8
    v_fma_f32 v51, v51, s48, -v8
    v_cvt_pk_bf16_f32 v44, v44, v45
    v_mfma_f32_16x16x32_bf16 v[220:223], v[172:175], v[36:39], v[220:223]
    v_exp_f32 v48, v48
    v_exp_f32 v49, v49
    v_fma_f32 v52, v52, s48, -v9
    v_fma_f32 v53, v53, s48, -v9
    v_cvt_pk_bf16_f32 v45, v46, v47
    v_mfma_f32_16x16x32_bf16 v[212:215], v[176:179], v[28:31], v[212:215]
    v_exp_f32 v50, v50
    v_exp_f32 v51, v51
    v_fma_f32 v54, v54, s48, -v9
    v_fma_f32 v55, v55, s48, -v9
    v_cvt_pk_bf16_f32 v46, v48, v49
    v_mfma_f32_16x16x32_bf16 v[224:227], v[176:179], v[36:39], v[224:227]
    v_exp_f32 v52, v52
    v_exp_f32 v53, v53
    v_fma_f32 v56, v56, s48, -v9
    v_fma_f32 v57, v57, s48, -v9
    v_cvt_pk_bf16_f32 v47, v50, v51
    v_mfma_f32_16x16x32_bf16 v[216:219], v[188:191], v[28:31], v[216:219]
    v_exp_f32 v54, v54
    v_exp_f32 v55, v55
    v_fma_f32 v58, v58, s48, -v9
    v_fma_f32 v59, v59, s48, -v9
    v_cvt_pk_bf16_f32 v52, v52, v53
    v_mfma_f32_16x16x32_bf16 v[228:231], v[188:191], v[36:39], v[228:231]
    v_exp_f32 v56, v56
    v_exp_f32 v57, v57
    v_cvt_pk_bf16_f32 v53, v54, v55
    v_exp_f32 v58, v58
    v_exp_f32 v59, v59
    v_cvt_pk_bf16_f32 v54, v56, v57
    s_nop 0
    v_cvt_pk_bf16_f32 v55, v58, v59
    s_cmp_eq_u32 s20, 2
    s_cbranch_scc1 L_atAy_34
    ds_read_b128 v[172:175], v12 offset:10240
    ds_read_b128 v[176:179], v12 offset:11264
    v_fma_f32 v60, v60, s48, -v8
    v_fma_f32 v61, v61, s48, -v8
    v_fma_f32 v62, v62, s48, -v8
    v_fma_f32 v63, v63, s48, -v8
    s_waitcnt lgkmcnt(2)
    v_exp_f32 v60, v60
    v_exp_f32 v61, v61
    v_fma_f32 v64, v64, s48, -v8
    v_fma_f32 v65, v65, s48, -v8
    v_mfma_f32_16x16x32_bf16 v[208:211], v[180:183], v[44:47], v[208:211]
    v_exp_f32 v62, v62
    v_exp_f32 v63, v63
    v_fma_f32 v66, v66, s48, -v8
    v_fma_f32 v67, v67, s48, -v8
    v_cvt_pk_bf16_f32 v60, v60, v61
    v_mfma_f32_16x16x32_bf16 v[220:223], v[180:183], v[52:55], v[220:223]
    v_exp_f32 v64, v64
    v_exp_f32 v65, v65
    v_fma_f32 v68, v68, s48, -v9
    v_fma_f32 v69, v69, s48, -v9
    v_cvt_pk_bf16_f32 v61, v62, v63
    v_mfma_f32_16x16x32_bf16 v[212:215], v[184:187], v[44:47], v[212:215]
    v_exp_f32 v66, v66
    v_exp_f32 v67, v67
    v_fma_f32 v70, v70, s48, -v9
    v_fma_f32 v71, v71, s48, -v9
    v_cvt_pk_bf16_f32 v62, v64, v65
    v_mfma_f32_16x16x32_bf16 v[224:227], v[184:187], v[52:55], v[224:227]
    v_exp_f32 v68, v68
    v_exp_f32 v69, v69
    v_fma_f32 v72, v72, s48, -v9
    v_fma_f32 v73, v73, s48, -v9
    v_cvt_pk_bf16_f32 v63, v66, v67
    v_mfma_f32_16x16x32_bf16 v[216:219], v[188:191], v[44:47], v[216:219]
    v_exp_f32 v70, v70
    v_exp_f32 v71, v71
    v_fma_f32 v74, v74, s48, -v9
    v_fma_f32 v75, v75, s48, -v9
    v_cvt_pk_bf16_f32 v68, v68, v69
    v_mfma_f32_16x16x32_bf16 v[228:231], v[188:191], v[52:55], v[228:231]
    v_exp_f32 v72, v72
    v_exp_f32 v73, v73
    v_cvt_pk_bf16_f32 v69, v70, v71
    v_exp_f32 v74, v74
    v_exp_f32 v75, v75
    v_cvt_pk_bf16_f32 v70, v72, v73
    s_nop 0
    v_cvt_pk_bf16_f32 v71, v74, v75
    s_cmp_eq_u32 s20, 3
    s_cbranch_scc1 L_atAy_35
    ds_read_b128 v[180:183], v12 offset:14336
    ds_read_b128 v[184:187], v12 offset:15360
    v_fma_f32 v76, v76, s48, -v8
    v_fma_f32 v77, v77, s48, -v8
    v_fma_f32 v78, v78, s48, -v8
    v_fma_f32 v79, v79, s48, -v8
    s_waitcnt lgkmcnt(2)
    v_exp_f32 v76, v76
    v_exp_f32 v77, v77
    v_fma_f32 v80, v80, s48, -v8
    v_fma_f32 v81, v81, s48, -v8
    v_mfma_f32_16x16x32_bf16 v[208:211], v[172:175], v[60:63], v[208:211]
    v_exp_f32 v78, v78
    v_exp_f32 v79, v79
    v_fma_f32 v82, v82, s48, -v8
    v_fma_f32 v83, v83, s48, -v8
    v_cvt_pk_bf16_f32 v76, v76, v77
    v_mfma_f32_16x16x32_bf16 v[220:223], v[172:175], v[68:71], v[220:223]
    v_exp_f32 v80, v80
    v_exp_f32 v81, v81
    v_fma_f32 v84, v84, s48, -v9
    v_fma_f32 v85, v85, s48, -v9
    v_cvt_pk_bf16_f32 v77, v78, v79
    v_mfma_f32_16x16x32_bf16 v[212:215], v[176:179], v[60:63], v[212:215]
    v_exp_f32 v82, v82
    v_exp_f32 v83, v83
    v_fma_f32 v86, v86, s48, -v9
    v_fma_f32 v87, v87, s48, -v9
    v_cvt_pk_bf16_f32 v78, v80, v81
    v_mfma_f32_16x16x32_bf16 v[224:227], v[176:179], v[68:71], v[224:227]
    v_exp_f32 v84, v84
    v_exp_f32 v85, v85
    v_fma_f32 v88, v88, s48, -v9
    v_fma_f32 v89, v89, s48, -v9
    v_cvt_pk_bf16_f32 v79, v82, v83
    v_mfma_f32_16x16x32_bf16 v[216:219], v[188:191], v[60:63], v[216:219]
    v_exp_f32 v86, v86
    v_exp_f32 v87, v87
    v_fma_f32 v90, v90, s48, -v9
    v_fma_f32 v91, v91, s48, -v9
    v_cvt_pk_bf16_f32 v84, v84, v85
    v_mfma_f32_16x16x32_bf16 v[228:231], v[188:191], v[68:71], v[228:231]
    v_exp_f32 v88, v88
    v_exp_f32 v89, v89
    v_cvt_pk_bf16_f32 v85, v86, v87
    v_exp_f32 v90, v90
    v_exp_f32 v91, v91
    v_cvt_pk_bf16_f32 v86, v88, v89
    s_nop 0
    v_cvt_pk_bf16_f32 v87, v90, v91
    s_cmp_eq_u32 s20, 4
    s_cbranch_scc1 L_atAy_36
    ds_read_b128 v[172:175], v12 offset:18432
    ds_read_b128 v[176:179], v12 offset:19456
    v_fma_f32 v92, v92, s48, -v8
    v_fma_f32 v93, v93, s48, -v8
    v_fma_f32 v94, v94, s48, -v8
    v_fma_f32 v95, v95, s48, -v8
    s_waitcnt lgkmcnt(2)
    v_exp_f32 v92, v92
    v_exp_f32 v93, v93
    v_fma_f32 v96, v96, s48, -v8
    v_fma_f32 v97, v97, s48, -v8
    v_mfma_f32_16x16x32_bf16 v[208:211], v[180:183], v[76:79], v[208:211]
    v_exp_f32 v94, v94
    v_exp_f32 v95, v95
    v_fma_f32 v98, v98, s48, -v8
    v_fma_f32 v99, v99, s48, -v8
    v_cvt_pk_bf16_f32 v92, v92, v93
    v_mfma_f32_16x16x32_bf16 v[220:223], v[180:183], v[84:87], v[220:223]
    v_exp_f32 v96, v96
    v_exp_f32 v97, v97
    v_fma_f32 v100, v100, s48, -v9
    v_fma_f32 v101, v101, s48, -v9
    v_cvt_pk_bf16_f32 v93, v94, v95
    v_mfma_f32_16x16x32_bf16 v[212:215], v[184:187], v[76:79], v[212:215]
    v_exp_f32 v98, v98
    v_exp_f32 v99, v99
    v_fma_f32 v102, v102, s48, -v9
    v_fma_f32 v103, v103, s48, -v9
    v_cvt_pk_bf16_f32 v94, v96, v97
    v_mfma_f32_16x16x32_bf16 v[224:227], v[184:187], v[84:87], v[224:227]
    v_exp_f32 v100, v100
    v_exp_f32 v101, v101
    v_fma_f32 v104, v104, s48, -v9
    v_fma_f32 v105, v105, s48, -v9
    v_cvt_pk_bf16_f32 v95, v98, v99
    v_mfma_f32_16x16x32_bf16 v[216:219], v[188:191], v[76:79], v[216:219]
    v_exp_f32 v102, v102
    v_exp_f32 v103, v103
    v_fma_f32 v106, v106, s48, -v9
    v_fma_f32 v107, v107, s48, -v9
    v_cvt_pk_bf16_f32 v100, v100, v101
    v_mfma_f32_16x16x32_bf16 v[228:231], v[188:191], v[84:87], v[228:231]
    v_exp_f32 v104, v104
    v_exp_f32 v105, v105
    v_cvt_pk_bf16_f32 v101, v102, v103
    v_exp_f32 v106, v106
    v_exp_f32 v107, v107
    v_cvt_pk_bf16_f32 v102, v104, v105
    s_nop 0
    v_cvt_pk_bf16_f32 v103, v106, v107
    s_cmp_eq_u32 s20, 5
    s_cbranch_scc1 L_atAy_37
    ds_read_b128 v[180:183], v12 offset:22528
    ds_read_b128 v[184:187], v12 offset:23552
    v_fma_f32 v108, v108, s48, -v8
    v_fma_f32 v109, v109, s48, -v8
    v_fma_f32 v110, v110, s48, -v8
    v_fma_f32 v111, v111, s48, -v8
    s_waitcnt lgkmcnt(2)
    v_exp_f32 v108, v108
    v_exp_f32 v109, v109
    v_fma_f32 v112, v112, s48, -v8
    v_fma_f32 v113, v113, s48, -v8
    v_mfma_f32_16x16x32_bf16 v[208:211], v[172:175], v[92:95], v[208:211]
    v_exp_f32 v110, v110
    v_exp_f32 v111, v111
    v_fma_f32 v114, v114, s48, -v8
    v_fma_f32 v115, v115, s48, -v8
    v_cvt_pk_bf16_f32 v108, v108, v109
    v_mfma_f32_16x16x32_bf16 v[220:223], v[172:175], v[100:103], v[220:223]
    v_exp_f32 v112, v112
    v_exp_f32 v113, v113
    v_fma_f32 v116, v116, s48, -v9
    v_fma_f32 v117, v117, s48, -v9
    v_cvt_pk_bf16_f32 v109, v110, v111
    v_mfma_f32_16x16x32_bf16 v[212:215], v[176:179], v[92:95], v[212:215]
    v_exp_f32 v114, v114
    v_exp_f32 v115, v115
    v_fma_f32 v118, v118, s48, -v9
    v_fma_f32 v119, v119, s48, -v9
    v_cvt_pk_bf16_f32 v110, v112, v113
    v_mfma_f32_16x16x32_bf16 v[224:227], v[176:179], v[100:103], v[224:227]
    v_exp_f32 v116, v116
    v_exp_f32 v117, v117
    v_fma_f32 v120, v120, s48, -v9
    v_fma_f32 v121, v121, s48, -v9
    v_cvt_pk_bf16_f32 v111, v114, v115
    v_mfma_f32_16x16x32_bf16 v[216:219], v[188:191], v[92:95], v[216:219]
    v_exp_f32 v118, v118
    v_exp_f32 v119, v119
    v_fma_f32 v122, v122, s48, -v9
    v_fma_f32 v123, v123, s48, -v9
    v_cvt_pk_bf16_f32 v116, v116, v117
    v_mfma_f32_16x16x32_bf16 v[228:231], v[188:191], v[100:103], v[228:231]
    v_exp_f32 v120, v120
    v_exp_f32 v121, v121
    v_cvt_pk_bf16_f32 v117, v118, v119
    v_exp_f32 v122, v122
    v_exp_f32 v123, v123
    v_cvt_pk_bf16_f32 v118, v120, v121
    s_nop 0
    v_cvt_pk_bf16_f32 v119, v122, v123
    s_cmp_eq_u32 s20, 6
    s_cbranch_scc1 L_atAy_38
    ds_read_b128 v[172:175], v12 offset:26624
    ds_read_b128 v[176:179], v12 offset:27648
    v_fma_f32 v124, v124, s48, -v8
    v_fma_f32 v125, v125, s48, -v8
    v_fma_f32 v126, v126, s48, -v8
    v_fma_f32 v127, v127, s48, -v8
    s_waitcnt lgkmcnt(2)
    v_exp_f32 v124, v124
    v_exp_f32 v125, v125
    v_fma_f32 v128, v128, s48, -v8
    v_fma_f32 v129, v129, s48, -v8
    v_mfma_f32_16x16x32_bf16 v[208:211], v[180:183], v[108:111], v[208:211]
    v_exp_f32 v126, v126
    v_exp_f32 v127, v127
    v_fma_f32 v130, v130, s48, -v8
    v_fma_f32 v131, v131, s48, -v8
    v_cvt_pk_bf16_f32 v124, v124, v125
    v_mfma_f32_16x16x32_bf16 v[220:223], v[180:183], v[116:119], v[220:223]
    v_exp_f32 v128, v128
    v_exp_f32 v129, v129
    v_fma_f32 v132, v132, s48, -v9
    v_fma_f32 v133, v133, s48, -v9
    v_cvt_pk_bf16_f32 v125, v126, v127
    v_mfma_f32_16x16x32_bf16 v[212:215], v[184:187], v[108:111], v[212:215]
    v_exp_f32 v130, v130
    v_exp_f32 v131, v131
    v_fma_f32 v134, v134, s48, -v9
    v_fma_f32 v135, v135, s48, -v9
    v_cvt_pk_bf16_f32 v126, v128, v129
    v_mfma_f32_16x16x32_bf16 v[224:227], v[184:187], v[116:119], v[224:227]
    v_exp_f32 v132, v132
    v_exp_f32 v133, v133
    v_fma_f32 v136, v136, s48, -v9
    v_fma_f32 v137, v137, s48, -v9
    v_cvt_pk_bf16_f32 v127, v130, v131
    v_mfma_f32_16x16x32_bf16 v[216:219], v[188:191], v[108:111], v[216:219]
    v_exp_f32 v134, v134
    v_exp_f32 v135, v135
    v_fma_f32 v138, v138, s48, -v9
    v_fma_f32 v139, v139, s48, -v9
    v_cvt_pk_bf16_f32 v132, v132, v133
    v_mfma_f32_16x16x32_bf16 v[228:231], v[188:191], v[116:119], v[228:231]
    v_exp_f32 v136, v136
    v_exp_f32 v137, v137
    v_cvt_pk_bf16_f32 v133, v134, v135
    v_exp_f32 v138, v138
    v_exp_f32 v139, v139
    v_cvt_pk_bf16_f32 v134, v136, v137
    s_nop 0
    v_cvt_pk_bf16_f32 v135, v138, v139
    s_cmp_eq_u32 s20, 7
    s_cbranch_scc1 L_atAy_39
    ds_read_b128 v[180:183], v12 offset:30720
    ds_read_b128 v[184:187], v12 offset:31744
    v_fma_f32 v140, v140, s48, -v8
    v_fma_f32 v141, v141, s48, -v8
    v_fma_f32 v142, v142, s48, -v8
    v_fma_f32 v143, v143, s48, -v8
    s_waitcnt lgkmcnt(2)
    v_exp_f32 v140, v140
    v_exp_f32 v141, v141
    v_fma_f32 v144, v144, s48, -v8
    v_fma_f32 v145, v145, s48, -v8
    v_mfma_f32_16x16x32_bf16 v[208:211], v[172:175], v[124:127], v[208:211]
    v_exp_f32 v142, v142
    v_exp_f32 v143, v143
    v_fma_f32 v146, v146, s48, -v8
    v_fma_f32 v147, v147, s48, -v8
    v_cvt_pk_bf16_f32 v140, v140, v141
    v_mfma_f32_16x16x32_bf16 v[220:223], v[172:175], v[132:135], v[220:223]
    v_exp_f32 v144, v144
    v_exp_f32 v145, v145
    v_fma_f32 v148, v148, s48, -v9
    v_fma_f32 v149, v149, s48, -v9
    v_cvt_pk_bf16_f32 v141, v142, v143
    v_mfma_f32_16x16x32_bf16 v[212:215], v[176:179], v[124:127], v[212:215]
    v_exp_f32 v146, v146
    v_exp_f32 v147, v147
    v_fma_f32 v150, v150, s48, -v9
    v_fma_f32 v151, v151, s48, -v9
    v_cvt_pk_bf16_f32 v142, v144, v145
    v_mfma_f32_16x16x32_bf16 v[224:227], v[176:179], v[132:135], v[224:227]
    v_exp_f32 v148, v148
    v_exp_f32 v149, v149
    v_fma_f32 v152, v152, s48, -v9
    v_fma_f32 v153, v153, s48, -v9
    v_cvt_pk_bf16_f32 v143, v146, v147
    v_mfma_f32_16x16x32_bf16 v[216:219], v[188:191], v[124:127], v[216:219]
    v_exp_f32 v150, v150
    v_exp_f32 v151, v151
    v_fma_f32 v154, v154, s48, -v9
    v_fma_f32 v155, v155, s48, -v9
    v_cvt_pk_bf16_f32 v148, v148, v149
    v_mfma_f32_16x16x32_bf16 v[228:231], v[188:191], v[132:135], v[228:231]
    v_exp_f32 v152, v152
    v_exp_f32 v153, v153
    v_cvt_pk_bf16_f32 v149, v150, v151
    v_exp_f32 v154, v154
    v_exp_f32 v155, v155
    v_cvt_pk_bf16_f32 v150, v152, v153
    s_nop 0
    v_cvt_pk_bf16_f32 v151, v154, v155
    s_waitcnt lgkmcnt(0)
    s_nop 0
    v_mfma_f32_16x16x32_bf16 v[208:211], v[180:183], v[140:143], v[208:211]
    v_mfma_f32_16x16x32_bf16 v[220:223], v[180:183], v[148:151], v[220:223]
    v_mfma_f32_16x16x32_bf16 v[212:215], v[184:187], v[140:143], v[212:215]
    v_mfma_f32_16x16x32_bf16 v[224:227], v[184:187], v[148:151], v[224:227]
    v_mfma_f32_16x16x32_bf16 v[216:219], v[188:191], v[140:143], v[216:219]
    v_mfma_f32_16x16x32_bf16 v[228:231], v[188:191], v[148:151], v[228:231]
L_atAc_25:
    s_cmp_lg_u32 s22, 0
    s_cbranch_scc1 L_k1_atdone
    s_cmp_eq_u32 s29, 0
    s_cbranch_scc1 L_k1_atdone
    s_mov_b32 s22, 1
    s_not_b64 s[36:37], s[36:37]
    s_not_b64 s[38:39], s[38:39]
    s_not_b64 s[40:41], s[40:41]
    s_not_b64 s[42:43], s[42:43]
    s_not_b64 s[44:45], s[44:45]
    s_not_b64 s[46:47], s[46:47]
    s_mov_b32 s24, s20
    s_mov_b32 s20, s21
    s_mov_b32 s21, s24
    v_add_u32 v8, 32768, v12
    v_add_u32 v12, 32768, v13
    v_mov_b32 v13, v8
    s_waitcnt vmcnt(0)
    s_barrier
    s_branch L_k1_part
L_k1_g2pf:
    s_cmp_lt_u32 s28, 4
    s_cbranch_scc1 L_k1_nofetch
    buffer_load_dword v22, v18, s[52:55], s27 offen sc1
    s_sub_u32 s35, s28, 4
    s_lshr_b32 s56, s35, 1
    s_lshl_b32 s56, s56, 17
    s_lshl_b32 s34, s29, 14
    s_add_u32 s56, s56, s34
    s_and_b32 s34, s30, 4
    s_lshl_b32 s34, s34, 11
    s_add_u32 s56, s56, s34
    s_and_b32 s34, s35, 1
    s_lshl_b32 s34, s34, 12
    s_add_u32 s56, s56, s34
    v_lshrrev_b32 v25, 3, v1
    v_lshlrev_b32 v25, 11, v25
    v_bfe_u32 v21, v1, 4, 2
    v_lshlrev_b32 v21, 1, v21
    v_and_b32 v23, 7, v1
    v_xor_b32 v21, v21, v23
    v_lshl_add_u32 v25, v21, 4, v25
    s_lshl_b32 s34, s35, 15
    s_and_b32 s57, s30, 8
    s_lshl_b32 s57, s57, 7
    s_add_u32 s34, s34, s57
    s_and_b32 s57, s30, 3
    s_lshl_b32 s57, s57, 8
    s_add_u32 s34, s34, s57
    v_add_u32 v24, s34, v25
    v_add_u32 v25, 128, v24
    v_add_u32 v26, 14336, v24
    v_add_u32 v27, 14464, v24
    s_lshr_b32 s34, s30, 2
    s_mul_i32 s34, s34, 14
    s_mul_i32 s57, s31, 36
    s_add_u32 s57, s57, s34
    s_cmp_ge_u32 s57, 56
    s_cselect_b32 s34, 56, 0
    s_sub_u32 s57, s57, s34
    s_add_u32 s59, s56, 0xe00000
    s_lshl_b32 s34, s57, 18
    s_add_u32 s56, s56, s34
    s_lshl_b32 s57, s57, 17
    s_lshl_b32 s35, s35, 12
    s_mov_b32 s8, s90
    s_mov_b32 s9, s91
    s_mov_b32 s10, 0x700000
    s_mov_b32 s11, 0x00020000
    s_mov_b32 s58, 0xe00000
    s_waitcnt vmcnt(0)
    v_readfirstlane_b32 s24, v22
    s_cmp_lt_u32 s24, 16
    s_cbranch_scc1 L_k1_nofetch
    s_mov_b32 s68, 1
    s_add_u32 m0, s35, 16384
    s_nop 0
    buffer_load_dwordx4 v24, s[8:11], s57 offen offset:0 lds
    buffer_load_dwordx4 v26, s[8:11], s57 offen offset:2048 lds
    s_add_u32 m0, s35, 17408
    s_nop 0
    buffer_load_dwordx4 v25, s[8:11], s57 offen offset:0 lds
    buffer_load_dwordx4 v27, s[8:11], s57 offen offset:2048 lds
    s_add_u32 s57, s57, 0x20000
    s_cmp_eq_u32 s57, 0x700000
    s_cselect_b32 s57, 0, s57
    s_add_u32 m0, s35, 0
    s_nop 0
    buffer_load_dwordx4 v19, s[12:15], s56 offen offset:0 lds
    buffer_load_dwordx4 v19, s[12:15], s56 offen offset:1024 lds
    buffer_load_dwordx4 v19, s[12:15], s56 offen offset:2048 lds
    buffer_load_dwordx4 v19, s[12:15], s56 offen offset:3072 lds
    s_add_u32 s56, s56, 0x40000
    s_cmp_ge_u32 s56, s58
    s_cselect_b32 s34, s58, 0
    s_sub_u32 s56, s56, s34
    s_add_u32 m0, s35, 81920
    s_nop 0
    buffer_load_dwordx4 v24, s[8:11], s57 offen offset:0 lds
    buffer_load_dwordx4 v26, s[8:11], s57 offen offset:2048 lds
    s_add_u32 m0, s35, 82944
    s_nop 0
    buffer_load_dwordx4 v25, s[8:11], s57 offen offset:0 lds
    buffer_load_dwordx4 v27, s[8:11], s57 offen offset:2048 lds
    s_add_u32 s57, s57, 0x20000
    s_cmp_eq_u32 s57, 0x700000
    s_cselect_b32 s57, 0, s57
    s_add_u32 m0, s35, 65536
    s_nop 0
    buffer_load_dwordx4 v19, s[12:15], s56 offen offset:0 lds
    buffer_load_dwordx4 v19, s[12:15], s56 offen offset:1024 lds
    buffer_load_dwordx4 v19, s[12:15], s56 offen offset:2048 lds
    buffer_load_dwordx4 v19, s[12:15], s56 offen offset:3072 lds
    s_add_u32 s56, s56, 0x40000
    s_cmp_ge_u32 s56, s58
    s_cselect_b32 s34, s58, 0
    s_sub_u32 s56, s56, s34
    s_branch L_k1_nofetch
L_atBx_10:
    s_nop 7
    v_cndmask_b32 v28, v28, v7, s[36:37]
    v_cndmask_b32 v29, v29, v7, s[38:39]
    v_cndmask_b32 v30, v30, v7, s[40:41]
    v_cndmask_b32 v31, v31, v7, s[42:43]
    v_max3_f32 v8, v16, v28, v29
    v_max3_f32 v8, v8, v30, v31
    v_cndmask_b32 v32, v32, v7, s[44:45]
    v_cndmask_b32 v33, v33, v7, s[44:45]
    v_cndmask_b32 v34, v34, v7, s[44:45]
    v_cndmask_b32 v35, v35, v7, s[44:45]
    v_max3_f32 v8, v8, v32, v33
    v_max3_f32 v8, v8, v34, v35
    v_cndmask_b32 v36, v36, v7, s[46:47]
    v_cndmask_b32 v37, v37, v7, s[46:47]
    v_cndmask_b32 v38, v38, v7, s[46:47]
    v_cndmask_b32 v39, v39, v7, s[46:47]
    v_max3_f32 v9, v17, v36, v37
    v_max3_f32 v9, v9, v38, v39
    v_cndmask_b32 v40, v40, v7, s[36:37]
    v_cndmask_b32 v41, v41, v7, s[38:39]
    v_cndmask_b32 v42, v42, v7, s[40:41]
    v_cndmask_b32 v43, v43, v7, s[42:43]
    v_max3_f32 v9, v9, v40, v41
    v_max3_f32 v9, v9, v42, v43
    s_branch L_atBb_8
L_atBx_11:
    s_nop 5
    v_max3_f32 v8, v8, v44, v45
    v_max3_f32 v8, v8, v46, v47
    v_max3_f32 v8, v8, v48, v49
    v_max3_f32 v8, v8, v50, v51
    v_max3_f32 v9, v9, v52, v53
    v_max3_f32 v9, v9, v54, v55
    v_max3_f32 v9, v9, v56, v57
    v_max3_f32 v9, v9, v58, v59
    s_branch L_atBb_8
L_atBx_12:
    s_nop 5
    v_max3_f32 v8, v8, v60, v61
    v_max3_f32 v8, v8, v62, v63
    v_max3_f32 v8, v8, v64, v65
    v_max3_f32 v8, v8, v66, v67
    v_max3_f32 v9, v9, v68, v69
    v_max3_f32 v9, v9, v70, v71
    v_max3_f32 v9, v9, v72, v73
    v_max3_f32 v9, v9, v74, v75
    s_branch L_atBb_8
L_atBx_13:
    s_nop 5
    v_max3_f32 v8, v8, v76, v77
    v_max3_f32 v8, v8, v78, v79
    v_max3_f32 v8, v8, v80, v81
    v_max3_f32 v8, v8, v82, v83
    v_max3_f32 v9, v9, v84, v85
    v_max3_f32 v9, v9, v86, v87
    v_max3_f32 v9, v9, v88, v89
    v_max3_f32 v9, v9, v90, v91
    s_branch L_atBb_8
L_atBx_14:
    s_nop 5
    v_max3_f32 v8, v8, v92, v93
    v_max3_f32 v8, v8, v94, v95
    v_max3_f32 v8, v8, v96, v97
    v_max3_f32 v8, v8, v98, v99
    v_max3_f32 v9, v9, v100, v101
    v_max3_f32 v9, v9, v102, v103
    v_max3_f32 v9, v9, v104, v105
    v_max3_f32 v9, v9, v106, v107
    s_branch L_atBb_8
L_atBx_15:
    s_nop 5
    v_max3_f32 v8, v8, v108, v109
    v_max3_f32 v8, v8, v110, v111
    v_max3_f32 v8, v8, v112, v113
    v_max3_f32 v8, v8, v114, v115
    v_max3_f32 v9, v9, v116, v117
    v_max3_f32 v9, v9, v118, v119
    v_max3_f32 v9, v9, v120, v121
    v_max3_f32 v9, v9, v122, v123
    s_branch L_atBb_8
L_atBx_16:
    s_nop 5
    v_max3_f32 v8, v8, v124, v125
    v_max3_f32 v8, v8, v126, v127
    v_max3_f32 v8, v8, v128, v129
    v_max3_f32 v8, v8, v130, v131
    v_max3_f32 v9, v9, v132, v133
    v_max3_f32 v9, v9, v134, v135
    v_max3_f32 v9, v9, v136, v137
    v_max3_f32 v9, v9, v138, v139
    s_branch L_atBb_8
L_atBy_17:
    s_waitcnt lgkmcnt(0)
    s_nop 0
    v_mfma_f32_16x16x32_bf16 v[232:235], v[172:175], v[28:31], v[232:235]
    v_mfma_f32_16x16x32_bf16 v[244:247], v[172:175], v[36:39], v[244:247]
    v_mfma_f32_16x16x32_bf16 v[236:239], v[176:179], v[28:31], v[236:239]
    v_mfma_f32_16x16x32_bf16 v[248:251], v[176:179], v[36:39], v[248:251]
    v_mfma_f32_16x16x32_bf16 v[240:243], v[188:191], v[28:31], v[240:243]
    v_mfma_f32_16x16x32_bf16 v[252:255], v[188:191], v[36:39], v[252:255]
    s_branch L_atBc_9
L_atBy_18:
    s_waitcnt lgkmcnt(0)
    s_nop 0
    v_mfma_f32_16x16x32_bf16 v[232:235], v[180:183], v[44:47], v[232:235]
    v_mfma_f32_16x16x32_bf16 v[244:247], v[180:183], v[52:55], v[244:247]
    v_mfma_f32_16x16x32_bf16 v[236:239], v[184:187], v[44:47], v[236:239]
    v_mfma_f32_16x16x32_bf16 v[248:251], v[184:187], v[52:55], v[248:251]
    v_mfma_f32_16x16x32_bf16 v[240:243], v[188:191], v[44:47], v[240:243]
    v_mfma_f32_16x16x32_bf16 v[252:255], v[188:191], v[52:55], v[252:255]
    s_branch L_atBc_9
L_atBy_19:
    s_waitcnt lgkmcnt(0)
    s_nop 0
    v_mfma_f32_16x16x32_bf16 v[232:235], v[172:175], v[60:63], v[232:235]
    v_mfma_f32_16x16x32_bf16 v[244:247], v[172:175], v[68:71], v[244:247]
    v_mfma_f32_16x16x32_bf16 v[236:239], v[176:179], v[60:63], v[236:239]
    v_mfma_f32_16x16x32_bf16 v[248:251], v[176:179], v[68:71], v[248:251]
    v_mfma_f32_16x16x32_bf16 v[240:243], v[188:191], v[60:63], v[240:243]
    v_mfma_f32_16x16x32_bf16 v[252:255], v[188:191], v[68:71], v[252:255]
    s_branch L_atBc_9
L_atBy_20:
    s_waitcnt lgkmcnt(0)
    s_nop 0
    v_mfma_f32_16x16x32_bf16 v[232:235], v[180:183], v[76:79], v[232:235]
    v_mfma_f32_16x16x32_bf16 v[244:247], v[180:183], v[84:87], v[244:247]
    v_mfma_f32_16x16x32_bf16 v[236:239], v[184:187], v[76:79], v[236:239]
    v_mfma_f32_16x16x32_bf16 v[248:251], v[184:187], v[84:87], v[248:251]
    v_mfma_f32_16x16x32_bf16 v[240:243], v[188:191], v[76:79], v[240:243]
    v_mfma_f32_16x16x32_bf16 v[252:255], v[188:191], v[84:87], v[252:255]
    s_branch L_atBc_9
L_atBy_21:
    s_waitcnt lgkmcnt(0)
    s_nop 0
    v_mfma_f32_16x16x32_bf16 v[232:235], v[172:175], v[92:95], v[232:235]
    v_mfma_f32_16x16x32_bf16 v[244:247], v[172:175], v[100:103], v[244:247]
    v_mfma_f32_16x16x32_bf16 v[236:239], v[176:179], v[92:95], v[236:239]
    v_mfma_f32_16x16x32_bf16 v[248:251], v[176:179], v[100:103], v[248:251]
    v_mfma_f32_16x16x32_bf16 v[240:243], v[188:191], v[92:95], v[240:243]
    v_mfma_f32_16x16x32_bf16 v[252:255], v[188:191], v[100:103], v[252:255]
    s_branch L_atBc_9
L_atBy_22:
    s_waitcnt lgkmcnt(0)
    s_nop 0
    v_mfma_f32_16x16x32_bf16 v[232:235], v[180:183], v[108:111], v[232:235]
    v_mfma_f32_16x16x32_bf16 v[244:247], v[180:183], v[116:119], v[244:247]
    v_mfma_f32_16x16x32_bf16 v[236:239], v[184:187], v[108:111], v[236:239]
    v_mfma_f32_16x16x32_bf16 v[248:251], v[184:187], v[116:119], v[248:251]
    v_mfma_f32_16x16x32_bf16 v[240:243], v[188:191], v[108:111], v[240:243]
    v_mfma_f32_16x16x32_bf16 v[252:255], v[188:191], v[116:119], v[252:255]
    s_branch L_atBc_9
L_atBy_23:
    s_waitcnt lgkmcnt(0)
    s_nop 0
    v_mfma_f32_16x16x32_bf16 v[232:235], v[172:175], v[124:127], v[232:235]
    v_mfma_f32_16x16x32_bf16 v[244:247], v[172:175], v[132:135], v[244:247]
    v_mfma_f32_16x16x32_bf16 v[236:239], v[176:179], v[124:127], v[236:239]
    v_mfma_f32_16x16x32_bf16 v[248:251], v[176:179], v[132:135], v[248:251]
    v_mfma_f32_16x16x32_bf16 v[240:243], v[188:191], v[124:127], v[240:243]
    v_mfma_f32_16x16x32_bf16 v[252:255], v[188:191], v[132:135], v[252:255]
    s_branch L_atBc_9
L_atAx_26:
    s_nop 7
    v_cndmask_b32 v28, v28, v7, s[36:37]
    v_cndmask_b32 v29, v29, v7, s[38:39]
    v_cndmask_b32 v30, v30, v7, s[40:41]
    v_cndmask_b32 v31, v31, v7, s[42:43]
    v_max3_f32 v8, v14, v28, v29
    v_max3_f32 v8, v8, v30, v31
    v_cndmask_b32 v32, v32, v7, s[44:45]
    v_cndmask_b32 v33, v33, v7, s[44:45]
    v_cndmask_b32 v34, v34, v7, s[44:45]
    v_cndmask_b32 v35, v35, v7, s[44:45]
    v_max3_f32 v8, v8, v32, v33
    v_max3_f32 v8, v8, v34, v35
    v_cndmask_b32 v36, v36, v7, s[46:47]
    v_cndmask_b32 v37, v37, v7, s[46:47]
    v_cndmask_b32 v38, v38, v7, s[46:47]
    v_cndmask_b32 v39, v39, v7, s[46:47]
    v_max3_f32 v9, v15, v36, v37
    v_max3_f32 v9, v9, v38, v39
    v_cndmask_b32 v40, v40, v7, s[36:37]
    v_cndmask_b32 v41, v41, v7, s[38:39]
    v_cndmask_b32 v42, v42, v7, s[40:41]
    v_cndmask_b32 v43, v43, v7, s[42:43]
    v_max3_f32 v9, v9, v40, v41
    v_max3_f32 v9, v9, v42, v43
    s_branch L_atAb_24
L_atAx_27:
    s_nop 5
    v_max3_f32 v8, v8, v44, v45
    v_max3_f32 v8, v8, v46, v47
    v_max3_f32 v8, v8, v48, v49
    v_max3_f32 v8, v8, v50, v51
    v_max3_f32 v9, v9, v52, v53
    v_max3_f32 v9, v9, v54, v55
    v_max3_f32 v9, v9, v56, v57
    v_max3_f32 v9, v9, v58, v59
    s_branch L_atAb_24
L_atAx_28:
    s_nop 5
    v_max3_f32 v8, v8, v60, v61
    v_max3_f32 v8, v8, v62, v63
    v_max3_f32 v8, v8, v64, v65
    v_max3_f32 v8, v8, v66, v67
    v_max3_f32 v9, v9, v68, v69
    v_max3_f32 v9, v9, v70, v71
    v_max3_f32 v9, v9, v72, v73
    v_max3_f32 v9, v9, v74, v75
    s_branch L_atAb_24
L_atAx_29:
    s_nop 5
    v_max3_f32 v8, v8, v76, v77
    v_max3_f32 v8, v8, v78, v79
    v_max3_f32 v8, v8, v80, v81
    v_max3_f32 v8, v8, v82, v83
    v_max3_f32 v9, v9, v84, v85
    v_max3_f32 v9, v9, v86, v87
    v_max3_f32 v9, v9, v88, v89
    v_max3_f32 v9, v9, v90, v91
    s_branch L_atAb_24
L_atAx_30:
    s_nop 5
    v_max3_f32 v8, v8, v92, v93
    v_max3_f32 v8, v8, v94, v95
    v_max3_f32 v8, v8, v96, v97
    v_max3_f32 v8, v8, v98, v99
    v_max3_f32 v9, v9, v100, v101
    v_max3_f32 v9, v9, v102, v103
    v_max3_f32 v9, v9, v104, v105
    v_max3_f32 v9, v9, v106, v107
    s_branch L_atAb_24
L_atAx_31:
    s_nop 5
    v_max3_f32 v8, v8, v108, v109
    v_max3_f32 v8, v8, v110, v111
    v_max3_f32 v8, v8, v112, v113
    v_max3_f32 v8, v8, v114, v115
    v_max3_f32 v9, v9, v116, v117
    v_max3_f32 v9, v9, v118, v119
    v_max3_f32 v9, v9, v120, v121
    v_max3_f32 v9, v9, v122, v123
    s_branch L_atAb_24
L_atAx_32:
    s_nop 5
    v_max3_f32 v8, v8, v124, v125
    v_max3_f32 v8, v8, v126, v127
    v_max3_f32 v8, v8, v128, v129
    v_max3_f32 v8, v8, v130, v131
    v_max3_f32 v9, v9, v132, v133
    v_max3_f32 v9, v9, v134, v135
    v_max3_f32 v9, v9, v136, v137
    v_max3_f32 v9, v9, v138, v139
    s_branch L_atAb_24
L_atAy_33:
    s_waitcnt lgkmcnt(0)
    s_nop 0
    v_mfma_f32_16x16x32_bf16 v[208:211], v[172:175], v[28:31], v[208:211]
    v_mfma_f32_16x16x32_bf16 v[220:223], v[172:175], v[36:39], v[220:223]
    v_mfma_f32_16x16x32_bf16 v[212:215], v[176:179], v[28:31], v[212:215]
    v_mfma_f32_16x16x32_bf16 v[224:227], v[176:179], v[36:39], v[224:227]
    v_mfma_f32_16x16x32_bf16 v[216:219], v[188:191], v[28:31], v[216:219]
    v_mfma_f32_16x16x32_bf16 v[228:231], v[188:191], v[36:39], v[228:231]
    s_branch L_atAc_25
L_atAy_34:
    s_waitcnt lgkmcnt(0)
    s_nop 0
    v_mfma_f32_16x16x32_bf16 v[208:211], v[180:183], v[44:47], v[208:211]
    v_mfma_f32_16x16x32_bf16 v[220:223], v[180:183], v[52:55], v[220:223]
    v_mfma_f32_16x16x32_bf16 v[212:215], v[184:187], v[44:47], v[212:215]
    v_mfma_f32_16x16x32_bf16 v[224:227], v[184:187], v[52:55], v[224:227]
    v_mfma_f32_16x16x32_bf16 v[216:219], v[188:191], v[44:47], v[216:219]
    v_mfma_f32_16x16x32_bf16 v[228:231], v[188:191], v[52:55], v[228:231]
    s_branch L_atAc_25
L_atAy_35:
    s_waitcnt lgkmcnt(0)
    s_nop 0
    v_mfma_f32_16x16x32_bf16 v[208:211], v[172:175], v[60:63], v[208:211]
    v_mfma_f32_16x16x32_bf16 v[220:223], v[172:175], v[68:71], v[220:223]
    v_mfma_f32_16x16x32_bf16 v[212:215], v[176:179], v[60:63], v[212:215]
    v_mfma_f32_16x16x32_bf16 v[224:227], v[176:179], v[68:71], v[224:227]
    v_mfma_f32_16x16x32_bf16 v[216:219], v[188:191], v[60:63], v[216:219]
    v_mfma_f32_16x16x32_bf16 v[228:231], v[188:191], v[68:71], v[228:231]
    s_branch L_atAc_25
L_atAy_36:
    s_waitcnt lgkmcnt(0)
    s_nop 0
    v_mfma_f32_16x16x32_bf16 v[208:211], v[180:183], v[76:79], v[208:211]
    v_mfma_f32_16x16x32_bf16 v[220:223], v[180:183], v[84:87], v[220:223]
    v_mfma_f32_16x16x32_bf16 v[212:215], v[184:187], v[76:79], v[212:215]
    v_mfma_f32_16x16x32_bf16 v[224:227], v[184:187], v[84:87], v[224:227]
    v_mfma_f32_16x16x32_bf16 v[216:219], v[188:191], v[76:79], v[216:219]
    v_mfma_f32_16x16x32_bf16 v[228:231], v[188:191], v[84:87], v[228:231]
    s_branch L_atAc_25
L_atAy_37:
    s_waitcnt lgkmcnt(0)
    s_nop 0
    v_mfma_f32_16x16x32_bf16 v[208:211], v[172:175], v[92:95], v[208:211]
    v_mfma_f32_16x16x32_bf16 v[220:223], v[172:175], v[100:103], v[220:223]
    v_mfma_f32_16x16x32_bf16 v[212:215], v[176:179], v[92:95], v[212:215]
    v_mfma_f32_16x16x32_bf16 v[224:227], v[176:179], v[100:103], v[224:227]
    v_mfma_f32_16x16x32_bf16 v[216:219], v[188:191], v[92:95], v[216:219]
    v_mfma_f32_16x16x32_bf16 v[228:231], v[188:191], v[100:103], v[228:231]
    s_branch L_atAc_25
L_atAy_38:
    s_waitcnt lgkmcnt(0)
    s_nop 0
    v_mfma_f32_16x16x32_bf16 v[208:211], v[180:183], v[108:111], v[208:211]
    v_mfma_f32_16x16x32_bf16 v[220:223], v[180:183], v[116:119], v[220:223]
    v_mfma_f32_16x16x32_bf16 v[212:215], v[184:187], v[108:111], v[212:215]
    v_mfma_f32_16x16x32_bf16 v[224:227], v[184:187], v[116:119], v[224:227]
    v_mfma_f32_16x16x32_bf16 v[216:219], v[188:191], v[108:111], v[216:219]
    v_mfma_f32_16x16x32_bf16 v[228:231], v[188:191], v[116:119], v[228:231]
    s_branch L_atAc_25
L_atAy_39:
    s_waitcnt lgkmcnt(0)
    s_nop 0
    v_mfma_f32_16x16x32_bf16 v[208:211], v[172:175], v[124:127], v[208:211]
    v_mfma_f32_16x16x32_bf16 v[220:223], v[172:175], v[132:135], v[220:223]
    v_mfma_f32_16x16x32_bf16 v[212:215], v[176:179], v[124:127], v[212:215]
    v_mfma_f32_16x16x32_bf16 v[224:227], v[176:179], v[132:135], v[224:227]
    v_mfma_f32_16x16x32_bf16 v[216:219], v[188:191], v[124:127], v[216:219]
    v_mfma_f32_16x16x32_bf16 v[228:231], v[188:191], v[132:135], v[228:231]
    s_branch L_atAc_25
L_k1_atdone:
    s_lshl_b32 s24, s30, 1
    s_add_u32 s24, s24, s33
    s_add_u32 s24, s24, 112
    s_lshl_b32 s24, s24, 17
    s_add_u32 s50, s50, s24
    s_add_u32 s51, s51, s24
    s_nop 4
    v_rcp_f32 v8, v240
    s_nop 0
    v_mul_f32 v232, v232, v8
    v_mul_f32 v233, v233, v8
    v_mul_f32 v234, v234, v8
    v_mul_f32 v235, v235, v8
    v_mul_f32 v236, v236, v8
    v_mul_f32 v237, v237, v8
    v_mul_f32 v238, v238, v8
    v_mul_f32 v239, v239, v8
    v_cvt_pk_bf16_f32 v36, v232, v233
    v_cvt_pk_bf16_f32 v37, v234, v235
    v_cvt_pk_bf16_f32 v38, v236, v237
    v_cvt_pk_bf16_f32 v39, v238, v239
    buffer_store_dwordx4 v[36:39], v19, s[12:15], s51 offen offset:0 sc1
    v_rcp_f32 v8, v252
    s_nop 0
    v_mul_f32 v244, v244, v8
    v_mul_f32 v245, v245, v8
    v_mul_f32 v246, v246, v8
    v_mul_f32 v247, v247, v8
    v_mul_f32 v248, v248, v8
    v_mul_f32 v249, v249, v8
    v_mul_f32 v250, v250, v8
    v_mul_f32 v251, v251, v8
    v_cvt_pk_bf16_f32 v40, v244, v245
    v_cvt_pk_bf16_f32 v41, v246, v247
    v_cvt_pk_bf16_f32 v42, v248, v249
    v_cvt_pk_bf16_f32 v43, v250, v251
    buffer_store_dwordx4 v[40:43], v19, s[12:15], s51 offen offset:1024 sc1
    v_rcp_f32 v8, v216
    s_nop 0
    v_mul_f32 v208, v208, v8
    v_mul_f32 v209, v209, v8
    v_mul_f32 v210, v210, v8
    v_mul_f32 v211, v211, v8
    v_mul_f32 v212, v212, v8
    v_mul_f32 v213, v213, v8
    v_mul_f32 v214, v214, v8
    v_mul_f32 v215, v215, v8
    v_cvt_pk_bf16_f32 v28, v208, v209
    v_cvt_pk_bf16_f32 v29, v210, v211
    v_cvt_pk_bf16_f32 v30, v212, v213
    v_cvt_pk_bf16_f32 v31, v214, v215
    buffer_store_dwordx4 v[28:31], v19, s[12:15], s50 offen offset:0 sc1
    v_rcp_f32 v8, v228
    s_nop 0
    v_mul_f32 v220, v220, v8
    v_mul_f32 v221, v221, v8
    v_mul_f32 v222, v222, v8
    v_mul_f32 v223, v223, v8
    v_mul_f32 v224, v224, v8
    v_mul_f32 v225, v225, v8
    v_mul_f32 v226, v226, v8
    v_mul_f32 v227, v227, v8
    v_cvt_pk_bf16_f32 v32, v220, v221
    v_cvt_pk_bf16_f32 v33, v222, v223
    v_cvt_pk_bf16_f32 v34, v224, v225
    v_cvt_pk_bf16_f32 v35, v226, v227
    buffer_store_dwordx4 v[32:35], v19, s[12:15], s50 offen offset:1024 sc1
    s_barrier
    s_cmp_lt_u32 s28, 4
    s_cbranch_scc1 L_g2_q0
    s_cmp_eq_u32 s68, 0
    s_cbranch_scc1 L_g2_q1
    s_add_u32 m0, s35, 49152
    s_nop 0
    buffer_load_dwordx4 v24, s[8:11], s57 offen offset:0 lds
    buffer_load_dwordx4 v26, s[8:11], s57 offen offset:2048 lds
    s_add_u32 m0, s35, 50176
    s_nop 0
    buffer_load_dwordx4 v25, s[8:11], s57 offen offset:0 lds
    buffer_load_dwordx4 v27, s[8:11], s57 offen offset:2048 lds
    s_add_u32 s57, s57, 0x20000
    s_cmp_eq_u32 s57, 0x700000
    s_cselect_b32 s57, 0, s57
    s_add_u32 m0, s35, 32768
    s_nop 0
    buffer_load_dwordx4 v19, s[12:15], s56 offen offset:0 lds
    buffer_load_dwordx4 v19, s[12:15], s56 offen offset:1024 lds
    buffer_load_dwordx4 v19, s[12:15], s56 offen offset:2048 lds
    buffer_load_dwordx4 v19, s[12:15], s56 offen offset:3072 lds
    s_add_u32 s56, s56, 0x40000
    s_cmp_ge_u32 s56, s58
    s_cselect_b32 s34, s58, 0
    s_sub_u32 s56, s56, s34
    s_add_u32 m0, s35, 114688
    s_nop 0
    buffer_load_dwordx4 v24, s[8:11], s57 offen offset:0 lds
    buffer_load_dwordx4 v26, s[8:11], s57 offen offset:2048 lds
    s_add_u32 m0, s35, 115712
    s_nop 0
    buffer_load_dwordx4 v25, s[8:11], s57 offen offset:0 lds
    buffer_load_dwordx4 v27, s[8:11], s57 offen offset:2048 lds
    s_add_u32 s57, s57, 0x20000
    s_cmp_eq_u32 s57, 0x700000
    s_cselect_b32 s57, 0, s57
    s_add_u32 m0, s35, 98304
    s_nop 0
    buffer_load_dwordx4 v19, s[12:15], s56 offen offset:0 lds
    buffer_load_dwordx4 v19, s[12:15], s56 offen offset:1024 lds
    buffer_load_dwordx4 v19, s[12:15], s56 offen offset:2048 lds
    buffer_load_dwordx4 v19, s[12:15], s56 offen offset:3072 lds
    s_add_u32 s56, s56, 0x40000
    s_cmp_ge_u32 s56, s58
    s_cselect_b32 s34, s58, 0
    s_sub_u32 s56, s56, s34
    s_waitcnt vmcnt(20)
    s_branch L_g2_com
L_g2_q1:
    s_sub_u32 s35, s28, 4
    s_lshr_b32 s56, s35, 1
    s_lshl_b32 s56, s56, 17
    s_lshl_b32 s34, s29, 14
    s_add_u32 s56, s56, s34
    s_and_b32 s34, s30, 4
    s_lshl_b32 s34, s34, 11
    s_add_u32 s56, s56, s34
    s_and_b32 s34, s35, 1
    s_lshl_b32 s34, s34, 12
    s_add_u32 s56, s56, s34
    v_lshrrev_b32 v25, 3, v1
    v_lshlrev_b32 v25, 11, v25
    v_bfe_u32 v21, v1, 4, 2
    v_lshlrev_b32 v21, 1, v21
    v_and_b32 v23, 7, v1
    v_xor_b32 v21, v21, v23
    v_lshl_add_u32 v25, v21, 4, v25
    s_lshl_b32 s34, s35, 15
    s_and_b32 s57, s30, 8
    s_lshl_b32 s57, s57, 7
    s_add_u32 s34, s34, s57
    s_and_b32 s57, s30, 3
    s_lshl_b32 s57, s57, 8
    s_add_u32 s34, s34, s57
    v_add_u32 v24, s34, v25
    v_add_u32 v25, 128, v24
    v_add_u32 v26, 14336, v24
    v_add_u32 v27, 14464, v24
    s_lshr_b32 s34, s30, 2
    s_mul_i32 s34, s34, 14
    s_mul_i32 s57, s31, 36
    s_add_u32 s57, s57, s34
    s_cmp_ge_u32 s57, 56
    s_cselect_b32 s34, 56, 0
    s_sub_u32 s57, s57, s34
    s_add_u32 s59, s56, 0xe00000
    s_lshl_b32 s34, s57, 18
    s_add_u32 s56, s56, s34
    s_lshl_b32 s57, s57, 17
    s_lshl_b32 s35, s35, 12
    s_mov_b32 s8, s90
    s_mov_b32 s9, s91
    s_mov_b32 s10, 0x700000
    s_mov_b32 s11, 0x00020000
    s_mov_b32 s58, 0xe00000
    s_add_u32 m0, s35, 16384
    s_nop 0
    buffer_load_dwordx4 v24, s[8:11], s57 offen offset:0 lds
    buffer_load_dwordx4 v26, s[8:11], s57 offen offset:2048 lds
    s_add_u32 m0, s35, 17408
    s_nop 0
    buffer_load_dwordx4 v25, s[8:11], s57 offen offset:0 lds
    buffer_load_dwordx4 v27, s[8:11], s57 offen offset:2048 lds
    s_add_u32 s57, s57, 0x20000
    s_cmp_eq_u32 s57, 0x700000
    s_cselect_b32 s57, 0, s57
    s_add_u32 m0, s35, 81920
    s_nop 0
    buffer_load_dwordx4 v24, s[8:11], s57 offen offset:0 lds
    buffer_load_dwordx4 v26, s[8:11], s57 offen offset:2048 lds
    s_add_u32 m0, s35, 82944
    s_nop 0
    buffer_load_dwordx4 v25, s[8:11], s57 offen offset:0 lds
    buffer_load_dwordx4 v27, s[8:11], s57 offen offset:2048 lds
    s_add_u32 s57, s57, 0x20000
    s_cmp_eq_u32 s57, 0x700000
    s_cselect_b32 s57, 0, s57
    s_add_u32 m0, s35, 49152
    s_nop 0
    buffer_load_dwordx4 v24, s[8:11], s57 offen offset:0 lds
    buffer_load_dwordx4 v26, s[8:11], s57 offen offset:2048 lds
    s_add_u32 m0, s35, 50176
    s_nop 0
    buffer_load_dwordx4 v25, s[8:11], s57 offen offset:0 lds
    buffer_load_dwordx4 v27, s[8:11], s57 offen offset:2048 lds
    s_add_u32 s57, s57, 0x20000
    s_cmp_eq_u32 s57, 0x700000
    s_cselect_b32 s57, 0, s57
    s_add_u32 m0, s35, 114688
    s_nop 0
    buffer_load_dwordx4 v24, s[8:11], s57 offen offset:0 lds
    buffer_load_dwordx4 v26, s[8:11], s57 offen offset:2048 lds
    s_add_u32 m0, s35, 115712
    s_nop 0
    buffer_load_dwordx4 v25, s[8:11], s57 offen offset:0 lds
    buffer_load_dwordx4 v27, s[8:11], s57 offen offset:2048 lds
    s_add_u32 s57, s57, 0x20000
    s_cmp_eq_u32 s57, 0x700000
    s_cselect_b32 s57, 0, s57
    s_waitcnt vmcnt(20)
    s_branch L_g2_com
L_g2_q0:
    s_waitcnt vmcnt(0)
    s_branch L_g2_com
L_k1_w1:
    s_mov_b32 s12, s24
    s_mov_b32 s13, s25
    s_mov_b32 s14, 0x700000
    s_mov_b32 s15, 0x00020000
    s_mul_i32 s39, s30, 448
    s_lshl_b32 s40, s28, 6
    s_add_u32 s39, s39, s40
    s_movk_i32 s40, 7168
    v_mul_lo_u32 v6, v6, s40
    v_add3_u32 v5, v5, v6, s39
    v_add_u32 v6, 27648, v5
    s_movk_i32 s40, 7168
    s_movk_i32 s49, 0x3f80
    s_cmp_ge_u32 s28, 7
    s_cbranch_scc1 L_k1_w1_role1
    s_add_u32 m0, s35, 0
    s_nop 0
    buffer_load_dwordx4 v5, s[12:15], s37 offen lds
    buffer_load_dwordx4 v6, s[12:15], s37 offen offset:1024 lds
    s_add_u32 s37, s37, 229376
    s_mov_b32 m0, s46
    s_nop 0
    buffer_load_dwordx4 v3, s[8:11], s36 offen lds
    buffer_load_dwordx4 v4, s[8:11], s36 offen offset:1024 lds
    s_add_u32 s34, s36, 32768
    s_add_u32 m0, s46, 2048
    s_add_u32 s36, s36, 128
    buffer_load_dwordx4 v3, s[8:11], s34 offen lds
    buffer_load_dwordx4 v4, s[8:11], s34 offen offset:1024 lds
    s_add_u32 s46, s46, 32768
    s_cmp_ge_u32 s46, 98304
    s_cselect_b32 s38, 98304, 0
    s_sub_u32 s46, s46, s38
    s_add_u32 m0, s35, 14336
    s_nop 0
    buffer_load_dwordx4 v5, s[12:15], s37 offen lds
    buffer_load_dwordx4 v6, s[12:15], s37 offen offset:1024 lds
    s_add_u32 s37, s37, 229376
    s_cmp_lt_u32 s2, 96
    s_cselect_b32 s16, s22, s24
    s_cselect_b32 s17, s23, s25
    s_cselect_b32 s38, 6144, s40
    s_cselect_b32 s39, 0, 96
    s_lshl_b32 s18, s38, 10
    s_cmp_ge_u32 s2, 208
    s_cselect_b32 s18, 0, s18
    s_mov_b32 s19, 0x00020000
    s_sub_u32 s39, s2, s39
    s_and_b32 s41, s39, 1
    s_lshl_b32 s41, s41, 3
    s_add_u32 s41, s41, s28
    s_lshl_b32 s41, s41, 6
    s_mul_i32 s41, s41, s38
    s_lshr_b32 s39, s39, 1
    s_lshl_b32 s39, s39, 7
    s_add_u32 s41, s41, s39
    v_lshrrev_b32 v18, 3, v1
    v_mul_lo_u32 v18, v18, s38
    v_and_b32 v2, 7, v1
    v_lshl_add_u32 v18, v2, 4, v18
    s_lshl_b32 s42, s38, 3
    v_and_b32 v2, 15, v1
    v_and_b32 v7, 1, v1
    v_lshlrev_b32 v7, 4, v7
    v_lshlrev_b32 v7, v7, s49
    v_lshrrev_b32 v2, 1, v2
    v_cmp_eq_u32 vcc, 0, v2
    s_nop 1
    v_cndmask_b32 v12, 0, v7, vcc
    v_cmp_eq_u32 vcc, 1, v2
    s_nop 1
    v_cndmask_b32 v13, 0, v7, vcc
    v_cmp_eq_u32 vcc, 2, v2
    s_nop 1
    v_cndmask_b32 v14, 0, v7, vcc
    v_cmp_eq_u32 vcc, 3, v2
    s_nop 1
    v_cndmask_b32 v15, 0, v7, vcc
    v_and_b32 v2, 15, v1
    v_lshlrev_b32 v8, 7, v2
    v_lshrrev_b32 v2, 1, v2
    v_lshrrev_b32 v7, 4, v1
    v_xor_b32 v2, v2, v7
    v_lshl_add_u32 v2, v2, 4, v8
    s_lshl_b32 s38, s32, 12
    s_sub_u32 s39, 28672, s38
    v_add_u32 v8, s38, v2
    v_add_u32 v10, s39, v2
    v_xor_b32 v9, 64, v8
    v_xor_b32 v11, 64, v10
    v_lshrrev_b32 v0, 2, v1
    v_lshlrev_b32 v0, 6, v0
    v_and_b32 v7, 16, v1
    v_lshl_add_u32 v0, v7, 1, v0
    v_and_b32 v7, 3, v1
    v_lshl_add_u32 v0, v7, 3, v0
    s_mul_i32 s40, s33, 8192
    s_add_u32 s40, s40, 98304
    v_add_u32 v16, s40, v0
    v_xor_b32 v17, 32, v16
    v_and_b32 v0, 0xffffffe7, v0
    v_and_b32 v7, 1, v1
    v_lshlrev_b32 v7, 5, v7
    v_xor_b32 v0, v0, v7
    v_and_b32 v7, 2, v1
    v_lshl_add_u32 v0, v7, 2, v0
    s_lshl_b32 s40, s33, 4
    s_add_u32 s40, s40, 104448
    v_add_u32 v0, s40, v0
    v_mov_b32 v20, 0
    v_mov_b32 v21, 0
    v_mov_b32 v22, 0
    v_mov_b32 v23, 0
    s_mov_b32 s47, 0
    s_mov_b32 s50, 32768
    s_mov_b32 s51, 32768
    s_add_u32 s52, s6, 0x3000000
    s_addc_u32 s53, s7, 0
    s_mov_b32 s54, 0x20000
    s_mov_b32 s55, 0x00020000
    s_mov_b32 s56, s4
    s_mov_b32 s57, s5
    s_mov_b32 s58, 0x100
    s_mov_b32 s59, 0x00020000
    s_waitcnt vmcnt(8)
    v_lshlrev_b32 v168, 16, v160
    v_and_b32 v169, 0xffff0000, v160
    v_lshlrev_b32 v170, 16, v161
    v_and_b32 v171, 0xffff0000, v161
    v_lshlrev_b32 v172, 16, v162
    v_and_b32 v173, 0xffff0000, v162
    v_lshlrev_b32 v174, 16, v163
    v_and_b32 v175, 0xffff0000, v163
    v_lshlrev_b32 v176, 16, v164
    v_and_b32 v177, 0xffff0000, v164
    v_lshlrev_b32 v178, 16, v165
    v_and_b32 v179, 0xffff0000, v165
    v_lshlrev_b32 v180, 16, v166
    v_and_b32 v181, 0xffff0000, v166
    v_lshlrev_b32 v182, 16, v167
    v_and_b32 v183, 0xffff0000, v167
    v_add_f32 v184, v168, v169
    v_add_f32 v185, v170, v171
    v_add_f32 v184, v184, v172
    v_add_f32 v185, v185, v173
    v_add_f32 v184, v184, v174
    v_add_f32 v185, v185, v175
    v_add_f32 v184, v184, v176
    v_add_f32 v185, v185, v177
    v_add_f32 v184, v184, v178
    v_add_f32 v185, v185, v179
    v_add_f32 v184, v184, v180
    v_add_f32 v185, v185, v181
    v_add_f32 v184, v184, v182
    v_add_f32 v185, v185, v183
    v_add_f32 v184, v184, v185
    s_nop 1
    v_add_f32_dpp v184, v184, v184 row_ror:8 row_mask:0xf bank_mask:0xf
    s_nop 1
    v_add_f32_dpp v184, v184, v184 row_ror:4 row_mask:0xf bank_mask:0xf
    s_nop 1
    v_add_f32_dpp v184, v184, v184 row_ror:2 row_mask:0xf bank_mask:0xf
    s_nop 1
    v_add_f32_dpp v184, v184, v184 row_ror:1 row_mask:0xf bank_mask:0xf
    v_mov_b32 v185, v184
    s_nop 1
    v_permlane16_swap_b32 v184, v185
    v_add_f32 v184, v184, v185
    v_mov_b32 v185, v184
    s_nop 1
    v_permlane32_swap_b32 v184, v185
    v_add_f32 v184, v184, v185
    v_mul_f32 v186, 0x3a800000, v184
    v_sub_f32 v168, v168, v186
    v_sub_f32 v169, v169, v186
    v_sub_f32 v170, v170, v186
    v_sub_f32 v171, v171, v186
    v_sub_f32 v172, v172, v186
    v_sub_f32 v173, v173, v186
    v_sub_f32 v174, v174, v186
    v_sub_f32 v175, v175, v186
    v_sub_f32 v176, v176, v186
    v_sub_f32 v177, v177, v186
    v_sub_f32 v178, v178, v186
    v_sub_f32 v179, v179, v186
    v_sub_f32 v180, v180, v186
    v_sub_f32 v181, v181, v186
    v_sub_f32 v182, v182, v186
    v_sub_f32 v183, v183, v186
    v_mul_f32 v184, v168, v168
    v_mul_f32 v185, v169, v169
    v_fmac_f32 v184, v170, v170
    v_fmac_f32 v185, v171, v171
    v_fmac_f32 v184, v172, v172
    v_fmac_f32 v185, v173, v173
    v_fmac_f32 v184, v174, v174
    v_fmac_f32 v185, v175, v175
    v_fmac_f32 v184, v176, v176
    v_fmac_f32 v185, v177, v177
    v_fmac_f32 v184, v178, v178
    v_fmac_f32 v185, v179, v179
    v_fmac_f32 v184, v180, v180
    v_fmac_f32 v185, v181, v181
    v_fmac_f32 v184, v182, v182
    v_fmac_f32 v185, v183, v183
    v_add_f32 v184, v184, v185
    s_nop 1
    v_add_f32_dpp v184, v184, v184 row_ror:8 row_mask:0xf bank_mask:0xf
    s_nop 1
    v_add_f32_dpp v184, v184, v184 row_ror:4 row_mask:0xf bank_mask:0xf
    s_nop 1
    v_add_f32_dpp v184, v184, v184 row_ror:2 row_mask:0xf bank_mask:0xf
    s_nop 1
    v_add_f32_dpp v184, v184, v184 row_ror:1 row_mask:0xf bank_mask:0xf
    v_mov_b32 v185, v184
    s_nop 1
    v_permlane16_swap_b32 v184, v185
    v_add_f32 v184, v184, v185
    v_mov_b32 v185, v184
    s_nop 1
    v_permlane32_swap_b32 v184, v185
    v_add_f32 v184, v184, v185
    v_mul_f32 v187, 0x3a800000, v184
    v_mov_b32 v168, v187
    v_cvt_pk_bf16_f32 v168, v168, v168
    v_lshlrev_b32 v168, 16, v168
    v_add_f32 v168, 0x3727c5ac, v168
    v_cvt_pk_bf16_f32 v168, v168, v168
    v_lshlrev_b32 v168, 16, v168
    v_sqrt_f32 v168, v168
    s_nop 0
    v_cvt_pk_bf16_f32 v168, v168, v168
    v_lshlrev_b32 v168, 16, v168
    v_rcp_f32 v160, v168
    v_mov_b32 v169, v186
    v_cvt_pk_bf16_f32 v169, v169, v169
    v_lshlrev_b32 v169, 16, v169
    v_mul_f32 v161, -v160, v169
    v_sub_f32 v171, v186, v169
    v_mul_f32 v171, v171, v160
    v_cvt_pk_bf16_f32 v171, v171, v171
    v_lshlrev_b32 v171, 16, v171
    v_mul_f32 v187, v187, v160
    v_mul_f32 v187, v187, v160
    v_mov_b32 v170, v187
    v_cvt_pk_bf16_f32 v170, v170, v170
    v_lshlrev_b32 v170, 16, v170
    v_add_f32 v170, 0x3727c5ac, v170
    v_cvt_pk_bf16_f32 v170, v170, v170
    v_lshlrev_b32 v170, 16, v170
    v_sqrt_f32 v170, v170
    s_nop 0
    v_cvt_pk_bf16_f32 v170, v170, v170
    v_lshlrev_b32 v170, 16, v170
    v_rcp_f32 v170, v170
    v_fma_f32 v171, v171, v168, v169
    v_mul_f32 v162, v160, v170
    v_mul_f32 v163, -v162, v171
    v_cmp_eq_u32 vcc, 1, v1
    s_nop 1
    v_cndmask_b32 v160, v160, v161, vcc
    v_cmp_eq_u32 vcc, 2, v1
    s_nop 1
    v_cndmask_b32 v160, v160, v162, vcc
    v_cmp_eq_u32 vcc, 3, v1
    s_nop 1
    v_cndmask_b32 v160, v160, v163, vcc
    v_lshlrev_b32 v2, 13, v1
    s_lshl_b32 s38, s31, 2
    s_add_u32 s39, s38, 32768
    s_lshl_b32 s38, s31, 4
    s_mov_b64 exec, 15
    buffer_store_dword v160, v2, s[52:55], s39 offen sc1
    s_mov_b64 exec, 1
    buffer_store_dwordx4 v[20:23], v20, s[52:55], s38 offen sc1
    s_mov_b64 exec, -1
    s_mov_b32 m0, s46
    s_nop 0
    buffer_load_dwordx4 v3, s[8:11], s36 offen lds
    buffer_load_dwordx4 v4, s[8:11], s36 offen offset:1024 lds
    s_add_u32 s34, s36, 32768
    s_add_u32 m0, s46, 2048
    s_add_u32 s36, s36, 128
    buffer_load_dwordx4 v3, s[8:11], s34 offen lds
    buffer_load_dwordx4 v4, s[8:11], s34 offen offset:1024 lds
    s_add_u32 s46, s46, 32768
    s_cmp_ge_u32 s46, 98304
    s_cselect_b32 s38, 98304, 0
    s_sub_u32 s46, s46, s38
    s_add_u32 m0, s35, 28672
    s_nop 0
    buffer_load_dwordx4 v5, s[12:15], s37 offen lds
    buffer_load_dwordx4 v6, s[12:15], s37 offen offset:1024 lds
    s_add_u32 s37, s37, 229376
    s_waitcnt vmcnt(10) lgkmcnt(0)
    s_barrier
    ds_read_b128 v[132:135], v8 offset:0
    ds_read_b64_tr_b16 v[148:149], v16 offset:0
    ds_read_b64_tr_b16 v[150:151], v16 offset:1024
    ds_read_b64_tr_b16 v[152:153], v17 offset:0
    ds_read_b64_tr_b16 v[154:155], v17 offset:1024
    ds_read_b64_tr_b16 v[156:157], v16 offset:2048
    ds_read_b64_tr_b16 v[158:159], v16 offset:3072
    ds_read_b64_tr_b16 v[160:161], v17 offset:2048
    ds_read_b64_tr_b16 v[162:163], v17 offset:3072
    ds_read_b64_tr_b16 v[164:165], v16 offset:4096
    ds_read_b64_tr_b16 v[166:167], v16 offset:5120
    ds_read_b64_tr_b16 v[168:169], v17 offset:4096
    ds_read_b64_tr_b16 v[170:171], v17 offset:5120
    ds_read_b64_tr_b16 v[172:173], v0 offset:0
    ds_read_b64_tr_b16 v[174:175], v0 offset:1024
    ds_read_b128 v[136:139], v8 offset:2048
    ds_read_b128 v[140:143], v10 offset:0
    ds_read_b128 v[144:147], v10 offset:2048
    s_add_u32 m0, s35, 43008
    s_nop 0
    buffer_load_dwordx4 v5, s[12:15], s37 offen lds
    buffer_load_dwordx4 v6, s[12:15], s37 offen offset:1024 lds
    s_add_u32 s37, s37, 229376
    s_waitcnt vmcnt(10) lgkmcnt(0)
    s_barrier
    v_mfma_f32_16x16x32_bf16 v[20:23], v[148:151], v[132:135], 0
    ds_read_b128 v[176:179], v9 offset:0
    v_mfma_f32_16x16x32_bf16 v[24:27], v[152:155], v[132:135], 0
    ds_read_b64_tr_b16 v[192:193], v16 offset:14336
    v_mfma_f32_16x16x32_bf16 v[28:31], v[156:159], v[132:135], 0
    ds_read_b64_tr_b16 v[194:195], v16 offset:15360
    s_mov_b32 m0, s46
    s_nop 0
    buffer_load_dwordx4 v3, s[8:11], s36 offen lds
    v_mfma_f32_16x16x32_bf16 v[32:35], v[160:163], v[132:135], 0
    v_mfma_f32_16x16x32_bf16 v[36:39], v[164:167], v[132:135], 0
    ds_read_b64_tr_b16 v[196:197], v17 offset:14336
    v_mfma_f32_16x16x32_bf16 v[40:43], v[168:171], v[132:135], 0
    ds_read_b64_tr_b16 v[198:199], v17 offset:15360
    v_mfma_f32_16x16x32_bf16 v[44:47], v[172:175], v[132:135], 0
    ds_read_b64_tr_b16 v[200:201], v16 offset:16384
    v_mfma_f32_16x16x32_bf16 v[48:51], v[148:151], v[136:139], 0
    buffer_load_dwordx4 v4, s[8:11], s36 offen offset:1024 lds
    s_add_u32 s34, s36, 32768
    v_mfma_f32_16x16x32_bf16 v[52:55], v[152:155], v[136:139], 0
    ds_read_b64_tr_b16 v[202:203], v16 offset:17408
    v_mfma_f32_16x16x32_bf16 v[56:59], v[156:159], v[136:139], 0
    ds_read_b64_tr_b16 v[204:205], v17 offset:16384
    v_mfma_f32_16x16x32_bf16 v[60:63], v[160:163], v[136:139], 0
    ds_read_b64_tr_b16 v[206:207], v17 offset:17408
    v_mfma_f32_16x16x32_bf16 v[64:67], v[164:167], v[136:139], 0
    s_add_u32 m0, s46, 2048
    s_add_u32 s36, s36, 128
    buffer_load_dwordx4 v3, s[8:11], s34 offen lds
    v_mfma_f32_16x16x32_bf16 v[68:71], v[168:171], v[136:139], 0
    ds_read_b64_tr_b16 v[208:209], v16 offset:18432
    v_mfma_f32_16x16x32_bf16 v[72:75], v[172:175], v[136:139], 0
    ds_read_b64_tr_b16 v[210:211], v16 offset:19456
    v_mfma_f32_16x16x32_bf16 v[76:79], v[148:151], v[140:143], 0
    ds_read_b64_tr_b16 v[212:213], v17 offset:18432
    v_mfma_f32_16x16x32_bf16 v[80:83], v[152:155], v[140:143], 0
    v_mfma_f32_16x16x32_bf16 v[84:87], v[156:159], v[140:143], 0
    ds_read_b64_tr_b16 v[214:215], v17 offset:19456
    buffer_load_dwordx4 v4, s[8:11], s34 offen offset:1024 lds
    s_add_u32 s46, s46, 32768
    s_cmp_ge_u32 s46, 98304
    s_cselect_b32 s38, 98304, 0
    s_sub_u32 s46, s46, s38
    v_mfma_f32_16x16x32_bf16 v[88:91], v[160:163], v[140:143], 0
    ds_read_b64_tr_b16 v[216:217], v0 offset:14336
    v_mfma_f32_16x16x32_bf16 v[92:95], v[164:167], v[140:143], 0
    ds_read_b64_tr_b16 v[218:219], v0 offset:15360
    v_mfma_f32_16x16x32_bf16 v[96:99], v[168:171], v[140:143], 0
    v_mfma_f32_16x16x32_bf16 v[100:103], v[172:175], v[140:143], 0
    ds_read_b128 v[180:183], v9 offset:2048
    v_mfma_f32_16x16x32_bf16 v[104:107], v[148:151], v[144:147], 0
    ds_read_b128 v[184:187], v11 offset:0
    s_add_u32 m0, s35, 0
    s_nop 0
    buffer_load_dwordx4 v5, s[12:15], s37 offen lds
    v_mfma_f32_16x16x32_bf16 v[108:111], v[152:155], v[144:147], 0
    ds_read_b128 v[188:191], v11 offset:2048
    v_mfma_f32_16x16x32_bf16 v[112:115], v[156:159], v[144:147], 0
    v_mfma_f32_16x16x32_bf16 v[116:119], v[160:163], v[144:147], 0
    v_mfma_f32_16x16x32_bf16 v[120:123], v[164:167], v[144:147], 0
    buffer_load_dwordx4 v6, s[12:15], s37 offen offset:1024 lds
    s_add_u32 s37, s37, 229376
    v_mfma_f32_16x16x32_bf16 v[124:127], v[168:171], v[144:147], 0
    v_add_u32 v8, s50, v8
    v_add_u32 v10, s50, v10
    v_mfma_f32_16x16x32_bf16 v[128:131], v[172:175], v[144:147], 0
    s_waitcnt vmcnt(8) lgkmcnt(0)
    s_barrier
    v_mfma_f32_16x16x32_bf16 v[20:23], v[192:195], v[176:179], v[20:23]
    ds_read_b128 v[132:135], v8 offset:0
    v_mfma_f32_16x16x32_bf16 v[24:27], v[196:199], v[176:179], v[24:27]
    ds_read_b64_tr_b16 v[148:149], v16 offset:28672
    s_add_u32 m0, s35, 14336
    s_nop 0
    buffer_load_dwordx4 v5, s[12:15], s37 offen lds
    v_mfma_f32_16x16x32_bf16 v[28:31], v[200:203], v[176:179], v[28:31]
    ds_read_b64_tr_b16 v[150:151], v16 offset:29696
    v_mfma_f32_16x16x32_bf16 v[32:35], v[204:207], v[176:179], v[32:35]
    v_mfma_f32_16x16x32_bf16 v[36:39], v[208:211], v[176:179], v[36:39]
    ds_read_b64_tr_b16 v[152:153], v17 offset:28672
    v_mfma_f32_16x16x32_bf16 v[40:43], v[212:215], v[176:179], v[40:43]
    ds_read_b64_tr_b16 v[154:155], v17 offset:29696
    buffer_load_dwordx4 v6, s[12:15], s37 offen offset:1024 lds
    s_add_u32 s37, s37, 229376
    v_mfma_f32_16x16x32_bf16 v[44:47], v[216:219], v[176:179], v[44:47]
    ds_read_b64_tr_b16 v[156:157], v16 offset:30720
    v_mfma_f32_16x16x32_bf16 v[48:51], v[192:195], v[180:183], v[48:51]
    v_mfma_f32_16x16x32_bf16 v[52:55], v[196:199], v[180:183], v[52:55]
    ds_read_b64_tr_b16 v[158:159], v16 offset:31744
    s_mov_b32 m0, s46
    s_nop 0
    buffer_load_dwordx4 v3, s[8:11], s36 offen lds
    v_mfma_f32_16x16x32_bf16 v[56:59], v[200:203], v[180:183], v[56:59]
    ds_read_b64_tr_b16 v[160:161], v17 offset:30720
    v_mfma_f32_16x16x32_bf16 v[60:63], v[204:207], v[180:183], v[60:63]
    ds_read_b64_tr_b16 v[162:163], v17 offset:31744
    v_mfma_f32_16x16x32_bf16 v[64:67], v[208:211], v[180:183], v[64:67]
    v_mfma_f32_16x16x32_bf16 v[68:71], v[212:215], v[180:183], v[68:71]
    ds_read_b64_tr_b16 v[164:165], v16 offset:32768
    buffer_load_dwordx4 v4, s[8:11], s36 offen offset:1024 lds
    s_add_u32 s34, s36, 32768
    v_mfma_f32_16x16x32_bf16 v[72:75], v[216:219], v[180:183], v[72:75]
    ds_read_b64_tr_b16 v[166:167], v16 offset:33792
    v_mfma_f32_16x16x32_bf16 v[76:79], v[192:195], v[184:187], v[76:79]
    ds_read_b64_tr_b16 v[168:169], v17 offset:32768
    v_mfma_f32_16x16x32_bf16 v[80:83], v[196:199], v[184:187], v[80:83]
    buffer_load_dwordx4 v[224:227], v18, s[16:19], s41 offen
    s_add_u32 s41, s41, s42
    v_mfma_f32_16x16x32_bf16 v[84:87], v[200:203], v[184:187], v[84:87]
    ds_read_b64_tr_b16 v[170:171], v17 offset:33792
    v_mfma_f32_16x16x32_bf16 v[88:91], v[204:207], v[184:187], v[88:91]
    ds_read_b64_tr_b16 v[172:173], v0 offset:28672
    v_mfma_f32_16x16x32_bf16 v[92:95], v[208:211], v[184:187], v[92:95]
    ds_read_b64_tr_b16 v[174:175], v0 offset:29696
    v_mfma_f32_16x16x32_bf16 v[96:99], v[212:215], v[184:187], v[96:99]
    buffer_load_dwordx4 v[228:231], v18, s[16:19], s41 offen
    s_add_u32 s41, s41, s42
    v_mfma_f32_16x16x32_bf16 v[100:103], v[216:219], v[184:187], v[100:103]
    ds_read_b128 v[136:139], v8 offset:2048
    v_mfma_f32_16x16x32_bf16 v[104:107], v[192:195], v[188:191], v[104:107]
    ds_read_b128 v[140:143], v10 offset:0
    v_mfma_f32_16x16x32_bf16 v[108:111], v[196:199], v[188:191], v[108:111]
    ds_read_b128 v[144:147], v10 offset:2048
    buffer_load_dwordx4 v[232:235], v18, s[16:19], s41 offen
    s_add_u32 s41, s41, s42
    v_mfma_f32_16x16x32_bf16 v[112:115], v[200:203], v[188:191], v[112:115]
    v_mfma_f32_16x16x32_bf16 v[116:119], v[204:207], v[188:191], v[116:119]
    v_mfma_f32_16x16x32_bf16 v[120:123], v[208:211], v[188:191], v[120:123]
    v_mfma_f32_16x16x32_bf16 v[124:127], v[212:215], v[188:191], v[124:127]
    buffer_load_dwordx4 v[236:239], v18, s[16:19], s41 offen
    s_add_u32 s41, s41, s42
    v_add_u32 v9, s50, v9
    v_add_u32 v11, s50, v11
    s_add_u32 s47, s47, s50
    s_cmp_eq_u32 s47, 65536
    s_cselect_b32 s50, 0xffff0000, s51
    v_mfma_f32_16x16x32_bf16 v[128:131], v[216:219], v[188:191], v[128:131]
    s_waitcnt vmcnt(14) lgkmcnt(0)
    s_barrier
    v_mfma_f32_16x16x32_bf16 v[20:23], v[148:151], v[132:135], v[20:23]
    ds_read_b128 v[176:179], v9 offset:0
    v_mfma_f32_16x16x32_bf16 v[24:27], v[152:155], v[132:135], v[24:27]
    ds_read_b64_tr_b16 v[192:193], v16 offset:43008
    s_add_u32 m0, s35, 28672
    s_nop 0
    buffer_load_dwordx4 v5, s[12:15], s37 offen lds
    v_mfma_f32_16x16x32_bf16 v[28:31], v[156:159], v[132:135], v[28:31]
    ds_read_b64_tr_b16 v[194:195], v16 offset:44032
    v_mfma_f32_16x16x32_bf16 v[32:35], v[160:163], v[132:135], v[32:35]
    v_mfma_f32_16x16x32_bf16 v[36:39], v[164:167], v[132:135], v[36:39]
    ds_read_b64_tr_b16 v[196:197], v17 offset:43008
    v_mfma_f32_16x16x32_bf16 v[40:43], v[168:171], v[132:135], v[40:43]
    ds_read_b64_tr_b16 v[198:199], v17 offset:44032
    buffer_load_dwordx4 v6, s[12:15], s37 offen offset:1024 lds
    s_add_u32 s37, s37, 229376
    v_mfma_f32_16x16x32_bf16 v[44:47], v[172:175], v[132:135], v[44:47]
    ds_read_b64_tr_b16 v[200:201], v16 offset:45056
    v_mfma_f32_16x16x32_bf16 v[48:51], v[148:151], v[136:139], v[48:51]
    v_mfma_f32_16x16x32_bf16 v[52:55], v[152:155], v[136:139], v[52:55]
    ds_read_b64_tr_b16 v[202:203], v16 offset:46080
    s_add_u32 m0, s46, 2048
    s_add_u32 s36, s36, 128
    buffer_load_dwordx4 v3, s[8:11], s34 offen lds
    v_mfma_f32_16x16x32_bf16 v[56:59], v[156:159], v[136:139], v[56:59]
    ds_read_b64_tr_b16 v[204:205], v17 offset:45056
    v_mfma_f32_16x16x32_bf16 v[60:63], v[160:163], v[136:139], v[60:63]
    ds_read_b64_tr_b16 v[206:207], v17 offset:46080
    v_mfma_f32_16x16x32_bf16 v[64:67], v[164:167], v[136:139], v[64:67]
    v_mfma_f32_16x16x32_bf16 v[68:71], v[168:171], v[136:139], v[68:71]
    ds_read_b64_tr_b16 v[208:209], v16 offset:47104
    buffer_load_dwordx4 v4, s[8:11], s34 offen offset:1024 lds
    s_add_u32 s46, s46, 32768
    s_cmp_ge_u32 s46, 98304
    s_cselect_b32 s38, 98304, 0
    s_sub_u32 s46, s46, s38
    v_mfma_f32_16x16x32_bf16 v[72:75], v[172:175], v[136:139], v[72:75]
    ds_read_b64_tr_b16 v[210:211], v16 offset:48128
    v_mfma_f32_16x16x32_bf16 v[76:79], v[148:151], v[140:143], v[76:79]
    ds_read_b64_tr_b16 v[212:213], v17 offset:47104
    v_mfma_f32_16x16x32_bf16 v[80:83], v[152:155], v[140:143], v[80:83]
    buffer_load_dwordx4 v[240:243], v18, s[16:19], s41 offen
    s_add_u32 s41, s41, s42
    v_mfma_f32_16x16x32_bf16 v[84:87], v[156:159], v[140:143], v[84:87]
    ds_read_b64_tr_b16 v[214:215], v17 offset:48128
    v_mfma_f32_16x16x32_bf16 v[88:91], v[160:163], v[140:143], v[88:91]
    ds_read_b64_tr_b16 v[216:217], v0 offset:43008
    v_mfma_f32_16x16x32_bf16 v[92:95], v[164:167], v[140:143], v[92:95]
    ds_read_b64_tr_b16 v[218:219], v0 offset:44032
    v_mfma_f32_16x16x32_bf16 v[96:99], v[168:171], v[140:143], v[96:99]
    buffer_load_dwordx4 v[244:247], v18, s[16:19], s41 offen
    s_add_u32 s41, s41, s42
    v_mfma_f32_16x16x32_bf16 v[100:103], v[172:175], v[140:143], v[100:103]
    ds_read_b128 v[180:183], v9 offset:2048
    v_mfma_f32_16x16x32_bf16 v[104:107], v[148:151], v[144:147], v[104:107]
    ds_read_b128 v[184:187], v11 offset:0
    v_mfma_f32_16x16x32_bf16 v[108:111], v[152:155], v[144:147], v[108:111]
    ds_read_b128 v[188:191], v11 offset:2048
    buffer_load_dwordx4 v[248:251], v18, s[16:19], s41 offen
    s_add_u32 s41, s41, s42
    v_mfma_f32_16x16x32_bf16 v[112:115], v[156:159], v[144:147], v[112:115]
    v_mfma_f32_16x16x32_bf16 v[116:119], v[160:163], v[144:147], v[116:119]
    v_mfma_f32_16x16x32_bf16 v[120:123], v[164:167], v[144:147], v[120:123]
    v_mfma_f32_16x16x32_bf16 v[124:127], v[168:171], v[144:147], v[124:127]
    buffer_load_dwordx4 v[252:255], v18, s[16:19], s41 offen
    s_add_u32 s41, s41, s42
    v_add_u32 v8, s50, v8
    v_add_u32 v10, s50, v10
    v_mfma_f32_16x16x32_bf16 v[128:131], v[172:175], v[144:147], v[128:131]
    s_waitcnt vmcnt(16) lgkmcnt(0)
    s_barrier
    v_mfma_f32_16x16x32_bf16 v[20:23], v[192:195], v[176:179], v[20:23]
    ds_read_b128 v[132:135], v8 offset:0
    v_mfma_f32_16x16x32_bf16 v[24:27], v[196:199], v[176:179], v[24:27]
    ds_read_b64_tr_b16 v[148:149], v16 offset:0
    v_mfma_f32_16x16x32_bf16 v[28:31], v[200:203], v[176:179], v[28:31]
    ds_read_b64_tr_b16 v[150:151], v16 offset:1024
    v_mfma_f32_16x16x32_bf16 v[32:35], v[204:207], v[176:179], v[32:35]
    s_add_u32 m0, s35, 43008
    s_nop 0
    buffer_load_dwordx4 v5, s[12:15], s37 offen lds
    v_mfma_f32_16x16x32_bf16 v[36:39], v[208:211], v[176:179], v[36:39]
    ds_read_b64_tr_b16 v[152:153], v17 offset:0
    v_mfma_f32_16x16x32_bf16 v[40:43], v[212:215], v[176:179], v[40:43]
    ds_read_b64_tr_b16 v[154:155], v17 offset:1024
    v_mfma_f32_16x16x32_bf16 v[44:47], v[216:219], v[176:179], v[44:47]
    ds_read_b64_tr_b16 v[156:157], v16 offset:2048
    v_mfma_f32_16x16x32_bf16 v[48:51], v[192:195], v[180:183], v[48:51]
    v_mfma_f32_16x16x32_bf16 v[52:55], v[196:199], v[180:183], v[52:55]
    ds_read_b64_tr_b16 v[158:159], v16 offset:3072
    v_mfma_f32_16x16x32_bf16 v[56:59], v[200:203], v[180:183], v[56:59]
    ds_read_b64_tr_b16 v[160:161], v17 offset:2048
    v_mfma_f32_16x16x32_bf16 v[60:63], v[204:207], v[180:183], v[60:63]
    ds_read_b64_tr_b16 v[162:163], v17 offset:3072
    buffer_load_dwordx4 v6, s[12:15], s37 offen offset:1024 lds
    s_add_u32 s37, s37, 229376
    v_mfma_f32_16x16x32_bf16 v[64:67], v[208:211], v[180:183], v[64:67]
    v_mfma_f32_16x16x32_bf16 v[68:71], v[212:215], v[180:183], v[68:71]
    ds_read_b64_tr_b16 v[164:165], v16 offset:4096
    v_mfma_f32_16x16x32_bf16 v[72:75], v[216:219], v[180:183], v[72:75]
    ds_read_b64_tr_b16 v[166:167], v16 offset:5120
    v_mfma_f32_16x16x32_bf16 v[76:79], v[192:195], v[184:187], v[76:79]
    ds_read_b64_tr_b16 v[168:169], v17 offset:4096
    v_mfma_f32_16x16x32_bf16 v[80:83], v[196:199], v[184:187], v[80:83]
    v_mfma_f32_16x16x32_bf16 v[84:87], v[200:203], v[184:187], v[84:87]
    ds_read_b64_tr_b16 v[170:171], v17 offset:5120
    v_mfma_f32_16x16x32_bf16 v[88:91], v[204:207], v[184:187], v[88:91]
    ds_read_b64_tr_b16 v[172:173], v0 offset:0
    s_mov_b32 m0, s46
    s_nop 0
    buffer_load_dwordx4 v3, s[8:11], s36 offen lds
    v_mfma_f32_16x16x32_bf16 v[92:95], v[208:211], v[184:187], v[92:95]
    ds_read_b64_tr_b16 v[174:175], v0 offset:1024
    v_mfma_f32_16x16x32_bf16 v[96:99], v[212:215], v[184:187], v[96:99]
    v_mfma_f32_16x16x32_bf16 v[100:103], v[216:219], v[184:187], v[100:103]
    ds_read_b128 v[136:139], v8 offset:2048
    v_mfma_f32_16x16x32_bf16 v[104:107], v[192:195], v[188:191], v[104:107]
    ds_read_b128 v[140:143], v10 offset:0
    v_mfma_f32_16x16x32_bf16 v[108:111], v[196:199], v[188:191], v[108:111]
    ds_read_b128 v[144:147], v10 offset:2048
    v_mfma_f32_16x16x32_bf16 v[112:115], v[200:203], v[188:191], v[112:115]
    v_mfma_f32_16x16x32_bf16 v[116:119], v[204:207], v[188:191], v[116:119]
    buffer_load_dwordx4 v4, s[8:11], s36 offen offset:1024 lds
    s_add_u32 s34, s36, 32768
    v_mfma_f32_16x16x32_bf16 v[120:123], v[208:211], v[188:191], v[120:123]
    v_mfma_f32_16x16x32_bf16 v[124:127], v[212:215], v[188:191], v[124:127]
    v_add_u32 v9, s50, v9
    v_add_u32 v11, s50, v11
    s_add_u32 s47, s47, s50
    s_cmp_eq_u32 s47, 65536
    s_cselect_b32 s50, 0xffff0000, s51
    v_mfma_f32_16x16x32_bf16 v[128:131], v[216:219], v[188:191], v[128:131]
    s_waitcnt vmcnt(18) lgkmcnt(0)
    s_barrier
    v_mfma_f32_16x16x32_bf16 v[20:23], v[148:151], v[132:135], v[20:23]
    ds_read_b128 v[176:179], v9 offset:0
    v_mfma_f32_16x16x32_bf16 v[24:27], v[152:155], v[132:135], v[24:27]
    ds_read_b64_tr_b16 v[192:193], v16 offset:14336
    v_mfma_f32_16x16x32_bf16 v[28:31], v[156:159], v[132:135], v[28:31]
    ds_read_b64_tr_b16 v[194:195], v16 offset:15360
    v_mfma_f32_16x16x32_bf16 v[32:35], v[160:163], v[132:135], v[32:35]
    s_add_u32 m0, s35, 0
    s_nop 0
    buffer_load_dwordx4 v5, s[12:15], s37 offen lds
    v_mfma_f32_16x16x32_bf16 v[36:39], v[164:167], v[132:135], v[36:39]
    ds_read_b64_tr_b16 v[196:197], v17 offset:14336
    v_mfma_f32_16x16x32_bf16 v[40:43], v[168:171], v[132:135], v[40:43]
    ds_read_b64_tr_b16 v[198:199], v17 offset:15360
    v_mfma_f32_16x16x32_bf16 v[44:47], v[172:175], v[132:135], v[44:47]
    ds_read_b64_tr_b16 v[200:201], v16 offset:16384
    v_mfma_f32_16x16x32_bf16 v[48:51], v[148:151], v[136:139], v[48:51]
    v_mfma_f32_16x16x32_bf16 v[52:55], v[152:155], v[136:139], v[52:55]
    ds_read_b64_tr_b16 v[202:203], v16 offset:17408
    v_mfma_f32_16x16x32_bf16 v[56:59], v[156:159], v[136:139], v[56:59]
    ds_read_b64_tr_b16 v[204:205], v17 offset:16384
    v_mfma_f32_16x16x32_bf16 v[60:63], v[160:163], v[136:139], v[60:63]
    ds_read_b64_tr_b16 v[206:207], v17 offset:17408
    buffer_load_dwordx4 v6, s[12:15], s37 offen offset:1024 lds
    s_add_u32 s37, s37, 229376
    v_mfma_f32_16x16x32_bf16 v[64:67], v[164:167], v[136:139], v[64:67]
    v_mfma_f32_16x16x32_bf16 v[68:71], v[168:171], v[136:139], v[68:71]
    ds_read_b64_tr_b16 v[208:209], v16 offset:18432
    v_mfma_f32_16x16x32_bf16 v[72:75], v[172:175], v[136:139], v[72:75]
    ds_read_b64_tr_b16 v[210:211], v16 offset:19456
    v_mfma_f32_16x16x32_bf16 v[76:79], v[148:151], v[140:143], v[76:79]
    ds_read_b64_tr_b16 v[212:213], v17 offset:18432
    v_mfma_f32_16x16x32_bf16 v[80:83], v[152:155], v[140:143], v[80:83]
    v_mfma_f32_16x16x32_bf16 v[84:87], v[156:159], v[140:143], v[84:87]
    ds_read_b64_tr_b16 v[214:215], v17 offset:19456
    v_mfma_f32_16x16x32_bf16 v[88:91], v[160:163], v[140:143], v[88:91]
    ds_read_b64_tr_b16 v[216:217], v0 offset:14336
    s_add_u32 m0, s46, 2048
    s_add_u32 s36, s36, 128
    buffer_load_dwordx4 v3, s[8:11], s34 offen lds
    v_mfma_f32_16x16x32_bf16 v[92:95], v[164:167], v[140:143], v[92:95]
    ds_read_b64_tr_b16 v[218:219], v0 offset:15360
    v_mfma_f32_16x16x32_bf16 v[96:99], v[168:171], v[140:143], v[96:99]
    v_mfma_f32_16x16x32_bf16 v[100:103], v[172:175], v[140:143], v[100:103]
    ds_read_b128 v[180:183], v9 offset:2048
    v_mfma_f32_16x16x32_bf16 v[104:107], v[148:151], v[144:147], v[104:107]
    ds_read_b128 v[184:187], v11 offset:0
    v_mfma_f32_16x16x32_bf16 v[108:111], v[152:155], v[144:147], v[108:111]
    ds_read_b128 v[188:191], v11 offset:2048
    v_mfma_f32_16x16x32_bf16 v[112:115], v[156:159], v[144:147], v[112:115]
    v_mfma_f32_16x16x32_bf16 v[116:119], v[160:163], v[144:147], v[116:119]
    buffer_load_dwordx4 v4, s[8:11], s34 offen offset:1024 lds
    s_add_u32 s46, s46, 32768
    s_cmp_ge_u32 s46, 98304
    s_cselect_b32 s38, 98304, 0
    s_sub_u32 s46, s46, s38
    v_mfma_f32_16x16x32_bf16 v[120:123], v[164:167], v[144:147], v[120:123]
    v_mfma_f32_16x16x32_bf16 v[124:127], v[168:171], v[144:147], v[124:127]
    v_add_u32 v8, s50, v8
    v_add_u32 v10, s50, v10
    v_mfma_f32_16x16x32_bf16 v[128:131], v[172:175], v[144:147], v[128:131]
    s_waitcnt vmcnt(12) lgkmcnt(0)
    s_barrier
    v_mfma_f32_16x16x32_bf16 v[20:23], v[192:195], v[176:179], v[20:23]
    ds_read_b128 v[132:135], v8 offset:0
    v_mfma_f32_16x16x32_bf16 v[24:27], v[196:199], v[176:179], v[24:27]
    ds_read_b64_tr_b16 v[148:149], v16 offset:28672
    v_mfma_f32_16x16x32_bf16 v[28:31], v[200:203], v[176:179], v[28:31]
    ds_read_b64_tr_b16 v[150:151], v16 offset:29696
    v_mfma_f32_16x16x32_bf16 v[32:35], v[204:207], v[176:179], v[32:35]
    s_add_u32 m0, s35, 14336
    s_nop 0
    buffer_load_dwordx4 v5, s[12:15], s37 offen lds
    v_mfma_f32_16x16x32_bf16 v[36:39], v[208:211], v[176:179], v[36:39]
    ds_read_b64_tr_b16 v[152:153], v17 offset:28672
    v_mfma_f32_16x16x32_bf16 v[40:43], v[212:215], v[176:179], v[40:43]
    ds_read_b64_tr_b16 v[154:155], v17 offset:29696
    v_mfma_f32_16x16x32_bf16 v[44:47], v[216:219], v[176:179], v[44:47]
    ds_read_b64_tr_b16 v[156:157], v16 offset:30720
    v_mfma_f32_16x16x32_bf16 v[48:51], v[192:195], v[180:183], v[48:51]
    v_mfma_f32_16x16x32_bf16 v[52:55], v[196:199], v[180:183], v[52:55]
    ds_read_b64_tr_b16 v[158:159], v16 offset:31744
    v_mfma_f32_16x16x32_bf16 v[56:59], v[200:203], v[180:183], v[56:59]
    ds_read_b64_tr_b16 v[160:161], v17 offset:30720
    v_mfma_f32_16x16x32_bf16 v[60:63], v[204:207], v[180:183], v[60:63]
    ds_read_b64_tr_b16 v[162:163], v17 offset:31744
    buffer_load_dwordx4 v6, s[12:15], s37 offen offset:1024 lds
    s_add_u32 s37, s37, 229376
    v_mfma_f32_16x16x32_bf16 v[64:67], v[208:211], v[180:183], v[64:67]
    v_mfma_f32_16x16x32_bf16 v[68:71], v[212:215], v[180:183], v[68:71]
    ds_read_b64_tr_b16 v[164:165], v16 offset:32768
    v_mfma_f32_16x16x32_bf16 v[72:75], v[216:219], v[180:183], v[72:75]
    ds_read_b64_tr_b16 v[166:167], v16 offset:33792
    v_mfma_f32_16x16x32_bf16 v[76:79], v[192:195], v[184:187], v[76:79]
    ds_read_b64_tr_b16 v[168:169], v17 offset:32768
    v_mfma_f32_16x16x32_bf16 v[80:83], v[196:199], v[184:187], v[80:83]
    v_mfma_f32_16x16x32_bf16 v[84:87], v[200:203], v[184:187], v[84:87]
    ds_read_b64_tr_b16 v[170:171], v17 offset:33792
    v_mfma_f32_16x16x32_bf16 v[88:91], v[204:207], v[184:187], v[88:91]
    ds_read_b64_tr_b16 v[172:173], v0 offset:28672
    s_mov_b32 m0, s46
    s_nop 0
    buffer_load_dwordx4 v3, s[8:11], s36 offen lds
    v_mfma_f32_16x16x32_bf16 v[92:95], v[208:211], v[184:187], v[92:95]
    ds_read_b64_tr_b16 v[174:175], v0 offset:29696
    v_mfma_f32_16x16x32_bf16 v[96:99], v[212:215], v[184:187], v[96:99]
    v_mfma_f32_16x16x32_bf16 v[100:103], v[216:219], v[184:187], v[100:103]
    ds_read_b128 v[136:139], v8 offset:2048
    v_mfma_f32_16x16x32_bf16 v[104:107], v[192:195], v[188:191], v[104:107]
    ds_read_b128 v[140:143], v10 offset:0
    v_mfma_f32_16x16x32_bf16 v[108:111], v[196:199], v[188:191], v[108:111]
    ds_read_b128 v[144:147], v10 offset:2048
    v_mfma_f32_16x16x32_bf16 v[112:115], v[200:203], v[188:191], v[112:115]
    v_mfma_f32_16x16x32_bf16 v[116:119], v[204:207], v[188:191], v[116:119]
    buffer_load_dwordx4 v4, s[8:11], s36 offen offset:1024 lds
    s_add_u32 s34, s36, 32768
    v_mfma_f32_16x16x32_bf16 v[120:123], v[208:211], v[188:191], v[120:123]
    v_mfma_f32_16x16x32_bf16 v[124:127], v[212:215], v[188:191], v[124:127]
    v_add_u32 v9, s50, v9
    v_add_u32 v11, s50, v11
    s_add_u32 s47, s47, s50
    s_cmp_eq_u32 s47, 65536
    s_cselect_b32 s50, 0xffff0000, s51
    v_mfma_f32_16x16x32_bf16 v[128:131], v[216:219], v[188:191], v[128:131]
    s_waitcnt vmcnt(10) lgkmcnt(0)
    s_barrier
    v_mfma_f32_16x16x32_bf16 v[220:223], v[12:15], v[224:227], 0
    v_mfma_f32_16x16x32_bf16 v[220:223], v[12:15], v[228:231], v[220:223]
    v_mfma_f32_16x16x32_bf16 v[220:223], v[12:15], v[232:235], v[220:223]
    v_mfma_f32_16x16x32_bf16 v[220:223], v[12:15], v[236:239], v[220:223]
    v_mfma_f32_16x16x32_bf16 v[220:223], v[12:15], v[240:243], v[220:223]
    v_mfma_f32_16x16x32_bf16 v[220:223], v[12:15], v[244:247], v[220:223]
    v_mfma_f32_16x16x32_bf16 v[220:223], v[12:15], v[248:251], v[220:223]
    v_mfma_f32_16x16x32_bf16 v[220:223], v[12:15], v[252:255], v[220:223]
    s_lshl_b32 s38, s28, 10
    s_add_u32 s38, s38, 155648
    v_add_u32 v2, s38, v19
    v_mfma_f32_16x16x32_bf16 v[20:23], v[148:151], v[132:135], v[20:23]
    ds_read_b128 v[176:179], v9 offset:0
    v_mfma_f32_16x16x32_bf16 v[24:27], v[152:155], v[132:135], v[24:27]
    ds_read_b64_tr_b16 v[192:193], v16 offset:43008
    v_mfma_f32_16x16x32_bf16 v[28:31], v[156:159], v[132:135], v[28:31]
    ds_read_b64_tr_b16 v[194:195], v16 offset:44032
    v_mfma_f32_16x16x32_bf16 v[32:35], v[160:163], v[132:135], v[32:35]
    s_add_u32 m0, s35, 28672
    s_nop 0
    buffer_load_dwordx4 v5, s[12:15], s37 offen lds
    v_mfma_f32_16x16x32_bf16 v[36:39], v[164:167], v[132:135], v[36:39]
    ds_read_b64_tr_b16 v[196:197], v17 offset:43008
    v_mfma_f32_16x16x32_bf16 v[40:43], v[168:171], v[132:135], v[40:43]
    ds_read_b64_tr_b16 v[198:199], v17 offset:44032
    v_mfma_f32_16x16x32_bf16 v[44:47], v[172:175], v[132:135], v[44:47]
    ds_read_b64_tr_b16 v[200:201], v16 offset:45056
    v_mfma_f32_16x16x32_bf16 v[48:51], v[148:151], v[136:139], v[48:51]
    v_mfma_f32_16x16x32_bf16 v[52:55], v[152:155], v[136:139], v[52:55]
    ds_read_b64_tr_b16 v[202:203], v16 offset:46080
    v_mfma_f32_16x16x32_bf16 v[56:59], v[156:159], v[136:139], v[56:59]
    ds_read_b64_tr_b16 v[204:205], v17 offset:45056
    v_mfma_f32_16x16x32_bf16 v[60:63], v[160:163], v[136:139], v[60:63]
    ds_read_b64_tr_b16 v[206:207], v17 offset:46080
    buffer_load_dwordx4 v6, s[12:15], s37 offen offset:1024 lds
    s_add_u32 s37, s37, 229376
    v_mfma_f32_16x16x32_bf16 v[64:67], v[164:167], v[136:139], v[64:67]
    v_mfma_f32_16x16x32_bf16 v[68:71], v[168:171], v[136:139], v[68:71]
    ds_read_b64_tr_b16 v[208:209], v16 offset:47104
    v_mfma_f32_16x16x32_bf16 v[72:75], v[172:175], v[136:139], v[72:75]
    ds_read_b64_tr_b16 v[210:211], v16 offset:48128
    v_mfma_f32_16x16x32_bf16 v[76:79], v[148:151], v[140:143], v[76:79]
    ds_read_b64_tr_b16 v[212:213], v17 offset:47104
    v_mfma_f32_16x16x32_bf16 v[80:83], v[152:155], v[140:143], v[80:83]
    v_mfma_f32_16x16x32_bf16 v[84:87], v[156:159], v[140:143], v[84:87]
    ds_read_b64_tr_b16 v[214:215], v17 offset:48128
    v_mfma_f32_16x16x32_bf16 v[88:91], v[160:163], v[140:143], v[88:91]
    ds_read_b64_tr_b16 v[216:217], v0 offset:43008
    s_add_u32 m0, s46, 2048
    s_add_u32 s36, s36, 128
    buffer_load_dwordx4 v3, s[8:11], s34 offen lds
    v_mfma_f32_16x16x32_bf16 v[92:95], v[164:167], v[140:143], v[92:95]
    ds_read_b64_tr_b16 v[218:219], v0 offset:44032
    v_mfma_f32_16x16x32_bf16 v[96:99], v[168:171], v[140:143], v[96:99]
    v_mfma_f32_16x16x32_bf16 v[100:103], v[172:175], v[140:143], v[100:103]
    ds_read_b128 v[180:183], v9 offset:2048
    v_mfma_f32_16x16x32_bf16 v[104:107], v[148:151], v[144:147], v[104:107]
    ds_read_b128 v[184:187], v11 offset:0
    v_mfma_f32_16x16x32_bf16 v[108:111], v[152:155], v[144:147], v[108:111]
    ds_read_b128 v[188:191], v11 offset:2048
    v_mfma_f32_16x16x32_bf16 v[112:115], v[156:159], v[144:147], v[112:115]
    v_mfma_f32_16x16x32_bf16 v[116:119], v[160:163], v[144:147], v[116:119]
    buffer_load_dwordx4 v4, s[8:11], s34 offen offset:1024 lds
    s_add_u32 s46, s46, 32768
    s_cmp_ge_u32 s46, 98304
    s_cselect_b32 s38, 98304, 0
    s_sub_u32 s46, s46, s38
    v_mfma_f32_16x16x32_bf16 v[120:123], v[164:167], v[144:147], v[120:123]
    v_mfma_f32_16x16x32_bf16 v[124:127], v[168:171], v[144:147], v[124:127]
    v_add_u32 v8, s50, v8
    v_add_u32 v10, s50, v10
    v_mfma_f32_16x16x32_bf16 v[128:131], v[172:175], v[144:147], v[128:131]
    ds_write_b128 v2, v[220:223]
    s_waitcnt vmcnt(8) lgkmcnt(0)
    s_barrier
    v_mfma_f32_16x16x32_bf16 v[20:23], v[192:195], v[176:179], v[20:23]
    ds_read_b128 v[132:135], v8 offset:0
    v_mfma_f32_16x16x32_bf16 v[24:27], v[196:199], v[176:179], v[24:27]
    ds_read_b64_tr_b16 v[148:149], v16 offset:0
    v_mfma_f32_16x16x32_bf16 v[28:31], v[200:203], v[176:179], v[28:31]
    ds_read_b64_tr_b16 v[150:151], v16 offset:1024
    v_mfma_f32_16x16x32_bf16 v[32:35], v[204:207], v[176:179], v[32:35]
    s_add_u32 m0, s35, 43008
    s_nop 0
    buffer_load_dwordx4 v5, s[12:15], s37 offen lds
    v_mfma_f32_16x16x32_bf16 v[36:39], v[208:211], v[176:179], v[36:39]
    ds_read_b64_tr_b16 v[152:153], v17 offset:0
    v_mfma_f32_16x16x32_bf16 v[40:43], v[212:215], v[176:179], v[40:43]
    ds_read_b64_tr_b16 v[154:155], v17 offset:1024
    v_mfma_f32_16x16x32_bf16 v[44:47], v[216:219], v[176:179], v[44:47]
    ds_read_b64_tr_b16 v[156:157], v16 offset:2048
    v_mfma_f32_16x16x32_bf16 v[48:51], v[192:195], v[180:183], v[48:51]
    v_mfma_f32_16x16x32_bf16 v[52:55], v[196:199], v[180:183], v[52:55]
    ds_read_b64_tr_b16 v[158:159], v16 offset:3072
    v_mfma_f32_16x16x32_bf16 v[56:59], v[200:203], v[180:183], v[56:59]
    ds_read_b64_tr_b16 v[160:161], v17 offset:2048
    v_mfma_f32_16x16x32_bf16 v[60:63], v[204:207], v[180:183], v[60:63]
    ds_read_b64_tr_b16 v[162:163], v17 offset:3072
    buffer_load_dwordx4 v6, s[12:15], s37 offen offset:1024 lds
    s_add_u32 s37, s37, 229376
    v_mfma_f32_16x16x32_bf16 v[64:67], v[208:211], v[180:183], v[64:67]
    v_mfma_f32_16x16x32_bf16 v[68:71], v[212:215], v[180:183], v[68:71]
    ds_read_b64_tr_b16 v[164:165], v16 offset:4096
    v_mfma_f32_16x16x32_bf16 v[72:75], v[216:219], v[180:183], v[72:75]
    ds_read_b64_tr_b16 v[166:167], v16 offset:5120
    v_mfma_f32_16x16x32_bf16 v[76:79], v[192:195], v[184:187], v[76:79]
    ds_read_b64_tr_b16 v[168:169], v17 offset:4096
    v_mfma_f32_16x16x32_bf16 v[80:83], v[196:199], v[184:187], v[80:83]
    v_mfma_f32_16x16x32_bf16 v[84:87], v[200:203], v[184:187], v[84:87]
    ds_read_b64_tr_b16 v[170:171], v17 offset:5120
    v_mfma_f32_16x16x32_bf16 v[88:91], v[204:207], v[184:187], v[88:91]
    ds_read_b64_tr_b16 v[172:173], v0 offset:0
    s_mov_b32 m0, s46
    s_nop 0
    buffer_load_dwordx4 v3, s[8:11], s36 offen lds
    v_mfma_f32_16x16x32_bf16 v[92:95], v[208:211], v[184:187], v[92:95]
    ds_read_b64_tr_b16 v[174:175], v0 offset:1024
    v_mfma_f32_16x16x32_bf16 v[96:99], v[212:215], v[184:187], v[96:99]
    v_mfma_f32_16x16x32_bf16 v[100:103], v[216:219], v[184:187], v[100:103]
    ds_read_b128 v[136:139], v8 offset:2048
    v_mfma_f32_16x16x32_bf16 v[104:107], v[192:195], v[188:191], v[104:107]
    ds_read_b128 v[140:143], v10 offset:0
    v_mfma_f32_16x16x32_bf16 v[108:111], v[196:199], v[188:191], v[108:111]
    ds_read_b128 v[144:147], v10 offset:2048
    v_mfma_f32_16x16x32_bf16 v[112:115], v[200:203], v[188:191], v[112:115]
    v_mfma_f32_16x16x32_bf16 v[116:119], v[204:207], v[188:191], v[116:119]
    buffer_load_dwordx4 v4, s[8:11], s36 offen offset:1024 lds
    s_add_u32 s34, s36, 32768
    v_mfma_f32_16x16x32_bf16 v[120:123], v[208:211], v[188:191], v[120:123]
    v_mfma_f32_16x16x32_bf16 v[124:127], v[212:215], v[188:191], v[124:127]
    v_add_u32 v9, s50, v9
    v_add_u32 v11, s50, v11
    s_add_u32 s47, s47, s50
    s_cmp_eq_u32 s47, 65536
    s_cselect_b32 s50, 0xffff0000, s51
    v_mfma_f32_16x16x32_bf16 v[128:131], v[216:219], v[188:191], v[128:131]
    s_mov_b32 s44, 5
L_k1loop_40:
    s_waitcnt vmcnt(8) lgkmcnt(0)
    s_barrier
    v_mfma_f32_16x16x32_bf16 v[20:23], v[148:151], v[132:135], v[20:23]
    ds_read_b128 v[176:179], v9 offset:0
    v_mfma_f32_16x16x32_bf16 v[24:27], v[152:155], v[132:135], v[24:27]
    ds_read_b64_tr_b16 v[192:193], v16 offset:14336
    v_mfma_f32_16x16x32_bf16 v[28:31], v[156:159], v[132:135], v[28:31]
    ds_read_b64_tr_b16 v[194:195], v16 offset:15360
    v_mfma_f32_16x16x32_bf16 v[32:35], v[160:163], v[132:135], v[32:35]
    s_add_u32 m0, s35, 0
    s_nop 0
    buffer_load_dwordx4 v5, s[12:15], s37 offen lds
    v_mfma_f32_16x16x32_bf16 v[36:39], v[164:167], v[132:135], v[36:39]
    ds_read_b64_tr_b16 v[196:197], v17 offset:14336
    v_mfma_f32_16x16x32_bf16 v[40:43], v[168:171], v[132:135], v[40:43]
    ds_read_b64_tr_b16 v[198:199], v17 offset:15360
    v_mfma_f32_16x16x32_bf16 v[44:47], v[172:175], v[132:135], v[44:47]
    ds_read_b64_tr_b16 v[200:201], v16 offset:16384
    v_mfma_f32_16x16x32_bf16 v[48:51], v[148:151], v[136:139], v[48:51]
    v_mfma_f32_16x16x32_bf16 v[52:55], v[152:155], v[136:139], v[52:55]
    ds_read_b64_tr_b16 v[202:203], v16 offset:17408
    v_mfma_f32_16x16x32_bf16 v[56:59], v[156:159], v[136:139], v[56:59]
    ds_read_b64_tr_b16 v[204:205], v17 offset:16384
    v_mfma_f32_16x16x32_bf16 v[60:63], v[160:163], v[136:139], v[60:63]
    ds_read_b64_tr_b16 v[206:207], v17 offset:17408
    buffer_load_dwordx4 v6, s[12:15], s37 offen offset:1024 lds
    s_add_u32 s37, s37, 229376
    v_mfma_f32_16x16x32_bf16 v[64:67], v[164:167], v[136:139], v[64:67]
    v_mfma_f32_16x16x32_bf16 v[68:71], v[168:171], v[136:139], v[68:71]
    ds_read_b64_tr_b16 v[208:209], v16 offset:18432
    v_mfma_f32_16x16x32_bf16 v[72:75], v[172:175], v[136:139], v[72:75]
    ds_read_b64_tr_b16 v[210:211], v16 offset:19456
    v_mfma_f32_16x16x32_bf16 v[76:79], v[148:151], v[140:143], v[76:79]
    ds_read_b64_tr_b16 v[212:213], v17 offset:18432
    v_mfma_f32_16x16x32_bf16 v[80:83], v[152:155], v[140:143], v[80:83]
    v_mfma_f32_16x16x32_bf16 v[84:87], v[156:159], v[140:143], v[84:87]
    ds_read_b64_tr_b16 v[214:215], v17 offset:19456
    v_mfma_f32_16x16x32_bf16 v[88:91], v[160:163], v[140:143], v[88:91]
    ds_read_b64_tr_b16 v[216:217], v0 offset:14336
    s_add_u32 m0, s46, 2048
    s_add_u32 s36, s36, 128
    buffer_load_dwordx4 v3, s[8:11], s34 offen lds
    v_mfma_f32_16x16x32_bf16 v[92:95], v[164:167], v[140:143], v[92:95]
    ds_read_b64_tr_b16 v[218:219], v0 offset:15360
    v_mfma_f32_16x16x32_bf16 v[96:99], v[168:171], v[140:143], v[96:99]
    v_mfma_f32_16x16x32_bf16 v[100:103], v[172:175], v[140:143], v[100:103]
    ds_read_b128 v[180:183], v9 offset:2048
    v_mfma_f32_16x16x32_bf16 v[104:107], v[148:151], v[144:147], v[104:107]
    ds_read_b128 v[184:187], v11 offset:0
    v_mfma_f32_16x16x32_bf16 v[108:111], v[152:155], v[144:147], v[108:111]
    ds_read_b128 v[188:191], v11 offset:2048
    v_mfma_f32_16x16x32_bf16 v[112:115], v[156:159], v[144:147], v[112:115]
    v_mfma_f32_16x16x32_bf16 v[116:119], v[160:163], v[144:147], v[116:119]
    buffer_load_dwordx4 v4, s[8:11], s34 offen offset:1024 lds
    s_add_u32 s46, s46, 32768
    s_cmp_ge_u32 s46, 98304
    s_cselect_b32 s38, 98304, 0
    s_sub_u32 s46, s46, s38
    v_mfma_f32_16x16x32_bf16 v[120:123], v[164:167], v[144:147], v[120:123]
    v_mfma_f32_16x16x32_bf16 v[124:127], v[168:171], v[144:147], v[124:127]
    v_add_u32 v8, s50, v8
    v_add_u32 v10, s50, v10
    v_mfma_f32_16x16x32_bf16 v[128:131], v[172:175], v[144:147], v[128:131]
    s_waitcnt vmcnt(8) lgkmcnt(0)
    s_barrier
    v_mfma_f32_16x16x32_bf16 v[20:23], v[192:195], v[176:179], v[20:23]
    ds_read_b128 v[132:135], v8 offset:0
    v_mfma_f32_16x16x32_bf16 v[24:27], v[196:199], v[176:179], v[24:27]
    ds_read_b64_tr_b16 v[148:149], v16 offset:28672
    v_mfma_f32_16x16x32_bf16 v[28:31], v[200:203], v[176:179], v[28:31]
    ds_read_b64_tr_b16 v[150:151], v16 offset:29696
    v_mfma_f32_16x16x32_bf16 v[32:35], v[204:207], v[176:179], v[32:35]
    s_add_u32 m0, s35, 14336
    s_nop 0
    buffer_load_dwordx4 v5, s[12:15], s37 offen lds
    v_mfma_f32_16x16x32_bf16 v[36:39], v[208:211], v[176:179], v[36:39]
    ds_read_b64_tr_b16 v[152:153], v17 offset:28672
    v_mfma_f32_16x16x32_bf16 v[40:43], v[212:215], v[176:179], v[40:43]
    ds_read_b64_tr_b16 v[154:155], v17 offset:29696
    v_mfma_f32_16x16x32_bf16 v[44:47], v[216:219], v[176:179], v[44:47]
    ds_read_b64_tr_b16 v[156:157], v16 offset:30720
    v_mfma_f32_16x16x32_bf16 v[48:51], v[192:195], v[180:183], v[48:51]
    v_mfma_f32_16x16x32_bf16 v[52:55], v[196:199], v[180:183], v[52:55]
    ds_read_b64_tr_b16 v[158:159], v16 offset:31744
    v_mfma_f32_16x16x32_bf16 v[56:59], v[200:203], v[180:183], v[56:59]
    ds_read_b64_tr_b16 v[160:161], v17 offset:30720
    v_mfma_f32_16x16x32_bf16 v[60:63], v[204:207], v[180:183], v[60:63]
    ds_read_b64_tr_b16 v[162:163], v17 offset:31744
    buffer_load_dwordx4 v6, s[12:15], s37 offen offset:1024 lds
    s_add_u32 s37, s37, 229376
    v_mfma_f32_16x16x32_bf16 v[64:67], v[208:211], v[180:183], v[64:67]
    v_mfma_f32_16x16x32_bf16 v[68:71], v[212:215], v[180:183], v[68:71]
    ds_read_b64_tr_b16 v[164:165], v16 offset:32768
    v_mfma_f32_16x16x32_bf16 v[72:75], v[216:219], v[180:183], v[72:75]
    ds_read_b64_tr_b16 v[166:167], v16 offset:33792
    v_mfma_f32_16x16x32_bf16 v[76:79], v[192:195], v[184:187], v[76:79]
    ds_read_b64_tr_b16 v[168:169], v17 offset:32768
    v_mfma_f32_16x16x32_bf16 v[80:83], v[196:199], v[184:187], v[80:83]
    v_mfma_f32_16x16x32_bf16 v[84:87], v[200:203], v[184:187], v[84:87]
    ds_read_b64_tr_b16 v[170:171], v17 offset:33792
    v_mfma_f32_16x16x32_bf16 v[88:91], v[204:207], v[184:187], v[88:91]
    ds_read_b64_tr_b16 v[172:173], v0 offset:28672
    s_mov_b32 m0, s46
    s_nop 0
    buffer_load_dwordx4 v3, s[8:11], s36 offen lds
    v_mfma_f32_16x16x32_bf16 v[92:95], v[208:211], v[184:187], v[92:95]
    ds_read_b64_tr_b16 v[174:175], v0 offset:29696
    v_mfma_f32_16x16x32_bf16 v[96:99], v[212:215], v[184:187], v[96:99]
    v_mfma_f32_16x16x32_bf16 v[100:103], v[216:219], v[184:187], v[100:103]
    ds_read_b128 v[136:139], v8 offset:2048
    v_mfma_f32_16x16x32_bf16 v[104:107], v[192:195], v[188:191], v[104:107]
    ds_read_b128 v[140:143], v10 offset:0
    v_mfma_f32_16x16x32_bf16 v[108:111], v[196:199], v[188:191], v[108:111]
    ds_read_b128 v[144:147], v10 offset:2048
    v_mfma_f32_16x16x32_bf16 v[112:115], v[200:203], v[188:191], v[112:115]
    v_mfma_f32_16x16x32_bf16 v[116:119], v[204:207], v[188:191], v[116:119]
    buffer_load_dwordx4 v4, s[8:11], s36 offen offset:1024 lds
    s_add_u32 s34, s36, 32768
    v_mfma_f32_16x16x32_bf16 v[120:123], v[208:211], v[188:191], v[120:123]
    v_mfma_f32_16x16x32_bf16 v[124:127], v[212:215], v[188:191], v[124:127]
    v_add_u32 v9, s50, v9
    v_add_u32 v11, s50, v11
    s_add_u32 s47, s47, s50
    s_cmp_eq_u32 s47, 65536
    s_cselect_b32 s50, 0xffff0000, s51
    v_mfma_f32_16x16x32_bf16 v[128:131], v[216:219], v[188:191], v[128:131]
    s_waitcnt vmcnt(8) lgkmcnt(0)
    s_barrier
    v_mfma_f32_16x16x32_bf16 v[20:23], v[148:151], v[132:135], v[20:23]
    ds_read_b128 v[176:179], v9 offset:0
    v_mfma_f32_16x16x32_bf16 v[24:27], v[152:155], v[132:135], v[24:27]
    ds_read_b64_tr_b16 v[192:193], v16 offset:43008
    v_mfma_f32_16x16x32_bf16 v[28:31], v[156:159], v[132:135], v[28:31]
    ds_read_b64_tr_b16 v[194:195], v16 offset:44032
    v_mfma_f32_16x16x32_bf16 v[32:35], v[160:163], v[132:135], v[32:35]
    s_add_u32 m0, s35, 28672
    s_nop 0
    buffer_load_dwordx4 v5, s[12:15], s37 offen lds
    v_mfma_f32_16x16x32_bf16 v[36:39], v[164:167], v[132:135], v[36:39]
    ds_read_b64_tr_b16 v[196:197], v17 offset:43008
    v_mfma_f32_16x16x32_bf16 v[40:43], v[168:171], v[132:135], v[40:43]
    ds_read_b64_tr_b16 v[198:199], v17 offset:44032
    v_mfma_f32_16x16x32_bf16 v[44:47], v[172:175], v[132:135], v[44:47]
    ds_read_b64_tr_b16 v[200:201], v16 offset:45056
    v_mfma_f32_16x16x32_bf16 v[48:51], v[148:151], v[136:139], v[48:51]
    v_mfma_f32_16x16x32_bf16 v[52:55], v[152:155], v[136:139], v[52:55]
    ds_read_b64_tr_b16 v[202:203], v16 offset:46080
    v_mfma_f32_16x16x32_bf16 v[56:59], v[156:159], v[136:139], v[56:59]
    ds_read_b64_tr_b16 v[204:205], v17 offset:45056
    v_mfma_f32_16x16x32_bf16 v[60:63], v[160:163], v[136:139], v[60:63]
    ds_read_b64_tr_b16 v[206:207], v17 offset:46080
    buffer_load_dwordx4 v6, s[12:15], s37 offen offset:1024 lds
    s_add_u32 s37, s37, 229376
    v_mfma_f32_16x16x32_bf16 v[64:67], v[164:167], v[136:139], v[64:67]
    v_mfma_f32_16x16x32_bf16 v[68:71], v[168:171], v[136:139], v[68:71]
    ds_read_b64_tr_b16 v[208:209], v16 offset:47104
    v_mfma_f32_16x16x32_bf16 v[72:75], v[172:175], v[136:139], v[72:75]
    ds_read_b64_tr_b16 v[210:211], v16 offset:48128
    v_mfma_f32_16x16x32_bf16 v[76:79], v[148:151], v[140:143], v[76:79]
    ds_read_b64_tr_b16 v[212:213], v17 offset:47104
    v_mfma_f32_16x16x32_bf16 v[80:83], v[152:155], v[140:143], v[80:83]
    v_mfma_f32_16x16x32_bf16 v[84:87], v[156:159], v[140:143], v[84:87]
    ds_read_b64_tr_b16 v[214:215], v17 offset:48128
    v_mfma_f32_16x16x32_bf16 v[88:91], v[160:163], v[140:143], v[88:91]
    ds_read_b64_tr_b16 v[216:217], v0 offset:43008
    s_add_u32 m0, s46, 2048
    s_add_u32 s36, s36, 128
    buffer_load_dwordx4 v3, s[8:11], s34 offen lds
    v_mfma_f32_16x16x32_bf16 v[92:95], v[164:167], v[140:143], v[92:95]
    ds_read_b64_tr_b16 v[218:219], v0 offset:44032
    v_mfma_f32_16x16x32_bf16 v[96:99], v[168:171], v[140:143], v[96:99]
    v_mfma_f32_16x16x32_bf16 v[100:103], v[172:175], v[140:143], v[100:103]
    ds_read_b128 v[180:183], v9 offset:2048
    v_mfma_f32_16x16x32_bf16 v[104:107], v[148:151], v[144:147], v[104:107]
    ds_read_b128 v[184:187], v11 offset:0
    v_mfma_f32_16x16x32_bf16 v[108:111], v[152:155], v[144:147], v[108:111]
    ds_read_b128 v[188:191], v11 offset:2048
    v_mfma_f32_16x16x32_bf16 v[112:115], v[156:159], v[144:147], v[112:115]
    v_mfma_f32_16x16x32_bf16 v[116:119], v[160:163], v[144:147], v[116:119]
    buffer_load_dwordx4 v4, s[8:11], s34 offen offset:1024 lds
    s_add_u32 s46, s46, 32768
    s_cmp_ge_u32 s46, 98304
    s_cselect_b32 s38, 98304, 0
    s_sub_u32 s46, s46, s38
    v_mfma_f32_16x16x32_bf16 v[120:123], v[164:167], v[144:147], v[120:123]
    v_mfma_f32_16x16x32_bf16 v[124:127], v[168:171], v[144:147], v[124:127]
    v_add_u32 v8, s50, v8
    v_add_u32 v10, s50, v10
    v_mfma_f32_16x16x32_bf16 v[128:131], v[172:175], v[144:147], v[128:131]
    s_waitcnt vmcnt(8) lgkmcnt(0)
    s_barrier
    v_mfma_f32_16x16x32_bf16 v[20:23], v[192:195], v[176:179], v[20:23]
    ds_read_b128 v[132:135], v8 offset:0
    v_mfma_f32_16x16x32_bf16 v[24:27], v[196:199], v[176:179], v[24:27]
    ds_read_b64_tr_b16 v[148:149], v16 offset:0
    v_mfma_f32_16x16x32_bf16 v[28:31], v[200:203], v[176:179], v[28:31]
    ds_read_b64_tr_b16 v[150:151], v16 offset:1024
    v_mfma_f32_16x16x32_bf16 v[32:35], v[204:207], v[176:179], v[32:35]
    s_add_u32 m0, s35, 43008
    s_nop 0
    buffer_load_dwordx4 v5, s[12:15], s37 offen lds
    v_mfma_f32_16x16x32_bf16 v[36:39], v[208:211], v[176:179], v[36:39]
    ds_read_b64_tr_b16 v[152:153], v17 offset:0
    v_mfma_f32_16x16x32_bf16 v[40:43], v[212:215], v[176:179], v[40:43]
    ds_read_b64_tr_b16 v[154:155], v17 offset:1024
    v_mfma_f32_16x16x32_bf16 v[44:47], v[216:219], v[176:179], v[44:47]
    ds_read_b64_tr_b16 v[156:157], v16 offset:2048
    v_mfma_f32_16x16x32_bf16 v[48:51], v[192:195], v[180:183], v[48:51]
    v_mfma_f32_16x16x32_bf16 v[52:55], v[196:199], v[180:183], v[52:55]
    ds_read_b64_tr_b16 v[158:159], v16 offset:3072
    v_mfma_f32_16x16x32_bf16 v[56:59], v[200:203], v[180:183], v[56:59]
    ds_read_b64_tr_b16 v[160:161], v17 offset:2048
    v_mfma_f32_16x16x32_bf16 v[60:63], v[204:207], v[180:183], v[60:63]
    ds_read_b64_tr_b16 v[162:163], v17 offset:3072
    buffer_load_dwordx4 v6, s[12:15], s37 offen offset:1024 lds
    s_add_u32 s37, s37, 229376
    v_mfma_f32_16x16x32_bf16 v[64:67], v[208:211], v[180:183], v[64:67]
    v_mfma_f32_16x16x32_bf16 v[68:71], v[212:215], v[180:183], v[68:71]
    ds_read_b64_tr_b16 v[164:165], v16 offset:4096
    v_mfma_f32_16x16x32_bf16 v[72:75], v[216:219], v[180:183], v[72:75]
    ds_read_b64_tr_b16 v[166:167], v16 offset:5120
    v_mfma_f32_16x16x32_bf16 v[76:79], v[192:195], v[184:187], v[76:79]
    ds_read_b64_tr_b16 v[168:169], v17 offset:4096
    v_mfma_f32_16x16x32_bf16 v[80:83], v[196:199], v[184:187], v[80:83]
    v_mfma_f32_16x16x32_bf16 v[84:87], v[200:203], v[184:187], v[84:87]
    ds_read_b64_tr_b16 v[170:171], v17 offset:5120
    v_mfma_f32_16x16x32_bf16 v[88:91], v[204:207], v[184:187], v[88:91]
    ds_read_b64_tr_b16 v[172:173], v0 offset:0
    s_mov_b32 m0, s46
    s_nop 0
    buffer_load_dwordx4 v3, s[8:11], s36 offen lds
    v_mfma_f32_16x16x32_bf16 v[92:95], v[208:211], v[184:187], v[92:95]
    ds_read_b64_tr_b16 v[174:175], v0 offset:1024
    v_mfma_f32_16x16x32_bf16 v[96:99], v[212:215], v[184:187], v[96:99]
    v_mfma_f32_16x16x32_bf16 v[100:103], v[216:219], v[184:187], v[100:103]
    ds_read_b128 v[136:139], v8 offset:2048
    v_mfma_f32_16x16x32_bf16 v[104:107], v[192:195], v[188:191], v[104:107]
    ds_read_b128 v[140:143], v10 offset:0
    v_mfma_f32_16x16x32_bf16 v[108:111], v[196:199], v[188:191], v[108:111]
    ds_read_b128 v[144:147], v10 offset:2048
    v_mfma_f32_16x16x32_bf16 v[112:115], v[200:203], v[188:191], v[112:115]
    v_mfma_f32_16x16x32_bf16 v[116:119], v[204:207], v[188:191], v[116:119]
    buffer_load_dwordx4 v4, s[8:11], s36 offen offset:1024 lds
    s_add_u32 s34, s36, 32768
    v_mfma_f32_16x16x32_bf16 v[120:123], v[208:211], v[188:191], v[120:123]
    v_mfma_f32_16x16x32_bf16 v[124:127], v[212:215], v[188:191], v[124:127]
    v_add_u32 v9, s50, v9
    v_add_u32 v11, s50, v11
    s_add_u32 s47, s47, s50
    s_cmp_eq_u32 s47, 65536
    s_cselect_b32 s50, 0xffff0000, s51
    v_mfma_f32_16x16x32_bf16 v[128:131], v[216:219], v[188:191], v[128:131]
    s_sub_u32 s44, s44, 1
    s_cmp_lg_u32 s44, 0
    s_cbranch_scc1 L_k1loop_40
    s_waitcnt vmcnt(8) lgkmcnt(0)
    s_barrier
    v_mfma_f32_16x16x32_bf16 v[20:23], v[148:151], v[132:135], v[20:23]
    ds_read_b128 v[176:179], v9 offset:0
    v_mfma_f32_16x16x32_bf16 v[24:27], v[152:155], v[132:135], v[24:27]
    ds_read_b64_tr_b16 v[192:193], v16 offset:14336
    v_mfma_f32_16x16x32_bf16 v[28:31], v[156:159], v[132:135], v[28:31]
    ds_read_b64_tr_b16 v[194:195], v16 offset:15360
    v_mfma_f32_16x16x32_bf16 v[32:35], v[160:163], v[132:135], v[32:35]
    v_mfma_f32_16x16x32_bf16 v[36:39], v[164:167], v[132:135], v[36:39]
    ds_read_b64_tr_b16 v[196:197], v17 offset:14336
    v_mfma_f32_16x16x32_bf16 v[40:43], v[168:171], v[132:135], v[40:43]
    ds_read_b64_tr_b16 v[198:199], v17 offset:15360
    v_mfma_f32_16x16x32_bf16 v[44:47], v[172:175], v[132:135], v[44:47]
    ds_read_b64_tr_b16 v[200:201], v16 offset:16384
    v_mfma_f32_16x16x32_bf16 v[48:51], v[148:151], v[136:139], v[48:51]
    v_mfma_f32_16x16x32_bf16 v[52:55], v[152:155], v[136:139], v[52:55]
    ds_read_b64_tr_b16 v[202:203], v16 offset:17408
    v_mfma_f32_16x16x32_bf16 v[56:59], v[156:159], v[136:139], v[56:59]
    ds_read_b64_tr_b16 v[204:205], v17 offset:16384
    v_mfma_f32_16x16x32_bf16 v[60:63], v[160:163], v[136:139], v[60:63]
    ds_read_b64_tr_b16 v[206:207], v17 offset:17408
    v_mfma_f32_16x16x32_bf16 v[64:67], v[164:167], v[136:139], v[64:67]
    v_mfma_f32_16x16x32_bf16 v[68:71], v[168:171], v[136:139], v[68:71]
    ds_read_b64_tr_b16 v[208:209], v16 offset:18432
    v_mfma_f32_16x16x32_bf16 v[72:75], v[172:175], v[136:139], v[72:75]
    ds_read_b64_tr_b16 v[210:211], v16 offset:19456
    v_mfma_f32_16x16x32_bf16 v[76:79], v[148:151], v[140:143], v[76:79]
    ds_read_b64_tr_b16 v[212:213], v17 offset:18432
    v_mfma_f32_16x16x32_bf16 v[80:83], v[152:155], v[140:143], v[80:83]
    v_mfma_f32_16x16x32_bf16 v[84:87], v[156:159], v[140:143], v[84:87]
    ds_read_b64_tr_b16 v[214:215], v17 offset:19456
    v_mfma_f32_16x16x32_bf16 v[88:91], v[160:163], v[140:143], v[88:91]
    ds_read_b64_tr_b16 v[216:217], v0 offset:14336
    v_mfma_f32_16x16x32_bf16 v[92:95], v[164:167], v[140:143], v[92:95]
    ds_read_b64_tr_b16 v[218:219], v0 offset:15360
    v_mfma_f32_16x16x32_bf16 v[96:99], v[168:171], v[140:143], v[96:99]
    v_mfma_f32_16x16x32_bf16 v[100:103], v[172:175], v[140:143], v[100:103]
    ds_read_b128 v[180:183], v9 offset:2048
    v_mfma_f32_16x16x32_bf16 v[104:107], v[148:151], v[144:147], v[104:107]
    ds_read_b128 v[184:187], v11 offset:0
    v_mfma_f32_16x16x32_bf16 v[108:111], v[152:155], v[144:147], v[108:111]
    ds_read_b128 v[188:191], v11 offset:2048
    v_mfma_f32_16x16x32_bf16 v[112:115], v[156:159], v[144:147], v[112:115]
    v_mfma_f32_16x16x32_bf16 v[116:119], v[160:163], v[144:147], v[116:119]
    v_mfma_f32_16x16x32_bf16 v[120:123], v[164:167], v[144:147], v[120:123]
    v_mfma_f32_16x16x32_bf16 v[124:127], v[168:171], v[144:147], v[124:127]
    v_add_u32 v8, s50, v8
    v_add_u32 v10, s50, v10
    v_mfma_f32_16x16x32_bf16 v[128:131], v[172:175], v[144:147], v[128:131]
    s_waitcnt vmcnt(4) lgkmcnt(0)
    s_barrier
    v_mfma_f32_16x16x32_bf16 v[20:23], v[192:195], v[176:179], v[20:23]
    ds_read_b128 v[132:135], v8 offset:0
    v_mfma_f32_16x16x32_bf16 v[24:27], v[196:199], v[176:179], v[24:27]
    ds_read_b64_tr_b16 v[148:149], v16 offset:28672
    v_mfma_f32_16x16x32_bf16 v[28:31], v[200:203], v[176:179], v[28:31]
    ds_read_b64_tr_b16 v[150:151], v16 offset:29696
    v_mfma_f32_16x16x32_bf16 v[32:35], v[204:207], v[176:179], v[32:35]
    v_mfma_f32_16x16x32_bf16 v[36:39], v[208:211], v[176:179], v[36:39]
    ds_read_b64_tr_b16 v[152:153], v17 offset:28672
    v_mfma_f32_16x16x32_bf16 v[40:43], v[212:215], v[176:179], v[40:43]
    ds_read_b64_tr_b16 v[154:155], v17 offset:29696
    v_mfma_f32_16x16x32_bf16 v[44:47], v[216:219], v[176:179], v[44:47]
    ds_read_b64_tr_b16 v[156:157], v16 offset:30720
    v_mfma_f32_16x16x32_bf16 v[48:51], v[192:195], v[180:183], v[48:51]
    v_mfma_f32_16x16x32_bf16 v[52:55], v[196:199], v[180:183], v[52:55]
    ds_read_b64_tr_b16 v[158:159], v16 offset:31744
    v_mfma_f32_16x16x32_bf16 v[56:59], v[200:203], v[180:183], v[56:59]
    ds_read_b64_tr_b16 v[160:161], v17 offset:30720
    v_mfma_f32_16x16x32_bf16 v[60:63], v[204:207], v[180:183], v[60:63]
    ds_read_b64_tr_b16 v[162:163], v17 offset:31744
    v_mfma_f32_16x16x32_bf16 v[64:67], v[208:211], v[180:183], v[64:67]
    v_mfma_f32_16x16x32_bf16 v[68:71], v[212:215], v[180:183], v[68:71]
    ds_read_b64_tr_b16 v[164:165], v16 offset:32768
    v_mfma_f32_16x16x32_bf16 v[72:75], v[216:219], v[180:183], v[72:75]
    ds_read_b64_tr_b16 v[166:167], v16 offset:33792
    v_mfma_f32_16x16x32_bf16 v[76:79], v[192:195], v[184:187], v[76:79]
    ds_read_b64_tr_b16 v[168:169], v17 offset:32768
    v_mfma_f32_16x16x32_bf16 v[80:83], v[196:199], v[184:187], v[80:83]
    v_mfma_f32_16x16x32_bf16 v[84:87], v[200:203], v[184:187], v[84:87]
    ds_read_b64_tr_b16 v[170:171], v17 offset:33792
    v_mfma_f32_16x16x32_bf16 v[88:91], v[204:207], v[184:187], v[88:91]
    ds_read_b64_tr_b16 v[172:173], v0 offset:28672
    v_mfma_f32_16x16x32_bf16 v[92:95], v[208:211], v[184:187], v[92:95]
    ds_read_b64_tr_b16 v[174:175], v0 offset:29696
    v_mfma_f32_16x16x32_bf16 v[96:99], v[212:215], v[184:187], v[96:99]
    v_mfma_f32_16x16x32_bf16 v[100:103], v[216:219], v[184:187], v[100:103]
    ds_read_b128 v[136:139], v8 offset:2048
    v_mfma_f32_16x16x32_bf16 v[104:107], v[192:195], v[188:191], v[104:107]
    ds_read_b128 v[140:143], v10 offset:0
    v_mfma_f32_16x16x32_bf16 v[108:111], v[196:199], v[188:191], v[108:111]
    ds_read_b128 v[144:147], v10 offset:2048
    v_mfma_f32_16x16x32_bf16 v[112:115], v[200:203], v[188:191], v[112:115]
    v_mfma_f32_16x16x32_bf16 v[116:119], v[204:207], v[188:191], v[116:119]
    v_mfma_f32_16x16x32_bf16 v[120:123], v[208:211], v[188:191], v[120:123]
    v_mfma_f32_16x16x32_bf16 v[124:127], v[212:215], v[188:191], v[124:127]
    v_add_u32 v9, s50, v9
    v_add_u32 v11, s50, v11
    s_add_u32 s47, s47, s50
    s_cmp_eq_u32 s47, 65536
    s_cselect_b32 s50, 0xffff0000, s51
    v_mfma_f32_16x16x32_bf16 v[128:131], v[216:219], v[188:191], v[128:131]
    s_waitcnt vmcnt(0) lgkmcnt(0)
    s_barrier
    v_lshlrev_b32 v7, 6, v1
    s_lshl_b32 s38, s31, 12
    s_mov_b32 s16, s90
    s_mov_b32 s17, s91
    s_mov_b32 s18, 0x700000
    s_mov_b32 s19, 0x00020000
    buffer_load_dword v3, v7, s[16:19], s38 offen
    s_mov_b32 s16, s92
    s_mov_b32 s17, s93
    s_mov_b32 s18, 0x200000
    s_mov_b32 s19, 0x00020000
    buffer_load_dword v4, v7, s[16:19], s38 offen
    s_lshl_b32 s38, s32, 7
    s_sub_u32 s39, 156544, s38
    s_add_u32 s38, s38, 155648
    v_and_b32 v2, 15, v1
    v_and_b32 v7, 48, v1
    v_lshl_add_u32 v12, v2, 2, s38
    v_lshl_add_u32 v13, v2, 2, s39
    s_lshl_b32 s38, s33, 9
    s_add_u32 s38, s38, 157696
    v_add_u32 v5, s38, v7
    v_lshrrev_b32 v7, 1, v7
    s_lshl_b32 s38, s33, 8
    s_add_u32 s38, s38, 159744
    v_add_u32 v14, s38, v7
    v_and_b32 v2, 16, v1
    v_lshrrev_b32 v7, 3, v1
    v_and_b32 v7, 4, v7
    v_add_u32 v2, v2, v7
    s_lshl_b32 s38, s33, 5
    s_add_u32 s38, s38, 158080
    v_lshl_add_u32 v6, v2, 2, s38
    s_lshl_b32 s38, s33, 4
    s_add_u32 s38, s38, 159936
    v_lshl_add_u32 v15, v2, 1, s38
    v_mfma_f32_16x16x32_bf16 v[20:23], v[148:151], v[132:135], v[20:23]
    ds_read_b128 v[176:179], v9 offset:0
    v_mfma_f32_16x16x32_bf16 v[24:27], v[152:155], v[132:135], v[24:27]
    ds_read_b64_tr_b16 v[192:193], v16 offset:43008
    v_mfma_f32_16x16x32_bf16 v[28:31], v[156:159], v[132:135], v[28:31]
    ds_read_b64_tr_b16 v[194:195], v16 offset:44032
    v_mfma_f32_16x16x32_bf16 v[32:35], v[160:163], v[132:135], v[32:35]
    v_mfma_f32_16x16x32_bf16 v[36:39], v[164:167], v[132:135], v[36:39]
    ds_read_b64_tr_b16 v[196:197], v17 offset:43008
    v_mfma_f32_16x16x32_bf16 v[40:43], v[168:171], v[132:135], v[40:43]
    ds_read_b64_tr_b16 v[198:199], v17 offset:44032
    v_mfma_f32_16x16x32_bf16 v[44:47], v[172:175], v[132:135], v[44:47]
    ds_read_b64_tr_b16 v[200:201], v16 offset:45056
    v_mfma_f32_16x16x32_bf16 v[48:51], v[148:151], v[136:139], v[48:51]
    v_mfma_f32_16x16x32_bf16 v[52:55], v[152:155], v[136:139], v[52:55]
    ds_read_b64_tr_b16 v[202:203], v16 offset:46080
    v_mfma_f32_16x16x32_bf16 v[56:59], v[156:159], v[136:139], v[56:59]
    ds_read_b64_tr_b16 v[204:205], v17 offset:45056
    v_mfma_f32_16x16x32_bf16 v[60:63], v[160:163], v[136:139], v[60:63]
    ds_read_b64_tr_b16 v[206:207], v17 offset:46080
    v_mfma_f32_16x16x32_bf16 v[64:67], v[164:167], v[136:139], v[64:67]
    v_mfma_f32_16x16x32_bf16 v[68:71], v[168:171], v[136:139], v[68:71]
    ds_read_b64_tr_b16 v[208:209], v16 offset:47104
    v_mfma_f32_16x16x32_bf16 v[72:75], v[172:175], v[136:139], v[72:75]
    ds_read_b64_tr_b16 v[210:211], v16 offset:48128
    v_mfma_f32_16x16x32_bf16 v[76:79], v[148:151], v[140:143], v[76:79]
    ds_read_b64_tr_b16 v[212:213], v17 offset:47104
    v_mfma_f32_16x16x32_bf16 v[80:83], v[152:155], v[140:143], v[80:83]
    v_mfma_f32_16x16x32_bf16 v[84:87], v[156:159], v[140:143], v[84:87]
    ds_read_b64_tr_b16 v[214:215], v17 offset:48128
    v_mfma_f32_16x16x32_bf16 v[88:91], v[160:163], v[140:143], v[88:91]
    ds_read_b64_tr_b16 v[216:217], v0 offset:43008
    v_mfma_f32_16x16x32_bf16 v[92:95], v[164:167], v[140:143], v[92:95]
    ds_read_b64_tr_b16 v[218:219], v0 offset:44032
    v_mfma_f32_16x16x32_bf16 v[96:99], v[168:171], v[140:143], v[96:99]
    v_mfma_f32_16x16x32_bf16 v[100:103], v[172:175], v[140:143], v[100:103]
    ds_read_b128 v[180:183], v9 offset:2048
    v_mfma_f32_16x16x32_bf16 v[104:107], v[148:151], v[144:147], v[104:107]
    ds_read_b128 v[184:187], v11 offset:0
    v_mfma_f32_16x16x32_bf16 v[108:111], v[152:155], v[144:147], v[108:111]
    ds_read_b128 v[188:191], v11 offset:2048
    v_mfma_f32_16x16x32_bf16 v[112:115], v[156:159], v[144:147], v[112:115]
    v_mfma_f32_16x16x32_bf16 v[116:119], v[160:163], v[144:147], v[116:119]
    v_mfma_f32_16x16x32_bf16 v[120:123], v[164:167], v[144:147], v[120:123]
    v_mfma_f32_16x16x32_bf16 v[124:127], v[168:171], v[144:147], v[124:127]
    v_add_u32 v8, s50, v8
    v_add_u32 v10, s50, v10
    v_mfma_f32_16x16x32_bf16 v[128:131], v[172:175], v[144:147], v[128:131]
    s_waitcnt vmcnt(2) lgkmcnt(0)
    s_barrier
    v_mfma_f32_16x16x32_bf16 v[20:23], v[192:195], v[176:179], v[20:23]
    ds_read_b32 v220, v12 offset:0
    ds_read_b32 v221, v12 offset:1024
    v_mfma_f32_16x16x32_bf16 v[24:27], v[196:199], v[176:179], v[24:27]
    ds_read_b32 v222, v12 offset:64
    v_mfma_f32_16x16x32_bf16 v[28:31], v[200:203], v[176:179], v[28:31]
    ds_read_b32 v223, v12 offset:1088
    v_mfma_f32_16x16x32_bf16 v[32:35], v[204:207], v[176:179], v[32:35]
    ds_read_b32 v224, v13 offset:0
    v_mfma_f32_16x16x32_bf16 v[36:39], v[208:211], v[176:179], v[36:39]
    ds_read_b32 v225, v13 offset:1024
    ds_read_b32 v226, v13 offset:64
    v_mfma_f32_16x16x32_bf16 v[40:43], v[212:215], v[176:179], v[40:43]
    ds_read_b32 v227, v13 offset:1088
    v_mfma_f32_16x16x32_bf16 v[44:47], v[216:219], v[176:179], v[44:47]
    ds_read_b128 v[132:135], v5 offset:0
    v_mfma_f32_16x16x32_bf16 v[48:51], v[192:195], v[180:183], v[48:51]
    ds_read_b128 v[136:139], v5 offset:64
    v_mfma_f32_16x16x32_bf16 v[52:55], v[196:199], v[180:183], v[52:55]
    ds_read_b128 v[140:143], v5 offset:128
    v_mfma_f32_16x16x32_bf16 v[56:59], v[200:203], v[180:183], v[56:59]
    ds_read_b128 v[144:147], v5 offset:192
    ds_read_b128 v[148:151], v5 offset:256
    v_mfma_f32_16x16x32_bf16 v[60:63], v[204:207], v[180:183], v[60:63]
    ds_read_b128 v[152:155], v5 offset:320
    v_mfma_f32_16x16x32_bf16 v[64:67], v[208:211], v[180:183], v[64:67]
    ds_read_b128 v[156:159], v6 offset:0
    v_mfma_f32_16x16x32_bf16 v[68:71], v[212:215], v[180:183], v[68:71]
    ds_read_b128 v[228:231], v5 offset:1024
    v_mfma_f32_16x16x32_bf16 v[72:75], v[216:219], v[180:183], v[72:75]
    ds_read_b128 v[232:235], v5 offset:1088
    v_mfma_f32_16x16x32_bf16 v[76:79], v[192:195], v[184:187], v[76:79]
    ds_read_b128 v[236:239], v5 offset:1152
    ds_read_b128 v[240:243], v5 offset:1216
    v_mfma_f32_16x16x32_bf16 v[80:83], v[196:199], v[184:187], v[80:83]
    ds_read_b128 v[244:247], v5 offset:1280
    v_mfma_f32_16x16x32_bf16 v[84:87], v[200:203], v[184:187], v[84:87]
    ds_read_b128 v[248:251], v5 offset:1344
    v_mfma_f32_16x16x32_bf16 v[88:91], v[204:207], v[184:187], v[88:91]
    ds_read_b128 v[252:255], v6 offset:1024
    v_mfma_f32_16x16x32_bf16 v[92:95], v[208:211], v[184:187], v[92:95]
    ds_read_b64 v[160:161], v14 offset:0
    v_mfma_f32_16x16x32_bf16 v[96:99], v[212:215], v[184:187], v[96:99]
    ds_read_b64 v[162:163], v14 offset:32
    ds_read_b64 v[164:165], v14 offset:64
    v_mfma_f32_16x16x32_bf16 v[100:103], v[216:219], v[184:187], v[100:103]
    ds_read_b64 v[166:167], v14 offset:96
    v_mfma_f32_16x16x32_bf16 v[104:107], v[192:195], v[188:191], v[104:107]
    ds_read_b64 v[168:169], v14 offset:128
    v_mfma_f32_16x16x32_bf16 v[108:111], v[196:199], v[188:191], v[108:111]
    ds_read_b64 v[170:171], v14 offset:160
    v_mfma_f32_16x16x32_bf16 v[112:115], v[200:203], v[188:191], v[112:115]
    ds_read_b64 v[172:173], v15 offset:0
    v_mfma_f32_16x16x32_bf16 v[116:119], v[204:207], v[188:191], v[116:119]
    v_mfma_f32_16x16x32_bf16 v[120:123], v[208:211], v[188:191], v[120:123]
    v_mfma_f32_16x16x32_bf16 v[124:127], v[212:215], v[188:191], v[124:127]
    v_add_u32 v9, s50, v9
    v_add_u32 v11, s50, v11
    s_add_u32 s47, s47, s50
    s_cmp_eq_u32 s47, 65536
    s_cselect_b32 s50, 0xffff0000, s51
    v_mfma_f32_16x16x32_bf16 v[128:131], v[216:219], v[188:191], v[128:131]
    s_branch L_k1_w1_epi
L_k1_w1_role1:
    s_mov_b32 m0, s46
    s_nop 0
    buffer_load_dwordx4 v3, s[8:11], s36 offen lds
    buffer_load_dwordx4 v4, s[8:11], s36 offen offset:1024 lds
    s_add_u32 s34, s36, 32768
    s_add_u32 m0, s46, 2048
    s_add_u32 s36, s36, 128
    buffer_load_dwordx4 v3, s[8:11], s34 offen lds
    buffer_load_dwordx4 v4, s[8:11], s34 offen offset:1024 lds
    s_add_u32 s46, s46, 32768
    s_cmp_ge_u32 s46, 98304
    s_cselect_b32 s38, 98304, 0
    s_sub_u32 s46, s46, s38
    s_cmp_lt_u32 s2, 96
    s_cselect_b32 s16, s22, s24
    s_cselect_b32 s17, s23, s25
    s_cselect_b32 s38, 6144, s40
    s_cselect_b32 s39, 0, 96
    s_lshl_b32 s18, s38, 10
    s_cmp_ge_u32 s2, 208
    s_cselect_b32 s18, 0, s18
    s_mov_b32 s19, 0x00020000
    s_sub_u32 s39, s2, s39
    s_and_b32 s41, s39, 1
    s_lshl_b32 s41, s41, 3
    s_add_u32 s41, s41, s28
    s_lshl_b32 s41, s41, 6
    s_mul_i32 s41, s41, s38
    s_lshr_b32 s39, s39, 1
    s_lshl_b32 s39, s39, 7
    s_add_u32 s41, s41, s39
    v_lshrrev_b32 v18, 3, v1
    v_mul_lo_u32 v18, v18, s38
    v_and_b32 v2, 7, v1
    v_lshl_add_u32 v18, v2, 4, v18
    s_lshl_b32 s42, s38, 3
    v_and_b32 v2, 15, v1
    v_and_b32 v7, 1, v1
    v_lshlrev_b32 v7, 4, v7
    v_lshlrev_b32 v7, v7, s49
    v_lshrrev_b32 v2, 1, v2
    v_cmp_eq_u32 vcc, 0, v2
    s_nop 1
    v_cndmask_b32 v12, 0, v7, vcc
    v_cmp_eq_u32 vcc, 1, v2
    s_nop 1
    v_cndmask_b32 v13, 0, v7, vcc
    v_cmp_eq_u32 vcc, 2, v2
    s_nop 1
    v_cndmask_b32 v14, 0, v7, vcc
    v_cmp_eq_u32 vcc, 3, v2
    s_nop 1
    v_cndmask_b32 v15, 0, v7, vcc
    v_and_b32 v2, 15, v1
    v_lshlrev_b32 v8, 7, v2
    v_lshrrev_b32 v2, 1, v2
    v_lshrrev_b32 v7, 4, v1
    v_xor_b32 v2, v2, v7
    v_lshl_add_u32 v2, v2, 4, v8
    s_lshl_b32 s38, s32, 12
    s_sub_u32 s39, 28672, s38
    v_add_u32 v8, s38, v2
    v_add_u32 v10, s39, v2
    v_xor_b32 v9, 64, v8
    v_xor_b32 v11, 64, v10
    v_lshrrev_b32 v0, 2, v1
    v_lshlrev_b32 v0, 6, v0
    v_and_b32 v7, 16, v1
    v_lshl_add_u32 v0, v7, 1, v0
    v_and_b32 v7, 3, v1
    v_lshl_add_u32 v0, v7, 3, v0
    s_mul_i32 s40, s33, 8192
    s_add_u32 s40, s40, 98304
    v_add_u32 v16, s40, v0
    v_xor_b32 v17, 32, v16
    v_and_b32 v0, 0xffffffe7, v0
    v_and_b32 v7, 1, v1
    v_lshlrev_b32 v7, 5, v7
    v_xor_b32 v0, v0, v7
    v_and_b32 v7, 2, v1
    v_lshl_add_u32 v0, v7, 2, v0
    s_lshl_b32 s40, s33, 4
    s_add_u32 s40, s40, 104448
    v_add_u32 v0, s40, v0
    v_mov_b32 v20, 0
    v_mov_b32 v21, 0
    v_mov_b32 v22, 0
    v_mov_b32 v23, 0
    s_mov_b32 s47, 0
    s_mov_b32 s50, 32768
    s_mov_b32 s51, 32768
    s_add_u32 s52, s6, 0x3000000
    s_addc_u32 s53, s7, 0
    s_mov_b32 s54, 0x20000
    s_mov_b32 s55, 0x00020000
    s_mov_b32 s56, s4
    s_mov_b32 s57, s5
    s_mov_b32 s58, 0x100
    s_mov_b32 s59, 0x00020000
    s_waitcnt vmcnt(4)
    v_lshlrev_b32 v168, 16, v160
    v_and_b32 v169, 0xffff0000, v160
    v_lshlrev_b32 v170, 16, v161
    v_and_b32 v171, 0xffff0000, v161
    v_lshlrev_b32 v172, 16, v162
    v_and_b32 v173, 0xffff0000, v162
    v_lshlrev_b32 v174, 16, v163
    v_and_b32 v175, 0xffff0000, v163
    v_lshlrev_b32 v176, 16, v164
    v_and_b32 v177, 0xffff0000, v164
    v_lshlrev_b32 v178, 16, v165
    v_and_b32 v179, 0xffff0000, v165
    v_lshlrev_b32 v180, 16, v166
    v_and_b32 v181, 0xffff0000, v166
    v_lshlrev_b32 v182, 16, v167
    v_and_b32 v183, 0xffff0000, v167
    v_add_f32 v184, v168, v169
    v_add_f32 v185, v170, v171
    v_add_f32 v184, v184, v172
    v_add_f32 v185, v185, v173
    v_add_f32 v184, v184, v174
    v_add_f32 v185, v185, v175
    v_add_f32 v184, v184, v176
    v_add_f32 v185, v185, v177
    v_add_f32 v184, v184, v178
    v_add_f32 v185, v185, v179
    v_add_f32 v184, v184, v180
    v_add_f32 v185, v185, v181
    v_add_f32 v184, v184, v182
    v_add_f32 v185, v185, v183
    v_add_f32 v184, v184, v185
    s_nop 1
    v_add_f32_dpp v184, v184, v184 row_ror:8 row_mask:0xf bank_mask:0xf
    s_nop 1
    v_add_f32_dpp v184, v184, v184 row_ror:4 row_mask:0xf bank_mask:0xf
    s_nop 1
    v_add_f32_dpp v184, v184, v184 row_ror:2 row_mask:0xf bank_mask:0xf
    s_nop 1
    v_add_f32_dpp v184, v184, v184 row_ror:1 row_mask:0xf bank_mask:0xf
    v_mov_b32 v185, v184
    s_nop 1
    v_permlane16_swap_b32 v184, v185
    v_add_f32 v184, v184, v185
    v_mov_b32 v185, v184
    s_nop 1
    v_permlane32_swap_b32 v184, v185
    v_add_f32 v184, v184, v185
    v_mul_f32 v186, 0x3a800000, v184
    v_sub_f32 v168, v168, v186
    v_sub_f32 v169, v169, v186
    v_sub_f32 v170, v170, v186
    v_sub_f32 v171, v171, v186
    v_sub_f32 v172, v172, v186
    v_sub_f32 v173, v173, v186
    v_sub_f32 v174, v174, v186
    v_sub_f32 v175, v175, v186
    v_sub_f32 v176, v176, v186
    v_sub_f32 v177, v177, v186
    v_sub_f32 v178, v178, v186
    v_sub_f32 v179, v179, v186
    v_sub_f32 v180, v180, v186
    v_sub_f32 v181, v181, v186
    v_sub_f32 v182, v182, v186
    v_sub_f32 v183, v183, v186
    v_mul_f32 v184, v168, v168
    v_mul_f32 v185, v169, v169
    v_fmac_f32 v184, v170, v170
    v_fmac_f32 v185, v171, v171
    v_fmac_f32 v184, v172, v172
    v_fmac_f32 v185, v173, v173
    v_fmac_f32 v184, v174, v174
    v_fmac_f32 v185, v175, v175
    v_fmac_f32 v184, v176, v176
    v_fmac_f32 v185, v177, v177
    v_fmac_f32 v184, v178, v178
    v_fmac_f32 v185, v179, v179
    v_fmac_f32 v184, v180, v180
    v_fmac_f32 v185, v181, v181
    v_fmac_f32 v184, v182, v182
    v_fmac_f32 v185, v183, v183
    v_add_f32 v184, v184, v185
    s_nop 1
    v_add_f32_dpp v184, v184, v184 row_ror:8 row_mask:0xf bank_mask:0xf
    s_nop 1
    v_add_f32_dpp v184, v184, v184 row_ror:4 row_mask:0xf bank_mask:0xf
    s_nop 1
    v_add_f32_dpp v184, v184, v184 row_ror:2 row_mask:0xf bank_mask:0xf
    s_nop 1
    v_add_f32_dpp v184, v184, v184 row_ror:1 row_mask:0xf bank_mask:0xf
    v_mov_b32 v185, v184
    s_nop 1
    v_permlane16_swap_b32 v184, v185
    v_add_f32 v184, v184, v185
    v_mov_b32 v185, v184
    s_nop 1
    v_permlane32_swap_b32 v184, v185
    v_add_f32 v184, v184, v185
    v_mul_f32 v187, 0x3a800000, v184
    v_mov_b32 v168, v187
    v_cvt_pk_bf16_f32 v168, v168, v168
    v_lshlrev_b32 v168, 16, v168
    v_add_f32 v168, 0x3727c5ac, v168
    v_cvt_pk_bf16_f32 v168, v168, v168
    v_lshlrev_b32 v168, 16, v168
    v_sqrt_f32 v168, v168
    s_nop 0
    v_cvt_pk_bf16_f32 v168, v168, v168
    v_lshlrev_b32 v168, 16, v168
    v_rcp_f32 v160, v168
    v_mov_b32 v169, v186
    v_cvt_pk_bf16_f32 v169, v169, v169
    v_lshlrev_b32 v169, 16, v169
    v_mul_f32 v161, -v160, v169
    v_sub_f32 v171, v186, v169
    v_mul_f32 v171, v171, v160
    v_cvt_pk_bf16_f32 v171, v171, v171
    v_lshlrev_b32 v171, 16, v171
    v_mul_f32 v187, v187, v160
    v_mul_f32 v187, v187, v160
    v_mov_b32 v170, v187
    v_cvt_pk_bf16_f32 v170, v170, v170
    v_lshlrev_b32 v170, 16, v170
    v_add_f32 v170, 0x3727c5ac, v170
    v_cvt_pk_bf16_f32 v170, v170, v170
    v_lshlrev_b32 v170, 16, v170
    v_sqrt_f32 v170, v170
    s_nop 0
    v_cvt_pk_bf16_f32 v170, v170, v170
    v_lshlrev_b32 v170, 16, v170
    v_rcp_f32 v170, v170
    v_fma_f32 v171, v171, v168, v169
    v_mul_f32 v162, v160, v170
    v_mul_f32 v163, -v162, v171
    v_cmp_eq_u32 vcc, 1, v1
    s_nop 1
    v_cndmask_b32 v160, v160, v161, vcc
    v_cmp_eq_u32 vcc, 2, v1
    s_nop 1
    v_cndmask_b32 v160, v160, v162, vcc
    v_cmp_eq_u32 vcc, 3, v1
    s_nop 1
    v_cndmask_b32 v160, v160, v163, vcc
    v_lshlrev_b32 v2, 13, v1
    s_lshl_b32 s38, s31, 2
    s_add_u32 s39, s38, 32768
    s_lshl_b32 s38, s31, 4
    s_mov_b64 exec, 15
    buffer_store_dword v160, v2, s[52:55], s39 offen sc1
    s_mov_b64 exec, 1
    buffer_store_dwordx4 v[20:23], v20, s[52:55], s38 offen sc1
    s_mov_b64 exec, -1
    s_mov_b32 m0, s46
    s_nop 0
    buffer_load_dwordx4 v3, s[8:11], s36 offen lds
    buffer_load_dwordx4 v4, s[8:11], s36 offen offset:1024 lds
    s_add_u32 s34, s36, 32768
    s_add_u32 m0, s46, 2048
    s_add_u32 s36, s36, 128
    buffer_load_dwordx4 v3, s[8:11], s34 offen lds
    buffer_load_dwordx4 v4, s[8:11], s34 offen offset:1024 lds
    s_add_u32 s46, s46, 32768
    s_cmp_ge_u32 s46, 98304
    s_cselect_b32 s38, 98304, 0
    s_sub_u32 s46, s46, s38
    s_waitcnt vmcnt(6) lgkmcnt(0)
    s_barrier
    ds_read_b128 v[132:135], v8 offset:0
    ds_read_b64_tr_b16 v[148:149], v16 offset:0
    ds_read_b64_tr_b16 v[150:151], v16 offset:1024
    ds_read_b64_tr_b16 v[152:153], v17 offset:0
    ds_read_b64_tr_b16 v[154:155], v17 offset:1024
    ds_read_b64_tr_b16 v[156:157], v16 offset:2048
    ds_read_b64_tr_b16 v[158:159], v16 offset:3072
    ds_read_b64_tr_b16 v[160:161], v17 offset:2048
    ds_read_b64_tr_b16 v[162:163], v17 offset:3072
    ds_read_b64_tr_b16 v[164:165], v16 offset:4096
    ds_read_b64_tr_b16 v[166:167], v16 offset:5120
    ds_read_b64_tr_b16 v[168:169], v17 offset:4096
    ds_read_b64_tr_b16 v[170:171], v17 offset:5120
    ds_read_b64_tr_b16 v[172:173], v0 offset:0
    ds_read_b64_tr_b16 v[174:175], v0 offset:1024
    ds_read_b128 v[136:139], v8 offset:2048
    ds_read_b128 v[140:143], v10 offset:0
    ds_read_b128 v[144:147], v10 offset:2048
    s_waitcnt vmcnt(6) lgkmcnt(0)
    s_barrier
    v_mfma_f32_16x16x32_bf16 v[20:23], v[148:151], v[132:135], 0
    ds_read_b128 v[176:179], v9 offset:0
    v_mfma_f32_16x16x32_bf16 v[24:27], v[152:155], v[132:135], 0
    ds_read_b64_tr_b16 v[192:193], v16 offset:14336
    v_mfma_f32_16x16x32_bf16 v[28:31], v[156:159], v[132:135], 0
    ds_read_b64_tr_b16 v[194:195], v16 offset:15360
    v_mfma_f32_16x16x32_bf16 v[32:35], v[160:163], v[132:135], 0
    s_mov_b32 m0, s46
    s_nop 0
    buffer_load_dwordx4 v3, s[8:11], s36 offen lds
    v_mfma_f32_16x16x32_bf16 v[36:39], v[164:167], v[132:135], 0
    ds_read_b64_tr_b16 v[196:197], v17 offset:14336
    v_mfma_f32_16x16x32_bf16 v[40:43], v[168:171], v[132:135], 0
    ds_read_b64_tr_b16 v[198:199], v17 offset:15360
    v_mfma_f32_16x16x32_bf16 v[44:47], v[172:175], v[132:135], 0
    ds_read_b64_tr_b16 v[200:201], v16 offset:16384
    v_mfma_f32_16x16x32_bf16 v[48:51], v[148:151], v[136:139], 0
    v_mfma_f32_16x16x32_bf16 v[52:55], v[152:155], v[136:139], 0
    ds_read_b64_tr_b16 v[202:203], v16 offset:17408
    v_mfma_f32_16x16x32_bf16 v[56:59], v[156:159], v[136:139], 0
    ds_read_b64_tr_b16 v[204:205], v17 offset:16384
    v_mfma_f32_16x16x32_bf16 v[60:63], v[160:163], v[136:139], 0
    ds_read_b64_tr_b16 v[206:207], v17 offset:17408
    buffer_load_dwordx4 v4, s[8:11], s36 offen offset:1024 lds
    s_add_u32 s34, s36, 32768
    v_mfma_f32_16x16x32_bf16 v[64:67], v[164:167], v[136:139], 0
    v_mfma_f32_16x16x32_bf16 v[68:71], v[168:171], v[136:139], 0
    ds_read_b64_tr_b16 v[208:209], v16 offset:18432
    v_mfma_f32_16x16x32_bf16 v[72:75], v[172:175], v[136:139], 0
    ds_read_b64_tr_b16 v[210:211], v16 offset:19456
    v_mfma_f32_16x16x32_bf16 v[76:79], v[148:151], v[140:143], 0
    ds_read_b64_tr_b16 v[212:213], v17 offset:18432
    v_mfma_f32_16x16x32_bf16 v[80:83], v[152:155], v[140:143], 0
    v_mfma_f32_16x16x32_bf16 v[84:87], v[156:159], v[140:143], 0
    ds_read_b64_tr_b16 v[214:215], v17 offset:19456
    v_mfma_f32_16x16x32_bf16 v[88:91], v[160:163], v[140:143], 0
    ds_read_b64_tr_b16 v[216:217], v0 offset:14336
    s_add_u32 m0, s46, 2048
    s_add_u32 s36, s36, 128
    buffer_load_dwordx4 v3, s[8:11], s34 offen lds
    v_mfma_f32_16x16x32_bf16 v[92:95], v[164:167], v[140:143], 0
    ds_read_b64_tr_b16 v[218:219], v0 offset:15360
    v_mfma_f32_16x16x32_bf16 v[96:99], v[168:171], v[140:143], 0
    v_mfma_f32_16x16x32_bf16 v[100:103], v[172:175], v[140:143], 0
    ds_read_b128 v[180:183], v9 offset:2048
    v_mfma_f32_16x16x32_bf16 v[104:107], v[148:151], v[144:147], 0
    ds_read_b128 v[184:187], v11 offset:0
    v_mfma_f32_16x16x32_bf16 v[108:111], v[152:155], v[144:147], 0
    ds_read_b128 v[188:191], v11 offset:2048
    v_mfma_f32_16x16x32_bf16 v[112:115], v[156:159], v[144:147], 0
    v_mfma_f32_16x16x32_bf16 v[116:119], v[160:163], v[144:147], 0
    buffer_load_dwordx4 v4, s[8:11], s34 offen offset:1024 lds
    s_add_u32 s46, s46, 32768
    s_cmp_ge_u32 s46, 98304
    s_cselect_b32 s38, 98304, 0
    s_sub_u32 s46, s46, s38
    v_mfma_f32_16x16x32_bf16 v[120:123], v[164:167], v[144:147], 0
    v_mfma_f32_16x16x32_bf16 v[124:127], v[168:171], v[144:147], 0
    v_add_u32 v8, s50, v8
    v_add_u32 v10, s50, v10
    v_mfma_f32_16x16x32_bf16 v[128:131], v[172:175], v[144:147], 0
    s_waitcnt vmcnt(4) lgkmcnt(0)
    s_barrier
    v_mfma_f32_16x16x32_bf16 v[20:23], v[192:195], v[176:179], v[20:23]
    ds_read_b128 v[132:135], v8 offset:0
    v_mfma_f32_16x16x32_bf16 v[24:27], v[196:199], v[176:179], v[24:27]
    ds_read_b64_tr_b16 v[148:149], v16 offset:28672
    v_mfma_f32_16x16x32_bf16 v[28:31], v[200:203], v[176:179], v[28:31]
    ds_read_b64_tr_b16 v[150:151], v16 offset:29696
    s_mov_b32 m0, s46
    s_nop 0
    buffer_load_dwordx4 v3, s[8:11], s36 offen lds
    v_mfma_f32_16x16x32_bf16 v[32:35], v[204:207], v[176:179], v[32:35]
    v_mfma_f32_16x16x32_bf16 v[36:39], v[208:211], v[176:179], v[36:39]
    ds_read_b64_tr_b16 v[152:153], v17 offset:28672
    v_mfma_f32_16x16x32_bf16 v[40:43], v[212:215], v[176:179], v[40:43]
    ds_read_b64_tr_b16 v[154:155], v17 offset:29696
    v_mfma_f32_16x16x32_bf16 v[44:47], v[216:219], v[176:179], v[44:47]
    ds_read_b64_tr_b16 v[156:157], v16 offset:30720
    v_mfma_f32_16x16x32_bf16 v[48:51], v[192:195], v[180:183], v[48:51]
    buffer_load_dwordx4 v4, s[8:11], s36 offen offset:1024 lds
    s_add_u32 s34, s36, 32768
    v_mfma_f32_16x16x32_bf16 v[52:55], v[196:199], v[180:183], v[52:55]
    ds_read_b64_tr_b16 v[158:159], v16 offset:31744
    v_mfma_f32_16x16x32_bf16 v[56:59], v[200:203], v[180:183], v[56:59]
    ds_read_b64_tr_b16 v[160:161], v17 offset:30720
    v_mfma_f32_16x16x32_bf16 v[60:63], v[204:207], v[180:183], v[60:63]
    ds_read_b64_tr_b16 v[162:163], v17 offset:31744
    v_mfma_f32_16x16x32_bf16 v[64:67], v[208:211], v[180:183], v[64:67]
    buffer_load_dwordx4 v[224:227], v18, s[16:19], s41 offen
    s_add_u32 s41, s41, s42
    v_mfma_f32_16x16x32_bf16 v[68:71], v[212:215], v[180:183], v[68:71]
    ds_read_b64_tr_b16 v[164:165], v16 offset:32768
    v_mfma_f32_16x16x32_bf16 v[72:75], v[216:219], v[180:183], v[72:75]
    ds_read_b64_tr_b16 v[166:167], v16 offset:33792
    v_mfma_f32_16x16x32_bf16 v[76:79], v[192:195], v[184:187], v[76:79]
    ds_read_b64_tr_b16 v[168:169], v17 offset:32768
    v_mfma_f32_16x16x32_bf16 v[80:83], v[196:199], v[184:187], v[80:83]
    v_mfma_f32_16x16x32_bf16 v[84:87], v[200:203], v[184:187], v[84:87]
    ds_read_b64_tr_b16 v[170:171], v17 offset:33792
    buffer_load_dwordx4 v[228:231], v18, s[16:19], s41 offen
    s_add_u32 s41, s41, s42
    v_mfma_f32_16x16x32_bf16 v[88:91], v[204:207], v[184:187], v[88:91]
    ds_read_b64_tr_b16 v[172:173], v0 offset:28672
    v_mfma_f32_16x16x32_bf16 v[92:95], v[208:211], v[184:187], v[92:95]
    ds_read_b64_tr_b16 v[174:175], v0 offset:29696
    v_mfma_f32_16x16x32_bf16 v[96:99], v[212:215], v[184:187], v[96:99]
    v_mfma_f32_16x16x32_bf16 v[100:103], v[216:219], v[184:187], v[100:103]
    ds_read_b128 v[136:139], v8 offset:2048
    v_mfma_f32_16x16x32_bf16 v[104:107], v[192:195], v[188:191], v[104:107]
    ds_read_b128 v[140:143], v10 offset:0
    buffer_load_dwordx4 v[232:235], v18, s[16:19], s41 offen
    s_add_u32 s41, s41, s42
    v_mfma_f32_16x16x32_bf16 v[108:111], v[196:199], v[188:191], v[108:111]
    ds_read_b128 v[144:147], v10 offset:2048
    v_mfma_f32_16x16x32_bf16 v[112:115], v[200:203], v[188:191], v[112:115]
    v_mfma_f32_16x16x32_bf16 v[116:119], v[204:207], v[188:191], v[116:119]
    v_mfma_f32_16x16x32_bf16 v[120:123], v[208:211], v[188:191], v[120:123]
    buffer_load_dwordx4 v[236:239], v18, s[16:19], s41 offen
    s_add_u32 s41, s41, s42
    v_mfma_f32_16x16x32_bf16 v[124:127], v[212:215], v[188:191], v[124:127]
    v_add_u32 v9, s50, v9
    v_add_u32 v11, s50, v11
    s_add_u32 s47, s47, s50
    s_cmp_eq_u32 s47, 65536
    s_cselect_b32 s50, 0xffff0000, s51
    v_mfma_f32_16x16x32_bf16 v[128:131], v[216:219], v[188:191], v[128:131]
    s_waitcnt vmcnt(10) lgkmcnt(0)
    s_barrier
    v_mfma_f32_16x16x32_bf16 v[20:23], v[148:151], v[132:135], v[20:23]
    ds_read_b128 v[176:179], v9 offset:0
    v_mfma_f32_16x16x32_bf16 v[24:27], v[152:155], v[132:135], v[24:27]
    ds_read_b64_tr_b16 v[192:193], v16 offset:43008
    v_mfma_f32_16x16x32_bf16 v[28:31], v[156:159], v[132:135], v[28:31]
    ds_read_b64_tr_b16 v[194:195], v16 offset:44032
    s_add_u32 m0, s46, 2048
    s_add_u32 s36, s36, 128
    buffer_load_dwordx4 v3, s[8:11], s34 offen lds
    v_mfma_f32_16x16x32_bf16 v[32:35], v[160:163], v[132:135], v[32:35]
    v_mfma_f32_16x16x32_bf16 v[36:39], v[164:167], v[132:135], v[36:39]
    ds_read_b64_tr_b16 v[196:197], v17 offset:43008
    v_mfma_f32_16x16x32_bf16 v[40:43], v[168:171], v[132:135], v[40:43]
    ds_read_b64_tr_b16 v[198:199], v17 offset:44032
    v_mfma_f32_16x16x32_bf16 v[44:47], v[172:175], v[132:135], v[44:47]
    ds_read_b64_tr_b16 v[200:201], v16 offset:45056
    v_mfma_f32_16x16x32_bf16 v[48:51], v[148:151], v[136:139], v[48:51]
    buffer_load_dwordx4 v4, s[8:11], s34 offen offset:1024 lds
    s_add_u32 s46, s46, 32768
    s_cmp_ge_u32 s46, 98304
    s_cselect_b32 s38, 98304, 0
    s_sub_u32 s46, s46, s38
    v_mfma_f32_16x16x32_bf16 v[52:55], v[152:155], v[136:139], v[52:55]
    ds_read_b64_tr_b16 v[202:203], v16 offset:46080
    v_mfma_f32_16x16x32_bf16 v[56:59], v[156:159], v[136:139], v[56:59]
    ds_read_b64_tr_b16 v[204:205], v17 offset:45056
    v_mfma_f32_16x16x32_bf16 v[60:63], v[160:163], v[136:139], v[60:63]
    ds_read_b64_tr_b16 v[206:207], v17 offset:46080
    v_mfma_f32_16x16x32_bf16 v[64:67], v[164:167], v[136:139], v[64:67]
    buffer_load_dwordx4 v[240:243], v18, s[16:19], s41 offen
    s_add_u32 s41, s41, s42
    v_mfma_f32_16x16x32_bf16 v[68:71], v[168:171], v[136:139], v[68:71]
    ds_read_b64_tr_b16 v[208:209], v16 offset:47104
    v_mfma_f32_16x16x32_bf16 v[72:75], v[172:175], v[136:139], v[72:75]
    ds_read_b64_tr_b16 v[210:211], v16 offset:48128
    v_mfma_f32_16x16x32_bf16 v[76:79], v[148:151], v[140:143], v[76:79]
    ds_read_b64_tr_b16 v[212:213], v17 offset:47104
    v_mfma_f32_16x16x32_bf16 v[80:83], v[152:155], v[140:143], v[80:83]
    v_mfma_f32_16x16x32_bf16 v[84:87], v[156:159], v[140:143], v[84:87]
    ds_read_b64_tr_b16 v[214:215], v17 offset:48128
    buffer_load_dwordx4 v[244:247], v18, s[16:19], s41 offen
    s_add_u32 s41, s41, s42
    v_mfma_f32_16x16x32_bf16 v[88:91], v[160:163], v[140:143], v[88:91]
    ds_read_b64_tr_b16 v[216:217], v0 offset:43008
    v_mfma_f32_16x16x32_bf16 v[92:95], v[164:167], v[140:143], v[92:95]
    ds_read_b64_tr_b16 v[218:219], v0 offset:44032
    v_mfma_f32_16x16x32_bf16 v[96:99], v[168:171], v[140:143], v[96:99]
    v_mfma_f32_16x16x32_bf16 v[100:103], v[172:175], v[140:143], v[100:103]
    ds_read_b128 v[180:183], v9 offset:2048
    v_mfma_f32_16x16x32_bf16 v[104:107], v[148:151], v[144:147], v[104:107]
    ds_read_b128 v[184:187], v11 offset:0
    buffer_load_dwordx4 v[248:251], v18, s[16:19], s41 offen
    s_add_u32 s41, s41, s42
    v_mfma_f32_16x16x32_bf16 v[108:111], v[152:155], v[144:147], v[108:111]
    ds_read_b128 v[188:191], v11 offset:2048
    v_mfma_f32_16x16x32_bf16 v[112:115], v[156:159], v[144:147], v[112:115]
    v_mfma_f32_16x16x32_bf16 v[116:119], v[160:163], v[144:147], v[116:119]
    v_mfma_f32_16x16x32_bf16 v[120:123], v[164:167], v[144:147], v[120:123]
    buffer_load_dwordx4 v[252:255], v18, s[16:19], s41 offen
    s_add_u32 s41, s41, s42
    v_mfma_f32_16x16x32_bf16 v[124:127], v[168:171], v[144:147], v[124:127]
    v_add_u32 v8, s50, v8
    v_add_u32 v10, s50, v10
    v_mfma_f32_16x16x32_bf16 v[128:131], v[172:175], v[144:147], v[128:131]
    s_waitcnt vmcnt(12) lgkmcnt(0)
    s_barrier
    v_mfma_f32_16x16x32_bf16 v[20:23], v[192:195], v[176:179], v[20:23]
    ds_read_b128 v[132:135], v8 offset:0
    v_mfma_f32_16x16x32_bf16 v[24:27], v[196:199], v[176:179], v[24:27]
    ds_read_b64_tr_b16 v[148:149], v16 offset:0
    v_mfma_f32_16x16x32_bf16 v[28:31], v[200:203], v[176:179], v[28:31]
    ds_read_b64_tr_b16 v[150:151], v16 offset:1024
    v_mfma_f32_16x16x32_bf16 v[32:35], v[204:207], v[176:179], v[32:35]
    v_mfma_f32_16x16x32_bf16 v[36:39], v[208:211], v[176:179], v[36:39]
    ds_read_b64_tr_b16 v[152:153], v17 offset:0
    v_mfma_f32_16x16x32_bf16 v[40:43], v[212:215], v[176:179], v[40:43]
    ds_read_b64_tr_b16 v[154:155], v17 offset:1024
    v_mfma_f32_16x16x32_bf16 v[44:47], v[216:219], v[176:179], v[44:47]
    ds_read_b64_tr_b16 v[156:157], v16 offset:2048
    v_mfma_f32_16x16x32_bf16 v[48:51], v[192:195], v[180:183], v[48:51]
    s_mov_b32 m0, s46
    s_nop 0
    buffer_load_dwordx4 v3, s[8:11], s36 offen lds
    v_mfma_f32_16x16x32_bf16 v[52:55], v[196:199], v[180:183], v[52:55]
    ds_read_b64_tr_b16 v[158:159], v16 offset:3072
    v_mfma_f32_16x16x32_bf16 v[56:59], v[200:203], v[180:183], v[56:59]
    ds_read_b64_tr_b16 v[160:161], v17 offset:2048
    v_mfma_f32_16x16x32_bf16 v[60:63], v[204:207], v[180:183], v[60:63]
    ds_read_b64_tr_b16 v[162:163], v17 offset:3072
    v_mfma_f32_16x16x32_bf16 v[64:67], v[208:211], v[180:183], v[64:67]
    v_mfma_f32_16x16x32_bf16 v[68:71], v[212:215], v[180:183], v[68:71]
    ds_read_b64_tr_b16 v[164:165], v16 offset:4096
    v_mfma_f32_16x16x32_bf16 v[72:75], v[216:219], v[180:183], v[72:75]
    ds_read_b64_tr_b16 v[166:167], v16 offset:5120
    v_mfma_f32_16x16x32_bf16 v[76:79], v[192:195], v[184:187], v[76:79]
    ds_read_b64_tr_b16 v[168:169], v17 offset:4096
    v_mfma_f32_16x16x32_bf16 v[80:83], v[196:199], v[184:187], v[80:83]
    v_mfma_f32_16x16x32_bf16 v[84:87], v[200:203], v[184:187], v[84:87]
    ds_read_b64_tr_b16 v[170:171], v17 offset:5120
    v_mfma_f32_16x16x32_bf16 v[88:91], v[204:207], v[184:187], v[88:91]
    ds_read_b64_tr_b16 v[172:173], v0 offset:0
    v_mfma_f32_16x16x32_bf16 v[92:95], v[208:211], v[184:187], v[92:95]
    ds_read_b64_tr_b16 v[174:175], v0 offset:1024
    v_mfma_f32_16x16x32_bf16 v[96:99], v[212:215], v[184:187], v[96:99]
    v_mfma_f32_16x16x32_bf16 v[100:103], v[216:219], v[184:187], v[100:103]
    ds_read_b128 v[136:139], v8 offset:2048
    v_mfma_f32_16x16x32_bf16 v[104:107], v[192:195], v[188:191], v[104:107]
    ds_read_b128 v[140:143], v10 offset:0
    buffer_load_dwordx4 v4, s[8:11], s36 offen offset:1024 lds
    s_add_u32 s34, s36, 32768
    v_mfma_f32_16x16x32_bf16 v[108:111], v[196:199], v[188:191], v[108:111]
    ds_read_b128 v[144:147], v10 offset:2048
    v_mfma_f32_16x16x32_bf16 v[112:115], v[200:203], v[188:191], v[112:115]
    v_mfma_f32_16x16x32_bf16 v[116:119], v[204:207], v[188:191], v[116:119]
    v_mfma_f32_16x16x32_bf16 v[120:123], v[208:211], v[188:191], v[120:123]
    v_mfma_f32_16x16x32_bf16 v[124:127], v[212:215], v[188:191], v[124:127]
    v_add_u32 v9, s50, v9
    v_add_u32 v11, s50, v11
    s_add_u32 s47, s47, s50
    s_cmp_eq_u32 s47, 65536
    s_cselect_b32 s50, 0xffff0000, s51
    v_mfma_f32_16x16x32_bf16 v[128:131], v[216:219], v[188:191], v[128:131]
    s_waitcnt vmcnt(14) lgkmcnt(0)
    s_barrier
    v_mfma_f32_16x16x32_bf16 v[20:23], v[148:151], v[132:135], v[20:23]
    ds_read_b128 v[176:179], v9 offset:0
    v_mfma_f32_16x16x32_bf16 v[24:27], v[152:155], v[132:135], v[24:27]
    ds_read_b64_tr_b16 v[192:193], v16 offset:14336
    v_mfma_f32_16x16x32_bf16 v[28:31], v[156:159], v[132:135], v[28:31]
    ds_read_b64_tr_b16 v[194:195], v16 offset:15360
    v_mfma_f32_16x16x32_bf16 v[32:35], v[160:163], v[132:135], v[32:35]
    v_mfma_f32_16x16x32_bf16 v[36:39], v[164:167], v[132:135], v[36:39]
    ds_read_b64_tr_b16 v[196:197], v17 offset:14336
    v_mfma_f32_16x16x32_bf16 v[40:43], v[168:171], v[132:135], v[40:43]
    ds_read_b64_tr_b16 v[198:199], v17 offset:15360
    v_mfma_f32_16x16x32_bf16 v[44:47], v[172:175], v[132:135], v[44:47]
    ds_read_b64_tr_b16 v[200:201], v16 offset:16384
    v_mfma_f32_16x16x32_bf16 v[48:51], v[148:151], v[136:139], v[48:51]
    s_add_u32 m0, s46, 2048
    s_add_u32 s36, s36, 128
    buffer_load_dwordx4 v3, s[8:11], s34 offen lds
    v_mfma_f32_16x16x32_bf16 v[52:55], v[152:155], v[136:139], v[52:55]
    ds_read_b64_tr_b16 v[202:203], v16 offset:17408
    v_mfma_f32_16x16x32_bf16 v[56:59], v[156:159], v[136:139], v[56:59]
    ds_read_b64_tr_b16 v[204:205], v17 offset:16384
    v_mfma_f32_16x16x32_bf16 v[60:63], v[160:163], v[136:139], v[60:63]
    ds_read_b64_tr_b16 v[206:207], v17 offset:17408
    v_mfma_f32_16x16x32_bf16 v[64:67], v[164:167], v[136:139], v[64:67]
    v_mfma_f32_16x16x32_bf16 v[68:71], v[168:171], v[136:139], v[68:71]
    ds_read_b64_tr_b16 v[208:209], v16 offset:18432
    v_mfma_f32_16x16x32_bf16 v[72:75], v[172:175], v[136:139], v[72:75]
    ds_read_b64_tr_b16 v[210:211], v16 offset:19456
    v_mfma_f32_16x16x32_bf16 v[76:79], v[148:151], v[140:143], v[76:79]
    ds_read_b64_tr_b16 v[212:213], v17 offset:18432
    v_mfma_f32_16x16x32_bf16 v[80:83], v[152:155], v[140:143], v[80:83]
    v_mfma_f32_16x16x32_bf16 v[84:87], v[156:159], v[140:143], v[84:87]
    ds_read_b64_tr_b16 v[214:215], v17 offset:19456
    v_mfma_f32_16x16x32_bf16 v[88:91], v[160:163], v[140:143], v[88:91]
    ds_read_b64_tr_b16 v[216:217], v0 offset:14336
    v_mfma_f32_16x16x32_bf16 v[92:95], v[164:167], v[140:143], v[92:95]
    ds_read_b64_tr_b16 v[218:219], v0 offset:15360
    v_mfma_f32_16x16x32_bf16 v[96:99], v[168:171], v[140:143], v[96:99]
    v_mfma_f32_16x16x32_bf16 v[100:103], v[172:175], v[140:143], v[100:103]
    ds_read_b128 v[180:183], v9 offset:2048
    v_mfma_f32_16x16x32_bf16 v[104:107], v[148:151], v[144:147], v[104:107]
    ds_read_b128 v[184:187], v11 offset:0
    buffer_load_dwordx4 v4, s[8:11], s34 offen offset:1024 lds
    s_add_u32 s46, s46, 32768
    s_cmp_ge_u32 s46, 98304
    s_cselect_b32 s38, 98304, 0
    s_sub_u32 s46, s46, s38
    v_mfma_f32_16x16x32_bf16 v[108:111], v[152:155], v[144:147], v[108:111]
    ds_read_b128 v[188:191], v11 offset:2048
    v_mfma_f32_16x16x32_bf16 v[112:115], v[156:159], v[144:147], v[112:115]
    v_mfma_f32_16x16x32_bf16 v[116:119], v[160:163], v[144:147], v[116:119]
    v_mfma_f32_16x16x32_bf16 v[120:123], v[164:167], v[144:147], v[120:123]
    v_mfma_f32_16x16x32_bf16 v[124:127], v[168:171], v[144:147], v[124:127]
    v_add_u32 v8, s50, v8
    v_add_u32 v10, s50, v10
    v_mfma_f32_16x16x32_bf16 v[128:131], v[172:175], v[144:147], v[128:131]
    s_waitcnt vmcnt(8) lgkmcnt(0)
    s_barrier
    v_mfma_f32_16x16x32_bf16 v[20:23], v[192:195], v[176:179], v[20:23]
    ds_read_b128 v[132:135], v8 offset:0
    v_mfma_f32_16x16x32_bf16 v[24:27], v[196:199], v[176:179], v[24:27]
    ds_read_b64_tr_b16 v[148:149], v16 offset:28672
    v_mfma_f32_16x16x32_bf16 v[28:31], v[200:203], v[176:179], v[28:31]
    ds_read_b64_tr_b16 v[150:151], v16 offset:29696
    v_mfma_f32_16x16x32_bf16 v[32:35], v[204:207], v[176:179], v[32:35]
    v_mfma_f32_16x16x32_bf16 v[36:39], v[208:211], v[176:179], v[36:39]
    ds_read_b64_tr_b16 v[152:153], v17 offset:28672
    v_mfma_f32_16x16x32_bf16 v[40:43], v[212:215], v[176:179], v[40:43]
    ds_read_b64_tr_b16 v[154:155], v17 offset:29696
    v_mfma_f32_16x16x32_bf16 v[44:47], v[216:219], v[176:179], v[44:47]
    ds_read_b64_tr_b16 v[156:157], v16 offset:30720
    v_mfma_f32_16x16x32_bf16 v[48:51], v[192:195], v[180:183], v[48:51]
    s_mov_b32 m0, s46
    s_nop 0
    buffer_load_dwordx4 v3, s[8:11], s36 offen lds
    v_mfma_f32_16x16x32_bf16 v[52:55], v[196:199], v[180:183], v[52:55]
    ds_read_b64_tr_b16 v[158:159], v16 offset:31744
    v_mfma_f32_16x16x32_bf16 v[56:59], v[200:203], v[180:183], v[56:59]
    ds_read_b64_tr_b16 v[160:161], v17 offset:30720
    v_mfma_f32_16x16x32_bf16 v[60:63], v[204:207], v[180:183], v[60:63]
    ds_read_b64_tr_b16 v[162:163], v17 offset:31744
    v_mfma_f32_16x16x32_bf16 v[64:67], v[208:211], v[180:183], v[64:67]
    v_mfma_f32_16x16x32_bf16 v[68:71], v[212:215], v[180:183], v[68:71]
    ds_read_b64_tr_b16 v[164:165], v16 offset:32768
    v_mfma_f32_16x16x32_bf16 v[72:75], v[216:219], v[180:183], v[72:75]
    ds_read_b64_tr_b16 v[166:167], v16 offset:33792
    v_mfma_f32_16x16x32_bf16 v[76:79], v[192:195], v[184:187], v[76:79]
    ds_read_b64_tr_b16 v[168:169], v17 offset:32768
    v_mfma_f32_16x16x32_bf16 v[80:83], v[196:199], v[184:187], v[80:83]
    v_mfma_f32_16x16x32_bf16 v[84:87], v[200:203], v[184:187], v[84:87]
    ds_read_b64_tr_b16 v[170:171], v17 offset:33792
    v_mfma_f32_16x16x32_bf16 v[88:91], v[204:207], v[184:187], v[88:91]
    ds_read_b64_tr_b16 v[172:173], v0 offset:28672
    v_mfma_f32_16x16x32_bf16 v[92:95], v[208:211], v[184:187], v[92:95]
    ds_read_b64_tr_b16 v[174:175], v0 offset:29696
    v_mfma_f32_16x16x32_bf16 v[96:99], v[212:215], v[184:187], v[96:99]
    v_mfma_f32_16x16x32_bf16 v[100:103], v[216:219], v[184:187], v[100:103]
    ds_read_b128 v[136:139], v8 offset:2048
    v_mfma_f32_16x16x32_bf16 v[104:107], v[192:195], v[188:191], v[104:107]
    ds_read_b128 v[140:143], v10 offset:0
    buffer_load_dwordx4 v4, s[8:11], s36 offen offset:1024 lds
    s_add_u32 s34, s36, 32768
    v_mfma_f32_16x16x32_bf16 v[108:111], v[196:199], v[188:191], v[108:111]
    ds_read_b128 v[144:147], v10 offset:2048
    v_mfma_f32_16x16x32_bf16 v[112:115], v[200:203], v[188:191], v[112:115]
    v_mfma_f32_16x16x32_bf16 v[116:119], v[204:207], v[188:191], v[116:119]
    v_mfma_f32_16x16x32_bf16 v[120:123], v[208:211], v[188:191], v[120:123]
    v_mfma_f32_16x16x32_bf16 v[124:127], v[212:215], v[188:191], v[124:127]
    v_add_u32 v9, s50, v9
    v_add_u32 v11, s50, v11
    s_add_u32 s47, s47, s50
    s_cmp_eq_u32 s47, 65536
    s_cselect_b32 s50, 0xffff0000, s51
    v_mfma_f32_16x16x32_bf16 v[128:131], v[216:219], v[188:191], v[128:131]
    s_waitcnt vmcnt(6) lgkmcnt(0)
    s_barrier
    v_mfma_f32_16x16x32_bf16 v[220:223], v[12:15], v[224:227], 0
    v_mfma_f32_16x16x32_bf16 v[220:223], v[12:15], v[228:231], v[220:223]
    v_mfma_f32_16x16x32_bf16 v[220:223], v[12:15], v[232:235], v[220:223]
    v_mfma_f32_16x16x32_bf16 v[220:223], v[12:15], v[236:239], v[220:223]
    v_mfma_f32_16x16x32_bf16 v[220:223], v[12:15], v[240:243], v[220:223]
    v_mfma_f32_16x16x32_bf16 v[220:223], v[12:15], v[244:247], v[220:223]
    v_mfma_f32_16x16x32_bf16 v[220:223], v[12:15], v[248:251], v[220:223]
    v_mfma_f32_16x16x32_bf16 v[220:223], v[12:15], v[252:255], v[220:223]
    s_lshl_b32 s38, s28, 10
    s_add_u32 s38, s38, 155648
    v_add_u32 v2, s38, v19
    v_mfma_f32_16x16x32_bf16 v[20:23], v[148:151], v[132:135], v[20:23]
    ds_read_b128 v[176:179], v9 offset:0
    v_mfma_f32_16x16x32_bf16 v[24:27], v[152:155], v[132:135], v[24:27]
    ds_read_b64_tr_b16 v[192:193], v16 offset:43008
    v_mfma_f32_16x16x32_bf16 v[28:31], v[156:159], v[132:135], v[28:31]
    ds_read_b64_tr_b16 v[194:195], v16 offset:44032
    v_mfma_f32_16x16x32_bf16 v[32:35], v[160:163], v[132:135], v[32:35]
    v_mfma_f32_16x16x32_bf16 v[36:39], v[164:167], v[132:135], v[36:39]
    ds_read_b64_tr_b16 v[196:197], v17 offset:43008
    v_mfma_f32_16x16x32_bf16 v[40:43], v[168:171], v[132:135], v[40:43]
    ds_read_b64_tr_b16 v[198:199], v17 offset:44032
    v_mfma_f32_16x16x32_bf16 v[44:47], v[172:175], v[132:135], v[44:47]
    ds_read_b64_tr_b16 v[200:201], v16 offset:45056
    v_mfma_f32_16x16x32_bf16 v[48:51], v[148:151], v[136:139], v[48:51]
    s_add_u32 m0, s46, 2048
    s_add_u32 s36, s36, 128
    buffer_load_dwordx4 v3, s[8:11], s34 offen lds
    v_mfma_f32_16x16x32_bf16 v[52:55], v[152:155], v[136:139], v[52:55]
    ds_read_b64_tr_b16 v[202:203], v16 offset:46080
    v_mfma_f32_16x16x32_bf16 v[56:59], v[156:159], v[136:139], v[56:59]
    ds_read_b64_tr_b16 v[204:205], v17 offset:45056
    v_mfma_f32_16x16x32_bf16 v[60:63], v[160:163], v[136:139], v[60:63]
    ds_read_b64_tr_b16 v[206:207], v17 offset:46080
    v_mfma_f32_16x16x32_bf16 v[64:67], v[164:167], v[136:139], v[64:67]
    v_mfma_f32_16x16x32_bf16 v[68:71], v[168:171], v[136:139], v[68:71]
    ds_read_b64_tr_b16 v[208:209], v16 offset:47104
    v_mfma_f32_16x16x32_bf16 v[72:75], v[172:175], v[136:139], v[72:75]
    ds_read_b64_tr_b16 v[210:211], v16 offset:48128
    v_mfma_f32_16x16x32_bf16 v[76:79], v[148:151], v[140:143], v[76:79]
    ds_read_b64_tr_b16 v[212:213], v17 offset:47104
    v_mfma_f32_16x16x32_bf16 v[80:83], v[152:155], v[140:143], v[80:83]
    v_mfma_f32_16x16x32_bf16 v[84:87], v[156:159], v[140:143], v[84:87]
    ds_read_b64_tr_b16 v[214:215], v17 offset:48128
    v_mfma_f32_16x16x32_bf16 v[88:91], v[160:163], v[140:143], v[88:91]
    ds_read_b64_tr_b16 v[216:217], v0 offset:43008
    v_mfma_f32_16x16x32_bf16 v[92:95], v[164:167], v[140:143], v[92:95]
    ds_read_b64_tr_b16 v[218:219], v0 offset:44032
    v_mfma_f32_16x16x32_bf16 v[96:99], v[168:171], v[140:143], v[96:99]
    v_mfma_f32_16x16x32_bf16 v[100:103], v[172:175], v[140:143], v[100:103]
    ds_read_b128 v[180:183], v9 offset:2048
    v_mfma_f32_16x16x32_bf16 v[104:107], v[148:151], v[144:147], v[104:107]
    ds_read_b128 v[184:187], v11 offset:0
    buffer_load_dwordx4 v4, s[8:11], s34 offen offset:1024 lds
    s_add_u32 s46, s46, 32768
    s_cmp_ge_u32 s46, 98304
    s_cselect_b32 s38, 98304, 0
    s_sub_u32 s46, s46, s38
    v_mfma_f32_16x16x32_bf16 v[108:111], v[152:155], v[144:147], v[108:111]
    ds_read_b128 v[188:191], v11 offset:2048
    v_mfma_f32_16x16x32_bf16 v[112:115], v[156:159], v[144:147], v[112:115]
    v_mfma_f32_16x16x32_bf16 v[116:119], v[160:163], v[144:147], v[116:119]
    v_mfma_f32_16x16x32_bf16 v[120:123], v[164:167], v[144:147], v[120:123]
    v_mfma_f32_16x16x32_bf16 v[124:127], v[168:171], v[144:147], v[124:127]
    v_add_u32 v8, s50, v8
    v_add_u32 v10, s50, v10
    v_mfma_f32_16x16x32_bf16 v[128:131], v[172:175], v[144:147], v[128:131]
    ds_write_b128 v2, v[220:223]
    s_waitcnt vmcnt(4) lgkmcnt(0)
    s_barrier
    s_cmp_lg_u32 s28, 7
    s_cbranch_scc1 L_csr_41
    v_lshrrev_b32 v2, 3, v1
    v_lshlrev_b32 v2, 4, v2
    v_bfe_u32 v7, v1, 2, 1
    v_lshl_add_u32 v2, v7, 8, v2
    v_and_b32 v7, 3, v1
    v_lshl_add_u32 v2, v7, 2, v2
    v_add_u32 v2, 155648, v2
    ds_read_b32 v224, v2 offset:0
    ds_read_b32 v225, v2 offset:128
    ds_read_b32 v226, v2 offset:1024
    ds_read_b32 v227, v2 offset:1152
    ds_read_b32 v228, v2 offset:2048
    ds_read_b32 v229, v2 offset:2176
    ds_read_b32 v230, v2 offset:3072
    ds_read_b32 v231, v2 offset:3200
    ds_read_b32 v232, v2 offset:4096
    ds_read_b32 v233, v2 offset:4224
    ds_read_b32 v234, v2 offset:5120
    ds_read_b32 v235, v2 offset:5248
    ds_read_b32 v236, v2 offset:6144
    ds_read_b32 v237, v2 offset:6272
    ds_read_b32 v238, v2 offset:7168
    ds_read_b32 v239, v2 offset:7296
    s_lshr_b32 s38, s2, 1
    s_lshl_b32 s38, s38, 8
    s_and_b32 s39, s2, 1
    s_mul_i32 s39, s39, 32768
    s_add_u32 s38, s38, s39
    s_add_u32 s38, s38, 65536
    v_lshlrev_b32 v2, 2, v1
    s_waitcnt lgkmcnt(0)
    v_add_f32 v224, v224, v232
    v_add_f32 v225, v225, v233
    v_add_f32 v226, v226, v234
    v_add_f32 v227, v227, v235
    v_add_f32 v228, v228, v236
    v_add_f32 v229, v229, v237
    v_add_f32 v230, v230, v238
    v_add_f32 v231, v231, v239
    v_add_f32 v224, v224, v228
    v_add_f32 v225, v225, v229
    v_add_f32 v226, v226, v230
    v_add_f32 v227, v227, v231
    v_add_f32 v224, v224, v226
    v_add_f32 v225, v225, v227
    v_add_f32 v224, v224, v225
    buffer_store_dword v224, v2, s[52:55], s38 offen sc1
L_csr_41:
    v_mfma_f32_16x16x32_bf16 v[20:23], v[192:195], v[176:179], v[20:23]
    ds_read_b128 v[132:135], v8 offset:0
    v_mfma_f32_16x16x32_bf16 v[24:27], v[196:199], v[176:179], v[24:27]
    ds_read_b64_tr_b16 v[148:149], v16 offset:0
    v_mfma_f32_16x16x32_bf16 v[28:31], v[200:203], v[176:179], v[28:31]
    ds_read_b64_tr_b16 v[150:151], v16 offset:1024
    v_mfma_f32_16x16x32_bf16 v[32:35], v[204:207], v[176:179], v[32:35]
    v_mfma_f32_16x16x32_bf16 v[36:39], v[208:211], v[176:179], v[36:39]
    ds_read_b64_tr_b16 v[152:153], v17 offset:0
    v_mfma_f32_16x16x32_bf16 v[40:43], v[212:215], v[176:179], v[40:43]
    ds_read_b64_tr_b16 v[154:155], v17 offset:1024
    v_mfma_f32_16x16x32_bf16 v[44:47], v[216:219], v[176:179], v[44:47]
    ds_read_b64_tr_b16 v[156:157], v16 offset:2048
    v_mfma_f32_16x16x32_bf16 v[48:51], v[192:195], v[180:183], v[48:51]
    s_mov_b32 m0, s46
    s_nop 0
    buffer_load_dwordx4 v3, s[8:11], s36 offen lds
    v_mfma_f32_16x16x32_bf16 v[52:55], v[196:199], v[180:183], v[52:55]
    ds_read_b64_tr_b16 v[158:159], v16 offset:3072
    v_mfma_f32_16x16x32_bf16 v[56:59], v[200:203], v[180:183], v[56:59]
    ds_read_b64_tr_b16 v[160:161], v17 offset:2048
    v_mfma_f32_16x16x32_bf16 v[60:63], v[204:207], v[180:183], v[60:63]
    ds_read_b64_tr_b16 v[162:163], v17 offset:3072
    v_mfma_f32_16x16x32_bf16 v[64:67], v[208:211], v[180:183], v[64:67]
    v_mfma_f32_16x16x32_bf16 v[68:71], v[212:215], v[180:183], v[68:71]
    ds_read_b64_tr_b16 v[164:165], v16 offset:4096
    v_mfma_f32_16x16x32_bf16 v[72:75], v[216:219], v[180:183], v[72:75]
    ds_read_b64_tr_b16 v[166:167], v16 offset:5120
    v_mfma_f32_16x16x32_bf16 v[76:79], v[192:195], v[184:187], v[76:79]
    ds_read_b64_tr_b16 v[168:169], v17 offset:4096
    v_mfma_f32_16x16x32_bf16 v[80:83], v[196:199], v[184:187], v[80:83]
    v_mfma_f32_16x16x32_bf16 v[84:87], v[200:203], v[184:187], v[84:87]
    ds_read_b64_tr_b16 v[170:171], v17 offset:5120
    v_mfma_f32_16x16x32_bf16 v[88:91], v[204:207], v[184:187], v[88:91]
    ds_read_b64_tr_b16 v[172:173], v0 offset:0
    v_mfma_f32_16x16x32_bf16 v[92:95], v[208:211], v[184:187], v[92:95]
    ds_read_b64_tr_b16 v[174:175], v0 offset:1024
    v_mfma_f32_16x16x32_bf16 v[96:99], v[212:215], v[184:187], v[96:99]
    v_mfma_f32_16x16x32_bf16 v[100:103], v[216:219], v[184:187], v[100:103]
    ds_read_b128 v[136:139], v8 offset:2048
    v_mfma_f32_16x16x32_bf16 v[104:107], v[192:195], v[188:191], v[104:107]
    ds_read_b128 v[140:143], v10 offset:0
    buffer_load_dwordx4 v4, s[8:11], s36 offen offset:1024 lds
    s_add_u32 s34, s36, 32768
    v_mfma_f32_16x16x32_bf16 v[108:111], v[196:199], v[188:191], v[108:111]
    ds_read_b128 v[144:147], v10 offset:2048
    v_mfma_f32_16x16x32_bf16 v[112:115], v[200:203], v[188:191], v[112:115]
    v_mfma_f32_16x16x32_bf16 v[116:119], v[204:207], v[188:191], v[116:119]
    v_mfma_f32_16x16x32_bf16 v[120:123], v[208:211], v[188:191], v[120:123]
    v_mfma_f32_16x16x32_bf16 v[124:127], v[212:215], v[188:191], v[124:127]
    v_add_u32 v9, s50, v9
    v_add_u32 v11, s50, v11
    s_add_u32 s47, s47, s50
    s_cmp_eq_u32 s47, 65536
    s_cselect_b32 s50, 0xffff0000, s51
    v_mfma_f32_16x16x32_bf16 v[128:131], v[216:219], v[188:191], v[128:131]
    s_mov_b32 s44, 5
L_k1loop_42:
    s_waitcnt vmcnt(4) lgkmcnt(0)
    s_barrier
    v_mfma_f32_16x16x32_bf16 v[20:23], v[148:151], v[132:135], v[20:23]
    ds_read_b128 v[176:179], v9 offset:0
    v_mfma_f32_16x16x32_bf16 v[24:27], v[152:155], v[132:135], v[24:27]
    ds_read_b64_tr_b16 v[192:193], v16 offset:14336
    v_mfma_f32_16x16x32_bf16 v[28:31], v[156:159], v[132:135], v[28:31]
    ds_read_b64_tr_b16 v[194:195], v16 offset:15360
    v_mfma_f32_16x16x32_bf16 v[32:35], v[160:163], v[132:135], v[32:35]
    v_mfma_f32_16x16x32_bf16 v[36:39], v[164:167], v[132:135], v[36:39]
    ds_read_b64_tr_b16 v[196:197], v17 offset:14336
    v_mfma_f32_16x16x32_bf16 v[40:43], v[168:171], v[132:135], v[40:43]
    ds_read_b64_tr_b16 v[198:199], v17 offset:15360
    v_mfma_f32_16x16x32_bf16 v[44:47], v[172:175], v[132:135], v[44:47]
    ds_read_b64_tr_b16 v[200:201], v16 offset:16384
    v_mfma_f32_16x16x32_bf16 v[48:51], v[148:151], v[136:139], v[48:51]
    s_add_u32 m0, s46, 2048
    s_add_u32 s36, s36, 128
    buffer_load_dwordx4 v3, s[8:11], s34 offen lds
    v_mfma_f32_16x16x32_bf16 v[52:55], v[152:155], v[136:139], v[52:55]
    ds_read_b64_tr_b16 v[202:203], v16 offset:17408
    v_mfma_f32_16x16x32_bf16 v[56:59], v[156:159], v[136:139], v[56:59]
    ds_read_b64_tr_b16 v[204:205], v17 offset:16384
    v_mfma_f32_16x16x32_bf16 v[60:63], v[160:163], v[136:139], v[60:63]
    ds_read_b64_tr_b16 v[206:207], v17 offset:17408
    v_mfma_f32_16x16x32_bf16 v[64:67], v[164:167], v[136:139], v[64:67]
    v_mfma_f32_16x16x32_bf16 v[68:71], v[168:171], v[136:139], v[68:71]
    ds_read_b64_tr_b16 v[208:209], v16 offset:18432
    v_mfma_f32_16x16x32_bf16 v[72:75], v[172:175], v[136:139], v[72:75]
    ds_read_b64_tr_b16 v[210:211], v16 offset:19456
    v_mfma_f32_16x16x32_bf16 v[76:79], v[148:151], v[140:143], v[76:79]
    ds_read_b64_tr_b16 v[212:213], v17 offset:18432
    v_mfma_f32_16x16x32_bf16 v[80:83], v[152:155], v[140:143], v[80:83]
    v_mfma_f32_16x16x32_bf16 v[84:87], v[156:159], v[140:143], v[84:87]
    ds_read_b64_tr_b16 v[214:215], v17 offset:19456
    v_mfma_f32_16x16x32_bf16 v[88:91], v[160:163], v[140:143], v[88:91]
    ds_read_b64_tr_b16 v[216:217], v0 offset:14336
    v_mfma_f32_16x16x32_bf16 v[92:95], v[164:167], v[140:143], v[92:95]
    ds_read_b64_tr_b16 v[218:219], v0 offset:15360
    v_mfma_f32_16x16x32_bf16 v[96:99], v[168:171], v[140:143], v[96:99]
    v_mfma_f32_16x16x32_bf16 v[100:103], v[172:175], v[140:143], v[100:103]
    ds_read_b128 v[180:183], v9 offset:2048
    v_mfma_f32_16x16x32_bf16 v[104:107], v[148:151], v[144:147], v[104:107]
    ds_read_b128 v[184:187], v11 offset:0
    buffer_load_dwordx4 v4, s[8:11], s34 offen offset:1024 lds
    s_add_u32 s46, s46, 32768
    s_cmp_ge_u32 s46, 98304
    s_cselect_b32 s38, 98304, 0
    s_sub_u32 s46, s46, s38
    v_mfma_f32_16x16x32_bf16 v[108:111], v[152:155], v[144:147], v[108:111]
    ds_read_b128 v[188:191], v11 offset:2048
    v_mfma_f32_16x16x32_bf16 v[112:115], v[156:159], v[144:147], v[112:115]
    v_mfma_f32_16x16x32_bf16 v[116:119], v[160:163], v[144:147], v[116:119]
    v_mfma_f32_16x16x32_bf16 v[120:123], v[164:167], v[144:147], v[120:123]
    v_mfma_f32_16x16x32_bf16 v[124:127], v[168:171], v[144:147], v[124:127]
    v_add_u32 v8, s50, v8
    v_add_u32 v10, s50, v10
    v_mfma_f32_16x16x32_bf16 v[128:131], v[172:175], v[144:147], v[128:131]
    s_waitcnt vmcnt(4) lgkmcnt(0)
    s_barrier
    v_mfma_f32_16x16x32_bf16 v[20:23], v[192:195], v[176:179], v[20:23]
    ds_read_b128 v[132:135], v8 offset:0
    v_mfma_f32_16x16x32_bf16 v[24:27], v[196:199], v[176:179], v[24:27]
    ds_read_b64_tr_b16 v[148:149], v16 offset:28672
    v_mfma_f32_16x16x32_bf16 v[28:31], v[200:203], v[176:179], v[28:31]
    ds_read_b64_tr_b16 v[150:151], v16 offset:29696
    v_mfma_f32_16x16x32_bf16 v[32:35], v[204:207], v[176:179], v[32:35]
    v_mfma_f32_16x16x32_bf16 v[36:39], v[208:211], v[176:179], v[36:39]
    ds_read_b64_tr_b16 v[152:153], v17 offset:28672
    v_mfma_f32_16x16x32_bf16 v[40:43], v[212:215], v[176:179], v[40:43]
    ds_read_b64_tr_b16 v[154:155], v17 offset:29696
    v_mfma_f32_16x16x32_bf16 v[44:47], v[216:219], v[176:179], v[44:47]
    ds_read_b64_tr_b16 v[156:157], v16 offset:30720
    v_mfma_f32_16x16x32_bf16 v[48:51], v[192:195], v[180:183], v[48:51]
    s_mov_b32 m0, s46
    s_nop 0
    buffer_load_dwordx4 v3, s[8:11], s36 offen lds
    v_mfma_f32_16x16x32_bf16 v[52:55], v[196:199], v[180:183], v[52:55]
    ds_read_b64_tr_b16 v[158:159], v16 offset:31744
    v_mfma_f32_16x16x32_bf16 v[56:59], v[200:203], v[180:183], v[56:59]
    ds_read_b64_tr_b16 v[160:161], v17 offset:30720
    v_mfma_f32_16x16x32_bf16 v[60:63], v[204:207], v[180:183], v[60:63]
    ds_read_b64_tr_b16 v[162:163], v17 offset:31744
    v_mfma_f32_16x16x32_bf16 v[64:67], v[208:211], v[180:183], v[64:67]
    v_mfma_f32_16x16x32_bf16 v[68:71], v[212:215], v[180:183], v[68:71]
    ds_read_b64_tr_b16 v[164:165], v16 offset:32768
    v_mfma_f32_16x16x32_bf16 v[72:75], v[216:219], v[180:183], v[72:75]
    ds_read_b64_tr_b16 v[166:167], v16 offset:33792
    v_mfma_f32_16x16x32_bf16 v[76:79], v[192:195], v[184:187], v[76:79]
    ds_read_b64_tr_b16 v[168:169], v17 offset:32768
    v_mfma_f32_16x16x32_bf16 v[80:83], v[196:199], v[184:187], v[80:83]
    v_mfma_f32_16x16x32_bf16 v[84:87], v[200:203], v[184:187], v[84:87]
    ds_read_b64_tr_b16 v[170:171], v17 offset:33792
    v_mfma_f32_16x16x32_bf16 v[88:91], v[204:207], v[184:187], v[88:91]
    ds_read_b64_tr_b16 v[172:173], v0 offset:28672
    v_mfma_f32_16x16x32_bf16 v[92:95], v[208:211], v[184:187], v[92:95]
    ds_read_b64_tr_b16 v[174:175], v0 offset:29696
    v_mfma_f32_16x16x32_bf16 v[96:99], v[212:215], v[184:187], v[96:99]
    v_mfma_f32_16x16x32_bf16 v[100:103], v[216:219], v[184:187], v[100:103]
    ds_read_b128 v[136:139], v8 offset:2048
    v_mfma_f32_16x16x32_bf16 v[104:107], v[192:195], v[188:191], v[104:107]
    ds_read_b128 v[140:143], v10 offset:0
    buffer_load_dwordx4 v4, s[8:11], s36 offen offset:1024 lds
    s_add_u32 s34, s36, 32768
    v_mfma_f32_16x16x32_bf16 v[108:111], v[196:199], v[188:191], v[108:111]
    ds_read_b128 v[144:147], v10 offset:2048
    v_mfma_f32_16x16x32_bf16 v[112:115], v[200:203], v[188:191], v[112:115]
    v_mfma_f32_16x16x32_bf16 v[116:119], v[204:207], v[188:191], v[116:119]
    v_mfma_f32_16x16x32_bf16 v[120:123], v[208:211], v[188:191], v[120:123]
    v_mfma_f32_16x16x32_bf16 v[124:127], v[212:215], v[188:191], v[124:127]
    v_add_u32 v9, s50, v9
    v_add_u32 v11, s50, v11
    s_add_u32 s47, s47, s50
    s_cmp_eq_u32 s47, 65536
    s_cselect_b32 s50, 0xffff0000, s51
    v_mfma_f32_16x16x32_bf16 v[128:131], v[216:219], v[188:191], v[128:131]
    s_waitcnt vmcnt(4) lgkmcnt(0)
    s_barrier
    v_mfma_f32_16x16x32_bf16 v[20:23], v[148:151], v[132:135], v[20:23]
    ds_read_b128 v[176:179], v9 offset:0
    v_mfma_f32_16x16x32_bf16 v[24:27], v[152:155], v[132:135], v[24:27]
    ds_read_b64_tr_b16 v[192:193], v16 offset:43008
    v_mfma_f32_16x16x32_bf16 v[28:31], v[156:159], v[132:135], v[28:31]
    ds_read_b64_tr_b16 v[194:195], v16 offset:44032
    v_mfma_f32_16x16x32_bf16 v[32:35], v[160:163], v[132:135], v[32:35]
    v_mfma_f32_16x16x32_bf16 v[36:39], v[164:167], v[132:135], v[36:39]
    ds_read_b64_tr_b16 v[196:197], v17 offset:43008
    v_mfma_f32_16x16x32_bf16 v[40:43], v[168:171], v[132:135], v[40:43]
    ds_read_b64_tr_b16 v[198:199], v17 offset:44032
    v_mfma_f32_16x16x32_bf16 v[44:47], v[172:175], v[132:135], v[44:47]
    ds_read_b64_tr_b16 v[200:201], v16 offset:45056
    v_mfma_f32_16x16x32_bf16 v[48:51], v[148:151], v[136:139], v[48:51]
    s_add_u32 m0, s46, 2048
    s_add_u32 s36, s36, 128
    buffer_load_dwordx4 v3, s[8:11], s34 offen lds
    v_mfma_f32_16x16x32_bf16 v[52:55], v[152:155], v[136:139], v[52:55]
    ds_read_b64_tr_b16 v[202:203], v16 offset:46080
    v_mfma_f32_16x16x32_bf16 v[56:59], v[156:159], v[136:139], v[56:59]
    ds_read_b64_tr_b16 v[204:205], v17 offset:45056
    v_mfma_f32_16x16x32_bf16 v[60:63], v[160:163], v[136:139], v[60:63]
    ds_read_b64_tr_b16 v[206:207], v17 offset:46080
    v_mfma_f32_16x16x32_bf16 v[64:67], v[164:167], v[136:139], v[64:67]
    v_mfma_f32_16x16x32_bf16 v[68:71], v[168:171], v[136:139], v[68:71]
    ds_read_b64_tr_b16 v[208:209], v16 offset:47104
    v_mfma_f32_16x16x32_bf16 v[72:75], v[172:175], v[136:139], v[72:75]
    ds_read_b64_tr_b16 v[210:211], v16 offset:48128
    v_mfma_f32_16x16x32_bf16 v[76:79], v[148:151], v[140:143], v[76:79]
    ds_read_b64_tr_b16 v[212:213], v17 offset:47104
    v_mfma_f32_16x16x32_bf16 v[80:83], v[152:155], v[140:143], v[80:83]
    v_mfma_f32_16x16x32_bf16 v[84:87], v[156:159], v[140:143], v[84:87]
    ds_read_b64_tr_b16 v[214:215], v17 offset:48128
    v_mfma_f32_16x16x32_bf16 v[88:91], v[160:163], v[140:143], v[88:91]
    ds_read_b64_tr_b16 v[216:217], v0 offset:43008
    v_mfma_f32_16x16x32_bf16 v[92:95], v[164:167], v[140:143], v[92:95]
    ds_read_b64_tr_b16 v[218:219], v0 offset:44032
    v_mfma_f32_16x16x32_bf16 v[96:99], v[168:171], v[140:143], v[96:99]
    v_mfma_f32_16x16x32_bf16 v[100:103], v[172:175], v[140:143], v[100:103]
    ds_read_b128 v[180:183], v9 offset:2048
    v_mfma_f32_16x16x32_bf16 v[104:107], v[148:151], v[144:147], v[104:107]
    ds_read_b128 v[184:187], v11 offset:0
    buffer_load_dwordx4 v4, s[8:11], s34 offen offset:1024 lds
    s_add_u32 s46, s46, 32768
    s_cmp_ge_u32 s46, 98304
    s_cselect_b32 s38, 98304, 0
    s_sub_u32 s46, s46, s38
    v_mfma_f32_16x16x32_bf16 v[108:111], v[152:155], v[144:147], v[108:111]
    ds_read_b128 v[188:191], v11 offset:2048
    v_mfma_f32_16x16x32_bf16 v[112:115], v[156:159], v[144:147], v[112:115]
    v_mfma_f32_16x16x32_bf16 v[116:119], v[160:163], v[144:147], v[116:119]
    v_mfma_f32_16x16x32_bf16 v[120:123], v[164:167], v[144:147], v[120:123]
    v_mfma_f32_16x16x32_bf16 v[124:127], v[168:171], v[144:147], v[124:127]
    v_add_u32 v8, s50, v8
    v_add_u32 v10, s50, v10
    v_mfma_f32_16x16x32_bf16 v[128:131], v[172:175], v[144:147], v[128:131]
    s_waitcnt vmcnt(4) lgkmcnt(0)
    s_barrier
    v_mfma_f32_16x16x32_bf16 v[20:23], v[192:195], v[176:179], v[20:23]
    ds_read_b128 v[132:135], v8 offset:0
    v_mfma_f32_16x16x32_bf16 v[24:27], v[196:199], v[176:179], v[24:27]
    ds_read_b64_tr_b16 v[148:149], v16 offset:0
    v_mfma_f32_16x16x32_bf16 v[28:31], v[200:203], v[176:179], v[28:31]
    ds_read_b64_tr_b16 v[150:151], v16 offset:1024
    v_mfma_f32_16x16x32_bf16 v[32:35], v[204:207], v[176:179], v[32:35]
    v_mfma_f32_16x16x32_bf16 v[36:39], v[208:211], v[176:179], v[36:39]
    ds_read_b64_tr_b16 v[152:153], v17 offset:0
    v_mfma_f32_16x16x32_bf16 v[40:43], v[212:215], v[176:179], v[40:43]
    ds_read_b64_tr_b16 v[154:155], v17 offset:1024
    v_mfma_f32_16x16x32_bf16 v[44:47], v[216:219], v[176:179], v[44:47]
    ds_read_b64_tr_b16 v[156:157], v16 offset:2048
    v_mfma_f32_16x16x32_bf16 v[48:51], v[192:195], v[180:183], v[48:51]
    s_mov_b32 m0, s46
    s_nop 0
    buffer_load_dwordx4 v3, s[8:11], s36 offen lds
    v_mfma_f32_16x16x32_bf16 v[52:55], v[196:199], v[180:183], v[52:55]
    ds_read_b64_tr_b16 v[158:159], v16 offset:3072
    v_mfma_f32_16x16x32_bf16 v[56:59], v[200:203], v[180:183], v[56:59]
    ds_read_b64_tr_b16 v[160:161], v17 offset:2048
    v_mfma_f32_16x16x32_bf16 v[60:63], v[204:207], v[180:183], v[60:63]
    ds_read_b64_tr_b16 v[162:163], v17 offset:3072
    v_mfma_f32_16x16x32_bf16 v[64:67], v[208:211], v[180:183], v[64:67]
    v_mfma_f32_16x16x32_bf16 v[68:71], v[212:215], v[180:183], v[68:71]
    ds_read_b64_tr_b16 v[164:165], v16 offset:4096
    v_mfma_f32_16x16x32_bf16 v[72:75], v[216:219], v[180:183], v[72:75]
    ds_read_b64_tr_b16 v[166:167], v16 offset:5120
    v_mfma_f32_16x16x32_bf16 v[76:79], v[192:195], v[184:187], v[76:79]
    ds_read_b64_tr_b16 v[168:169], v17 offset:4096
    v_mfma_f32_16x16x32_bf16 v[80:83], v[196:199], v[184:187], v[80:83]
    v_mfma_f32_16x16x32_bf16 v[84:87], v[200:203], v[184:187], v[84:87]
    ds_read_b64_tr_b16 v[170:171], v17 offset:5120
    v_mfma_f32_16x16x32_bf16 v[88:91], v[204:207], v[184:187], v[88:91]
    ds_read_b64_tr_b16 v[172:173], v0 offset:0
    v_mfma_f32_16x16x32_bf16 v[92:95], v[208:211], v[184:187], v[92:95]
    ds_read_b64_tr_b16 v[174:175], v0 offset:1024
    v_mfma_f32_16x16x32_bf16 v[96:99], v[212:215], v[184:187], v[96:99]
    v_mfma_f32_16x16x32_bf16 v[100:103], v[216:219], v[184:187], v[100:103]
    ds_read_b128 v[136:139], v8 offset:2048
    v_mfma_f32_16x16x32_bf16 v[104:107], v[192:195], v[188:191], v[104:107]
    ds_read_b128 v[140:143], v10 offset:0
    buffer_load_dwordx4 v4, s[8:11], s36 offen offset:1024 lds
    s_add_u32 s34, s36, 32768
    v_mfma_f32_16x16x32_bf16 v[108:111], v[196:199], v[188:191], v[108:111]
    ds_read_b128 v[144:147], v10 offset:2048
    v_mfma_f32_16x16x32_bf16 v[112:115], v[200:203], v[188:191], v[112:115]
    v_mfma_f32_16x16x32_bf16 v[116:119], v[204:207], v[188:191], v[116:119]
    v_mfma_f32_16x16x32_bf16 v[120:123], v[208:211], v[188:191], v[120:123]
    v_mfma_f32_16x16x32_bf16 v[124:127], v[212:215], v[188:191], v[124:127]
    v_add_u32 v9, s50, v9
    v_add_u32 v11, s50, v11
    s_add_u32 s47, s47, s50
    s_cmp_eq_u32 s47, 65536
    s_cselect_b32 s50, 0xffff0000, s51
    v_mfma_f32_16x16x32_bf16 v[128:131], v[216:219], v[188:191], v[128:131]
    s_lshl_b32 s38, s44, 3
    s_add_u32 s38, s38, s28
    s_cmp_lg_u32 s38, 47
    s_cbranch_scc1 L_sig_43
    v_mov_b32 v12, 1
    v_mov_b32 v13, 0
    s_mov_b64 exec, 1
    buffer_atomic_add v12, v13, s[56:59], 0 offen sc1
    s_mov_b64 exec, -1
L_sig_43:
    s_sub_u32 s44, s44, 1
    s_cmp_lg_u32 s44, 0
    s_cbranch_scc1 L_k1loop_42
    s_waitcnt vmcnt(4) lgkmcnt(0)
    s_barrier
    v_mov_b32 v3, 0
    buffer_load_dword v4, v3, s[56:59], 0 offen sc1
    v_mfma_f32_16x16x32_bf16 v[20:23], v[148:151], v[132:135], v[20:23]
    ds_read_b128 v[176:179], v9 offset:0
    v_mfma_f32_16x16x32_bf16 v[24:27], v[152:155], v[132:135], v[24:27]
    ds_read_b64_tr_b16 v[192:193], v16 offset:14336
    v_mfma_f32_16x16x32_bf16 v[28:31], v[156:159], v[132:135], v[28:31]
    ds_read_b64_tr_b16 v[194:195], v16 offset:15360
    v_mfma_f32_16x16x32_bf16 v[32:35], v[160:163], v[132:135], v[32:35]
    v_mfma_f32_16x16x32_bf16 v[36:39], v[164:167], v[132:135], v[36:39]
    ds_read_b64_tr_b16 v[196:197], v17 offset:14336
    v_mfma_f32_16x16x32_bf16 v[40:43], v[168:171], v[132:135], v[40:43]
    ds_read_b64_tr_b16 v[198:199], v17 offset:15360
    v_mfma_f32_16x16x32_bf16 v[44:47], v[172:175], v[132:135], v[44:47]
    ds_read_b64_tr_b16 v[200:201], v16 offset:16384
    v_mfma_f32_16x16x32_bf16 v[48:51], v[148:151], v[136:139], v[48:51]
    v_mfma_f32_16x16x32_bf16 v[52:55], v[152:155], v[136:139], v[52:55]
    ds_read_b64_tr_b16 v[202:203], v16 offset:17408
    v_mfma_f32_16x16x32_bf16 v[56:59], v[156:159], v[136:139], v[56:59]
    ds_read_b64_tr_b16 v[204:205], v17 offset:16384
    v_mfma_f32_16x16x32_bf16 v[60:63], v[160:163], v[136:139], v[60:63]
    ds_read_b64_tr_b16 v[206:207], v17 offset:17408
    v_mfma_f32_16x16x32_bf16 v[64:67], v[164:167], v[136:139], v[64:67]
    v_mfma_f32_16x16x32_bf16 v[68:71], v[168:171], v[136:139], v[68:71]
    ds_read_b64_tr_b16 v[208:209], v16 offset:18432
    v_mfma_f32_16x16x32_bf16 v[72:75], v[172:175], v[136:139], v[72:75]
    ds_read_b64_tr_b16 v[210:211], v16 offset:19456
    v_mfma_f32_16x16x32_bf16 v[76:79], v[148:151], v[140:143], v[76:79]
    ds_read_b64_tr_b16 v[212:213], v17 offset:18432
    v_mfma_f32_16x16x32_bf16 v[80:83], v[152:155], v[140:143], v[80:83]
    v_mfma_f32_16x16x32_bf16 v[84:87], v[156:159], v[140:143], v[84:87]
    ds_read_b64_tr_b16 v[214:215], v17 offset:19456
    v_mfma_f32_16x16x32_bf16 v[88:91], v[160:163], v[140:143], v[88:91]
    ds_read_b64_tr_b16 v[216:217], v0 offset:14336
    v_mfma_f32_16x16x32_bf16 v[92:95], v[164:167], v[140:143], v[92:95]
    ds_read_b64_tr_b16 v[218:219], v0 offset:15360
    v_mfma_f32_16x16x32_bf16 v[96:99], v[168:171], v[140:143], v[96:99]
    v_mfma_f32_16x16x32_bf16 v[100:103], v[172:175], v[140:143], v[100:103]
    ds_read_b128 v[180:183], v9 offset:2048
    v_mfma_f32_16x16x32_bf16 v[104:107], v[148:151], v[144:147], v[104:107]
    ds_read_b128 v[184:187], v11 offset:0
    v_mfma_f32_16x16x32_bf16 v[108:111], v[152:155], v[144:147], v[108:111]
    ds_read_b128 v[188:191], v11 offset:2048
    v_mfma_f32_16x16x32_bf16 v[112:115], v[156:159], v[144:147], v[112:115]
    v_mfma_f32_16x16x32_bf16 v[116:119], v[160:163], v[144:147], v[116:119]
    v_mfma_f32_16x16x32_bf16 v[120:123], v[164:167], v[144:147], v[120:123]
    v_mfma_f32_16x16x32_bf16 v[124:127], v[168:171], v[144:147], v[124:127]
    v_add_u32 v8, s50, v8
    v_add_u32 v10, s50, v10
    v_mfma_f32_16x16x32_bf16 v[128:131], v[172:175], v[144:147], v[128:131]
    s_waitcnt vmcnt(0) lgkmcnt(0)
    s_barrier
    s_cmp_lg_u32 s28, 7
    s_cbranch_scc1 L_pc_46
L_pa_44:
    v_readfirstlane_b32 s38, v4
    s_cmp_ge_u32 s38, 256
    s_cbranch_scc1 L_pb_45
    buffer_load_dword v4, v3, s[56:59], 0 offen sc1
    s_waitcnt vmcnt(0)
    s_branch L_pa_44
L_pb_45:
    s_lshl_b32 s38, s29, 10
    s_add_u32 s38, s38, 49152
    s_add_u32 s41, s38, 7168
    s_mov_b32 m0, 155648
    v_mov_b32 v2, v19
    s_mul_i32 s39, s30, 896
    s_add_u32 s39, s39, 75776
    s_add_u32 s40, s39, 31744
    buffer_load_dwordx4 v19, s[52:55], s38 offen sc1 lds
    buffer_load_dwordx4 v19, s[52:55], s41 offen offset:1024 sc1 lds
    buffer_load_dwordx4 v2, s[52:55], s39 offen offset:2048 sc1 lds
    buffer_load_dwordx4 v2, s[52:55], s40 offen offset:3072 sc1 lds
    s_mov_b32 s16, s26
    s_mov_b32 s17, s27
    s_mov_b32 s18, 0x1c00
    s_mov_b32 s19, 0x00020000
    s_mov_b32 m0, 159744
    s_mul_i32 s39, s30, 448
    buffer_load_dwordx4 v19, s[16:19], s39 offen lds
L_pc_46:
    v_mfma_f32_16x16x32_bf16 v[20:23], v[192:195], v[176:179], v[20:23]
    ds_read_b128 v[132:135], v8 offset:0
    v_mfma_f32_16x16x32_bf16 v[24:27], v[196:199], v[176:179], v[24:27]
    ds_read_b64_tr_b16 v[148:149], v16 offset:28672
    v_mfma_f32_16x16x32_bf16 v[28:31], v[200:203], v[176:179], v[28:31]
    ds_read_b64_tr_b16 v[150:151], v16 offset:29696
    v_mfma_f32_16x16x32_bf16 v[32:35], v[204:207], v[176:179], v[32:35]
    v_mfma_f32_16x16x32_bf16 v[36:39], v[208:211], v[176:179], v[36:39]
    ds_read_b64_tr_b16 v[152:153], v17 offset:28672
    v_mfma_f32_16x16x32_bf16 v[40:43], v[212:215], v[176:179], v[40:43]
    ds_read_b64_tr_b16 v[154:155], v17 offset:29696
    v_mfma_f32_16x16x32_bf16 v[44:47], v[216:219], v[176:179], v[44:47]
    ds_read_b64_tr_b16 v[156:157], v16 offset:30720
    v_mfma_f32_16x16x32_bf16 v[48:51], v[192:195], v[180:183], v[48:51]
    v_mfma_f32_16x16x32_bf16 v[52:55], v[196:199], v[180:183], v[52:55]
    ds_read_b64_tr_b16 v[158:159], v16 offset:31744
    v_mfma_f32_16x16x32_bf16 v[56:59], v[200:203], v[180:183], v[56:59]
    ds_read_b64_tr_b16 v[160:161], v17 offset:30720
    v_mfma_f32_16x16x32_bf16 v[60:63], v[204:207], v[180:183], v[60:63]
    ds_read_b64_tr_b16 v[162:163], v17 offset:31744
    v_mfma_f32_16x16x32_bf16 v[64:67], v[208:211], v[180:183], v[64:67]
    v_mfma_f32_16x16x32_bf16 v[68:71], v[212:215], v[180:183], v[68:71]
    ds_read_b64_tr_b16 v[164:165], v16 offset:32768
    v_mfma_f32_16x16x32_bf16 v[72:75], v[216:219], v[180:183], v[72:75]
    ds_read_b64_tr_b16 v[166:167], v16 offset:33792
    v_mfma_f32_16x16x32_bf16 v[76:79], v[192:195], v[184:187], v[76:79]
    ds_read_b64_tr_b16 v[168:169], v17 offset:32768
    v_mfma_f32_16x16x32_bf16 v[80:83], v[196:199], v[184:187], v[80:83]
    v_mfma_f32_16x16x32_bf16 v[84:87], v[200:203], v[184:187], v[84:87]
    ds_read_b64_tr_b16 v[170:171], v17 offset:33792
    v_mfma_f32_16x16x32_bf16 v[88:91], v[204:207], v[184:187], v[88:91]
    ds_read_b64_tr_b16 v[172:173], v0 offset:28672
    v_mfma_f32_16x16x32_bf16 v[92:95], v[208:211], v[184:187], v[92:95]
    ds_read_b64_tr_b16 v[174:175], v0 offset:29696
    v_mfma_f32_16x16x32_bf16 v[96:99], v[212:215], v[184:187], v[96:99]
    v_mfma_f32_16x16x32_bf16 v[100:103], v[216:219], v[184:187], v[100:103]
    ds_read_b128 v[136:139], v8 offset:2048
    v_mfma_f32_16x16x32_bf16 v[104:107], v[192:195], v[188:191], v[104:107]
    ds_read_b128 v[140:143], v10 offset:0
    v_mfma_f32_16x16x32_bf16 v[108:111], v[196:199], v[188:191], v[108:111]
    ds_read_b128 v[144:147], v10 offset:2048
    v_mfma_f32_16x16x32_bf16 v[112:115], v[200:203], v[188:191], v[112:115]
    v_mfma_f32_16x16x32_bf16 v[116:119], v[204:207], v[188:191], v[116:119]
    v_mfma_f32_16x16x32_bf16 v[120:123], v[208:211], v[188:191], v[120:123]
    v_mfma_f32_16x16x32_bf16 v[124:127], v[212:215], v[188:191], v[124:127]
    v_add_u32 v9, s50, v9
    v_add_u32 v11, s50, v11
    s_add_u32 s47, s47, s50
    s_cmp_eq_u32 s47, 65536
    s_cselect_b32 s50, 0xffff0000, s51
    v_mfma_f32_16x16x32_bf16 v[128:131], v[216:219], v[188:191], v[128:131]
    s_waitcnt vmcnt(63) lgkmcnt(0)
    s_barrier
    v_lshlrev_b32 v7, 6, v1
    s_lshl_b32 s38, s31, 12
    s_mov_b32 s16, s90
    s_mov_b32 s17, s91
    s_mov_b32 s18, 0x700000
    s_mov_b32 s19, 0x00020000
    buffer_load_dword v3, v7, s[16:19], s38 offen
    s_mov_b32 s16, s92
    s_mov_b32 s17, s93
    s_mov_b32 s18, 0x200000
    s_mov_b32 s19, 0x00020000
    buffer_load_dword v4, v7, s[16:19], s38 offen
    s_lshl_b32 s38, s32, 7
    s_sub_u32 s39, 156544, s38
    s_add_u32 s38, s38, 155648
    v_and_b32 v2, 15, v1
    v_and_b32 v7, 48, v1
    v_lshl_add_u32 v12, v2, 2, s38
    v_lshl_add_u32 v13, v2, 2, s39
    s_lshl_b32 s38, s33, 9
    s_add_u32 s38, s38, 157696
    v_add_u32 v5, s38, v7
    v_lshrrev_b32 v7, 1, v7
    s_lshl_b32 s38, s33, 8
    s_add_u32 s38, s38, 159744
    v_add_u32 v14, s38, v7
    v_and_b32 v2, 16, v1
    v_lshrrev_b32 v7, 3, v1
    v_and_b32 v7, 4, v7
    v_add_u32 v2, v2, v7
    s_lshl_b32 s38, s33, 5
    s_add_u32 s38, s38, 158080
    v_lshl_add_u32 v6, v2, 2, s38
    s_lshl_b32 s38, s33, 4
    s_add_u32 s38, s38, 159936
    v_lshl_add_u32 v15, v2, 1, s38
    v_mfma_f32_16x16x32_bf16 v[20:23], v[148:151], v[132:135], v[20:23]
    ds_read_b128 v[176:179], v9 offset:0
    v_mfma_f32_16x16x32_bf16 v[24:27], v[152:155], v[132:135], v[24:27]
    ds_read_b64_tr_b16 v[192:193], v16 offset:43008
    v_mfma_f32_16x16x32_bf16 v[28:31], v[156:159], v[132:135], v[28:31]
    ds_read_b64_tr_b16 v[194:195], v16 offset:44032
    v_mfma_f32_16x16x32_bf16 v[32:35], v[160:163], v[132:135], v[32:35]
    v_mfma_f32_16x16x32_bf16 v[36:39], v[164:167], v[132:135], v[36:39]
    ds_read_b64_tr_b16 v[196:197], v17 offset:43008
    v_mfma_f32_16x16x32_bf16 v[40:43], v[168:171], v[132:135], v[40:43]
    ds_read_b64_tr_b16 v[198:199], v17 offset:44032
    v_mfma_f32_16x16x32_bf16 v[44:47], v[172:175], v[132:135], v[44:47]
    ds_read_b64_tr_b16 v[200:201], v16 offset:45056
    v_mfma_f32_16x16x32_bf16 v[48:51], v[148:151], v[136:139], v[48:51]
    v_mfma_f32_16x16x32_bf16 v[52:55], v[152:155], v[136:139], v[52:55]
    ds_read_b64_tr_b16 v[202:203], v16 offset:46080
    v_mfma_f32_16x16x32_bf16 v[56:59], v[156:159], v[136:139], v[56:59]
    ds_read_b64_tr_b16 v[204:205], v17 offset:45056
    v_mfma_f32_16x16x32_bf16 v[60:63], v[160:163], v[136:139], v[60:63]
    ds_read_b64_tr_b16 v[206:207], v17 offset:46080
    v_mfma_f32_16x16x32_bf16 v[64:67], v[164:167], v[136:139], v[64:67]
    v_mfma_f32_16x16x32_bf16 v[68:71], v[168:171], v[136:139], v[68:71]
    ds_read_b64_tr_b16 v[208:209], v16 offset:47104
    v_mfma_f32_16x16x32_bf16 v[72:75], v[172:175], v[136:139], v[72:75]
    ds_read_b64_tr_b16 v[210:211], v16 offset:48128
    v_mfma_f32_16x16x32_bf16 v[76:79], v[148:151], v[140:143], v[76:79]
    ds_read_b64_tr_b16 v[212:213], v17 offset:47104
    v_mfma_f32_16x16x32_bf16 v[80:83], v[152:155], v[140:143], v[80:83]
    v_mfma_f32_16x16x32_bf16 v[84:87], v[156:159], v[140:143], v[84:87]
    ds_read_b64_tr_b16 v[214:215], v17 offset:48128
    v_mfma_f32_16x16x32_bf16 v[88:91], v[160:163], v[140:143], v[88:91]
    ds_read_b64_tr_b16 v[216:217], v0 offset:43008
    v_mfma_f32_16x16x32_bf16 v[92:95], v[164:167], v[140:143], v[92:95]
    ds_read_b64_tr_b16 v[218:219], v0 offset:44032
    v_mfma_f32_16x16x32_bf16 v[96:99], v[168:171], v[140:143], v[96:99]
    v_mfma_f32_16x16x32_bf16 v[100:103], v[172:175], v[140:143], v[100:103]
    ds_read_b128 v[180:183], v9 offset:2048
    v_mfma_f32_16x16x32_bf16 v[104:107], v[148:151], v[144:147], v[104:107]
    ds_read_b128 v[184:187], v11 offset:0
    v_mfma_f32_16x16x32_bf16 v[108:111], v[152:155], v[144:147], v[108:111]
    ds_read_b128 v[188:191], v11 offset:2048
    v_mfma_f32_16x16x32_bf16 v[112:115], v[156:159], v[144:147], v[112:115]
    v_mfma_f32_16x16x32_bf16 v[116:119], v[160:163], v[144:147], v[116:119]
    v_mfma_f32_16x16x32_bf16 v[120:123], v[164:167], v[144:147], v[120:123]
    v_mfma_f32_16x16x32_bf16 v[124:127], v[168:171], v[144:147], v[124:127]
    v_add_u32 v8, s50, v8
    v_add_u32 v10, s50, v10
    v_mfma_f32_16x16x32_bf16 v[128:131], v[172:175], v[144:147], v[128:131]
    s_waitcnt vmcnt(2) lgkmcnt(0)
    s_barrier
    v_mfma_f32_16x16x32_bf16 v[20:23], v[192:195], v[176:179], v[20:23]
    ds_read_b32 v220, v12 offset:0
    ds_read_b32 v221, v12 offset:1024
    v_mfma_f32_16x16x32_bf16 v[24:27], v[196:199], v[176:179], v[24:27]
    ds_read_b32 v222, v12 offset:64
    v_mfma_f32_16x16x32_bf16 v[28:31], v[200:203], v[176:179], v[28:31]
    ds_read_b32 v223, v12 offset:1088
    v_mfma_f32_16x16x32_bf16 v[32:35], v[204:207], v[176:179], v[32:35]
    ds_read_b32 v224, v13 offset:0
    v_mfma_f32_16x16x32_bf16 v[36:39], v[208:211], v[176:179], v[36:39]
    ds_read_b32 v225, v13 offset:1024
    ds_read_b32 v226, v13 offset:64
    v_mfma_f32_16x16x32_bf16 v[40:43], v[212:215], v[176:179], v[40:43]
    ds_read_b32 v227, v13 offset:1088
    v_mfma_f32_16x16x32_bf16 v[44:47], v[216:219], v[176:179], v[44:47]
    ds_read_b128 v[132:135], v5 offset:0
    v_mfma_f32_16x16x32_bf16 v[48:51], v[192:195], v[180:183], v[48:51]
    ds_read_b128 v[136:139], v5 offset:64
    v_mfma_f32_16x16x32_bf16 v[52:55], v[196:199], v[180:183], v[52:55]
    ds_read_b128 v[140:143], v5 offset:128
    v_mfma_f32_16x16x32_bf16 v[56:59], v[200:203], v[180:183], v[56:59]
    ds_read_b128 v[144:147], v5 offset:192
    ds_read_b128 v[148:151], v5 offset:256
    v_mfma_f32_16x16x32_bf16 v[60:63], v[204:207], v[180:183], v[60:63]
    ds_read_b128 v[152:155], v5 offset:320
    v_mfma_f32_16x16x32_bf16 v[64:67], v[208:211], v[180:183], v[64:67]
    ds_read_b128 v[156:159], v6 offset:0
    v_mfma_f32_16x16x32_bf16 v[68:71], v[212:215], v[180:183], v[68:71]
    ds_read_b128 v[228:231], v5 offset:1024
    v_mfma_f32_16x16x32_bf16 v[72:75], v[216:219], v[180:183], v[72:75]
    ds_read_b128 v[232:235], v5 offset:1088
    v_mfma_f32_16x16x32_bf16 v[76:79], v[192:195], v[184:187], v[76:79]
    ds_read_b128 v[236:239], v5 offset:1152
    ds_read_b128 v[240:243], v5 offset:1216
    v_mfma_f32_16x16x32_bf16 v[80:83], v[196:199], v[184:187], v[80:83]
    ds_read_b128 v[244:247], v5 offset:1280
    v_mfma_f32_16x16x32_bf16 v[84:87], v[200:203], v[184:187], v[84:87]
    ds_read_b128 v[248:251], v5 offset:1344
    v_mfma_f32_16x16x32_bf16 v[88:91], v[204:207], v[184:187], v[88:91]
    ds_read_b128 v[252:255], v6 offset:1024
    v_mfma_f32_16x16x32_bf16 v[92:95], v[208:211], v[184:187], v[92:95]
    ds_read_b64 v[160:161], v14 offset:0
    v_mfma_f32_16x16x32_bf16 v[96:99], v[212:215], v[184:187], v[96:99]
    ds_read_b64 v[162:163], v14 offset:32
    ds_read_b64 v[164:165], v14 offset:64
    v_mfma_f32_16x16x32_bf16 v[100:103], v[216:219], v[184:187], v[100:103]
    ds_read_b64 v[166:167], v14 offset:96
    v_mfma_f32_16x16x32_bf16 v[104:107], v[192:195], v[188:191], v[104:107]
    ds_read_b64 v[168:169], v14 offset:128
    v_mfma_f32_16x16x32_bf16 v[108:111], v[196:199], v[188:191], v[108:111]
    ds_read_b64 v[170:171], v14 offset:160
    v_mfma_f32_16x16x32_bf16 v[112:115], v[200:203], v[188:191], v[112:115]
    ds_read_b64 v[172:173], v15 offset:0
    v_mfma_f32_16x16x32_bf16 v[116:119], v[204:207], v[188:191], v[116:119]
    v_mfma_f32_16x16x32_bf16 v[120:123], v[208:211], v[188:191], v[120:123]
    v_mfma_f32_16x16x32_bf16 v[124:127], v[212:215], v[188:191], v[124:127]
    v_add_u32 v9, s50, v9
    v_add_u32 v11, s50, v11
    s_add_u32 s47, s47, s50
    s_cmp_eq_u32 s47, 65536
    s_cselect_b32 s50, 0xffff0000, s51
    v_mfma_f32_16x16x32_bf16 v[128:131], v[216:219], v[188:191], v[128:131]
L_k1_w1_epi:
    s_waitcnt lgkmcnt(0)
    v_pk_add_f32 v[132:133], v[132:133], v[228:229]
    v_pk_add_f32 v[134:135], v[134:135], v[230:231]
    v_pk_add_f32 v[136:137], v[136:137], v[232:233]
    v_pk_add_f32 v[138:139], v[138:139], v[234:235]
    v_pk_add_f32 v[140:141], v[140:141], v[236:237]
    v_pk_add_f32 v[142:143], v[142:143], v[238:239]
    v_pk_add_f32 v[144:145], v[144:145], v[240:241]
    v_pk_add_f32 v[146:147], v[146:147], v[242:243]
    v_pk_add_f32 v[148:149], v[148:149], v[244:245]
    v_pk_add_f32 v[150:151], v[150:151], v[246:247]
    v_pk_add_f32 v[152:153], v[152:153], v[248:249]
    v_pk_add_f32 v[154:155], v[154:155], v[250:251]
    v_pk_add_f32 v[156:157], v[156:157], v[252:253]
    v_pk_add_f32 v[158:159], v[158:159], v[254:255]
    v_mov_b32 v208, v221
    v_mov_b32 v209, v221
    v_mov_b32 v221, v220
    v_mov_b32 v210, v223
    v_mov_b32 v211, v223
    v_mov_b32 v223, v222
    v_mov_b32 v212, v225
    v_mov_b32 v213, v225
    v_mov_b32 v225, v224
    v_mov_b32 v214, v227
    v_mov_b32 v215, v227
    v_mov_b32 v227, v226
    s_add_u32 s12, s6, 0x1400000
    s_addc_u32 s13, s7, 0
    s_mov_b32 s14, 0x1200000
    s_mov_b32 s15, 0x00020000
    s_lshl_b32 s39, s29, 14
    s_lshl_b32 s40, s32, 11
    s_sub_u32 s41, 14336, s40
    s_add_u32 s40, s40, s39
    s_add_u32 s41, s41, s39
    s_mov_b32 s31, 0
    s_mov_b32 s68, 0
    v_lshlrev_b32 v228, 16, v160
    v_and_b32 v229, 0xffff0000, v160
    v_lshlrev_b32 v230, 16, v161
    v_and_b32 v231, 0xffff0000, v161
    v_lshlrev_b32 v232, 16, v162
    v_and_b32 v233, 0xffff0000, v162
    v_lshlrev_b32 v234, 16, v163
    v_and_b32 v235, 0xffff0000, v163
    v_lshlrev_b32 v236, 16, v164
    v_and_b32 v237, 0xffff0000, v164
    v_lshlrev_b32 v238, 16, v165
    v_and_b32 v239, 0xffff0000, v165
    v_lshlrev_b32 v240, 16, v166
    v_and_b32 v241, 0xffff0000, v166
    v_lshlrev_b32 v242, 16, v167
    v_and_b32 v243, 0xffff0000, v167
    v_lshlrev_b32 v244, 16, v168
    v_and_b32 v245, 0xffff0000, v168
    v_lshlrev_b32 v246, 16, v169
    v_and_b32 v247, 0xffff0000, v169
    v_lshlrev_b32 v248, 16, v170
    v_and_b32 v249, 0xffff0000, v170
    v_lshlrev_b32 v250, 16, v171
    v_and_b32 v251, 0xffff0000, v171
    v_lshlrev_b32 v252, 16, v172
    v_and_b32 v253, 0xffff0000, v172
    v_lshlrev_b32 v254, 16, v173
    v_and_b32 v255, 0xffff0000, v173
    v_mov_b32 v8, 0xc0135761
    v_mov_b32 v12, 0xbdd2d3e8
    v_mov_b32 v216, 1.0
    v_mov_b32 v9, 0xc0135761
    v_mov_b32 v13, 0xbdd2d3e8
    v_mov_b32 v217, 1.0
    s_mul_i32 s38, s30, 7
    s_lshl_b32 s38, s38, 17
    s_add_u32 s40, s40, s38
    s_add_u32 s41, s41, s38
    s_lshl_b32 s39, s33, 9
    s_add_u32 s39, s39, 0x60000
    s_add_u32 s42, s40, s39
    s_add_u32 s43, s41, s39
    s_lshl_b32 s39, s33, 19
    s_add_u32 s40, s40, s39
    s_add_u32 s41, s41, s39
    v_and_b32 v10, 0xf0, v19
    v_and_b32 v2, 16, v1
    v_lshl_add_u32 v10, v2, 6, v10
    v_and_b32 v2, 32, v1
    v_lshl_add_u32 v10, v2, 3, v10
    v_pk_fma_f32 v[176:177], v[132:133], v[208:209], v[228:229]
    v_pk_fma_f32 v[178:179], v[134:135], v[208:209], v[230:231]
    v_pk_fma_f32 v[180:181], v[136:137], v[208:209], v[232:233]
    v_pk_fma_f32 v[182:183], v[138:139], v[208:209], v[234:235]
    v_pk_fma_f32 v[20:21], v[20:21], v[220:221], v[176:177]
    v_pk_fma_f32 v[22:23], v[22:23], v[220:221], v[178:179]
    v_pk_fma_f32 v[24:25], v[24:25], v[220:221], v[180:181]
    v_pk_fma_f32 v[26:27], v[26:27], v[220:221], v[182:183]
    v_pk_mul_f32 v[176:177], v[20:21], v[20:21]
    v_pk_mul_f32 v[178:179], v[22:23], v[22:23]
    v_pk_mul_f32 v[180:181], v[24:25], v[24:25]
    v_pk_mul_f32 v[182:183], v[26:27], v[26:27]
    v_pk_fma_f32 v[176:177], v[176:177], v[12:13], v[8:9]
    v_pk_fma_f32 v[178:179], v[178:179], v[12:13], v[8:9]
    v_pk_fma_f32 v[180:181], v[180:181], v[12:13], v[8:9]
    v_pk_fma_f32 v[182:183], v[182:183], v[12:13], v[8:9]
    v_pk_mul_f32 v[176:177], v[176:177], v[20:21]
    v_pk_mul_f32 v[178:179], v[178:179], v[22:23]
    v_pk_mul_f32 v[180:181], v[180:181], v[24:25]
    v_pk_mul_f32 v[182:183], v[182:183], v[26:27]
    v_exp_f32 v176, v176
    v_exp_f32 v177, v177
    v_exp_f32 v178, v178
    v_exp_f32 v179, v179
    v_exp_f32 v180, v180
    v_exp_f32 v181, v181
    v_exp_f32 v182, v182
    v_exp_f32 v183, v183
    v_pk_add_f32 v[176:177], v[176:177], v[216:217]
    v_pk_add_f32 v[178:179], v[178:179], v[216:217]
    v_pk_add_f32 v[180:181], v[180:181], v[216:217]
    v_pk_add_f32 v[182:183], v[182:183], v[216:217]
    v_rcp_f32 v176, v176
    v_rcp_f32 v177, v177
    v_rcp_f32 v178, v178
    v_rcp_f32 v179, v179
    v_rcp_f32 v180, v180
    v_rcp_f32 v181, v181
    v_rcp_f32 v182, v182
    v_rcp_f32 v183, v183
    v_pk_mul_f32 v[20:21], v[20:21], v[176:177]
    v_pk_mul_f32 v[22:23], v[22:23], v[178:179]
    v_pk_mul_f32 v[24:25], v[24:25], v[180:181]
    v_pk_mul_f32 v[26:27], v[26:27], v[182:183]
    v_cvt_pk_bf16_f32 v184, v20, v21
    v_cvt_pk_bf16_f32 v185, v22, v23
    v_cvt_pk_bf16_f32 v186, v24, v25
    v_cvt_pk_bf16_f32 v187, v26, v27
    buffer_store_dwordx4 v[184:187], v19, s[12:15], s40 offen offset:0 sc1
    v_pk_fma_f32 v[176:177], v[132:133], v[210:211], v[228:229]
    v_pk_fma_f32 v[178:179], v[134:135], v[210:211], v[230:231]
    v_pk_fma_f32 v[180:181], v[136:137], v[210:211], v[232:233]
    v_pk_fma_f32 v[182:183], v[138:139], v[210:211], v[234:235]
    v_pk_fma_f32 v[48:49], v[48:49], v[222:223], v[176:177]
    v_pk_fma_f32 v[50:51], v[50:51], v[222:223], v[178:179]
    v_pk_fma_f32 v[52:53], v[52:53], v[222:223], v[180:181]
    v_pk_fma_f32 v[54:55], v[54:55], v[222:223], v[182:183]
    v_pk_mul_f32 v[176:177], v[48:49], v[48:49]
    v_pk_mul_f32 v[178:179], v[50:51], v[50:51]
    v_pk_mul_f32 v[180:181], v[52:53], v[52:53]
    v_pk_mul_f32 v[182:183], v[54:55], v[54:55]
    v_pk_fma_f32 v[176:177], v[176:177], v[12:13], v[8:9]
    v_pk_fma_f32 v[178:179], v[178:179], v[12:13], v[8:9]
    v_pk_fma_f32 v[180:181], v[180:181], v[12:13], v[8:9]
    v_pk_fma_f32 v[182:183], v[182:183], v[12:13], v[8:9]
    v_pk_mul_f32 v[176:177], v[176:177], v[48:49]
    v_pk_mul_f32 v[178:179], v[178:179], v[50:51]
    v_pk_mul_f32 v[180:181], v[180:181], v[52:53]
    v_pk_mul_f32 v[182:183], v[182:183], v[54:55]
    v_exp_f32 v176, v176
    v_exp_f32 v177, v177
    v_exp_f32 v178, v178
    v_exp_f32 v179, v179
    v_exp_f32 v180, v180
    v_exp_f32 v181, v181
    v_exp_f32 v182, v182
    v_exp_f32 v183, v183
    v_pk_add_f32 v[176:177], v[176:177], v[216:217]
    v_pk_add_f32 v[178:179], v[178:179], v[216:217]
    v_pk_add_f32 v[180:181], v[180:181], v[216:217]
    v_pk_add_f32 v[182:183], v[182:183], v[216:217]
    v_rcp_f32 v176, v176
    v_rcp_f32 v177, v177
    v_rcp_f32 v178, v178
    v_rcp_f32 v179, v179
    v_rcp_f32 v180, v180
    v_rcp_f32 v181, v181
    v_rcp_f32 v182, v182
    v_rcp_f32 v183, v183
    v_pk_mul_f32 v[48:49], v[48:49], v[176:177]
    v_pk_mul_f32 v[50:51], v[50:51], v[178:179]
    v_pk_mul_f32 v[52:53], v[52:53], v[180:181]
    v_pk_mul_f32 v[54:55], v[54:55], v[182:183]
    v_cvt_pk_bf16_f32 v188, v48, v49
    v_cvt_pk_bf16_f32 v189, v50, v51
    v_cvt_pk_bf16_f32 v190, v52, v53
    v_cvt_pk_bf16_f32 v191, v54, v55
    buffer_store_dwordx4 v[188:191], v19, s[12:15], s40 offen offset:1024 sc1
    v_pk_fma_f32 v[176:177], v[132:133], v[212:213], v[228:229]
    v_pk_fma_f32 v[178:179], v[134:135], v[212:213], v[230:231]
    v_pk_fma_f32 v[180:181], v[136:137], v[212:213], v[232:233]
    v_pk_fma_f32 v[182:183], v[138:139], v[212:213], v[234:235]
    v_pk_fma_f32 v[76:77], v[76:77], v[224:225], v[176:177]
    v_pk_fma_f32 v[78:79], v[78:79], v[224:225], v[178:179]
    v_pk_fma_f32 v[80:81], v[80:81], v[224:225], v[180:181]
    v_pk_fma_f32 v[82:83], v[82:83], v[224:225], v[182:183]
    v_pk_mul_f32 v[176:177], v[76:77], v[76:77]
    v_pk_mul_f32 v[178:179], v[78:79], v[78:79]
    v_pk_mul_f32 v[180:181], v[80:81], v[80:81]
    v_pk_mul_f32 v[182:183], v[82:83], v[82:83]
    v_pk_fma_f32 v[176:177], v[176:177], v[12:13], v[8:9]
    v_pk_fma_f32 v[178:179], v[178:179], v[12:13], v[8:9]
    v_pk_fma_f32 v[180:181], v[180:181], v[12:13], v[8:9]
    v_pk_fma_f32 v[182:183], v[182:183], v[12:13], v[8:9]
    v_pk_mul_f32 v[176:177], v[176:177], v[76:77]
    v_pk_mul_f32 v[178:179], v[178:179], v[78:79]
    v_pk_mul_f32 v[180:181], v[180:181], v[80:81]
    v_pk_mul_f32 v[182:183], v[182:183], v[82:83]
    v_exp_f32 v176, v176
    v_exp_f32 v177, v177
    v_exp_f32 v178, v178
    v_exp_f32 v179, v179
    v_exp_f32 v180, v180
    v_exp_f32 v181, v181
    v_exp_f32 v182, v182
    v_exp_f32 v183, v183
    v_pk_add_f32 v[176:177], v[176:177], v[216:217]
    v_pk_add_f32 v[178:179], v[178:179], v[216:217]
    v_pk_add_f32 v[180:181], v[180:181], v[216:217]
    v_pk_add_f32 v[182:183], v[182:183], v[216:217]
    v_rcp_f32 v176, v176
    v_rcp_f32 v177, v177
    v_rcp_f32 v178, v178
    v_rcp_f32 v179, v179
    v_rcp_f32 v180, v180
    v_rcp_f32 v181, v181
    v_rcp_f32 v182, v182
    v_rcp_f32 v183, v183
    v_pk_mul_f32 v[76:77], v[76:77], v[176:177]
    v_pk_mul_f32 v[78:79], v[78:79], v[178:179]
    v_pk_mul_f32 v[80:81], v[80:81], v[180:181]
    v_pk_mul_f32 v[82:83], v[82:83], v[182:183]
    v_cvt_pk_bf16_f32 v192, v76, v77
    v_cvt_pk_bf16_f32 v193, v78, v79
    v_cvt_pk_bf16_f32 v194, v80, v81
    v_cvt_pk_bf16_f32 v195, v82, v83
    buffer_store_dwordx4 v[192:195], v19, s[12:15], s41 offen offset:0 sc1
    v_pk_fma_f32 v[176:177], v[132:133], v[214:215], v[228:229]
    v_pk_fma_f32 v[178:179], v[134:135], v[214:215], v[230:231]
    v_pk_fma_f32 v[180:181], v[136:137], v[214:215], v[232:233]
    v_pk_fma_f32 v[182:183], v[138:139], v[214:215], v[234:235]
    v_pk_fma_f32 v[104:105], v[104:105], v[226:227], v[176:177]
    v_pk_fma_f32 v[106:107], v[106:107], v[226:227], v[178:179]
    v_pk_fma_f32 v[108:109], v[108:109], v[226:227], v[180:181]
    v_pk_fma_f32 v[110:111], v[110:111], v[226:227], v[182:183]
    v_pk_mul_f32 v[176:177], v[104:105], v[104:105]
    v_pk_mul_f32 v[178:179], v[106:107], v[106:107]
    v_pk_mul_f32 v[180:181], v[108:109], v[108:109]
    v_pk_mul_f32 v[182:183], v[110:111], v[110:111]
    v_pk_fma_f32 v[176:177], v[176:177], v[12:13], v[8:9]
    v_pk_fma_f32 v[178:179], v[178:179], v[12:13], v[8:9]
    v_pk_fma_f32 v[180:181], v[180:181], v[12:13], v[8:9]
    v_pk_fma_f32 v[182:183], v[182:183], v[12:13], v[8:9]
    v_pk_mul_f32 v[176:177], v[176:177], v[104:105]
    v_pk_mul_f32 v[178:179], v[178:179], v[106:107]
    v_pk_mul_f32 v[180:181], v[180:181], v[108:109]
    v_pk_mul_f32 v[182:183], v[182:183], v[110:111]
    v_exp_f32 v176, v176
    v_exp_f32 v177, v177
    v_exp_f32 v178, v178
    v_exp_f32 v179, v179
    v_exp_f32 v180, v180
    v_exp_f32 v181, v181
    v_exp_f32 v182, v182
    v_exp_f32 v183, v183
    v_pk_add_f32 v[176:177], v[176:177], v[216:217]
    v_pk_add_f32 v[178:179], v[178:179], v[216:217]
    v_pk_add_f32 v[180:181], v[180:181], v[216:217]
    v_pk_add_f32 v[182:183], v[182:183], v[216:217]
    v_rcp_f32 v176, v176
    v_rcp_f32 v177, v177
    v_rcp_f32 v178, v178
    v_rcp_f32 v179, v179
    v_rcp_f32 v180, v180
    v_rcp_f32 v181, v181
    v_rcp_f32 v182, v182
    v_rcp_f32 v183, v183
    v_pk_mul_f32 v[104:105], v[104:105], v[176:177]
    v_pk_mul_f32 v[106:107], v[106:107], v[178:179]
    v_pk_mul_f32 v[108:109], v[108:109], v[180:181]
    v_pk_mul_f32 v[110:111], v[110:111], v[182:183]
    v_cvt_pk_bf16_f32 v196, v104, v105
    v_cvt_pk_bf16_f32 v197, v106, v107
    v_cvt_pk_bf16_f32 v198, v108, v109
    v_cvt_pk_bf16_f32 v199, v110, v111
    buffer_store_dwordx4 v[196:199], v19, s[12:15], s41 offen offset:1024 sc1
    s_add_u32 s40, s40, 0x20000
    s_add_u32 s41, s41, 0x20000
    v_pk_fma_f32 v[176:177], v[140:141], v[208:209], v[236:237]
    v_pk_fma_f32 v[178:179], v[142:143], v[208:209], v[238:239]
    v_pk_fma_f32 v[180:181], v[144:145], v[208:209], v[240:241]
    v_pk_fma_f32 v[182:183], v[146:147], v[208:209], v[242:243]
    v_pk_fma_f32 v[28:29], v[28:29], v[220:221], v[176:177]
    v_pk_fma_f32 v[30:31], v[30:31], v[220:221], v[178:179]
    v_pk_fma_f32 v[32:33], v[32:33], v[220:221], v[180:181]
    v_pk_fma_f32 v[34:35], v[34:35], v[220:221], v[182:183]
    v_pk_mul_f32 v[176:177], v[28:29], v[28:29]
    v_pk_mul_f32 v[178:179], v[30:31], v[30:31]
    v_pk_mul_f32 v[180:181], v[32:33], v[32:33]
    v_pk_mul_f32 v[182:183], v[34:35], v[34:35]
    v_pk_fma_f32 v[176:177], v[176:177], v[12:13], v[8:9]
    v_pk_fma_f32 v[178:179], v[178:179], v[12:13], v[8:9]
    v_pk_fma_f32 v[180:181], v[180:181], v[12:13], v[8:9]
    v_pk_fma_f32 v[182:183], v[182:183], v[12:13], v[8:9]
    v_pk_mul_f32 v[176:177], v[176:177], v[28:29]
    v_pk_mul_f32 v[178:179], v[178:179], v[30:31]
    v_pk_mul_f32 v[180:181], v[180:181], v[32:33]
    v_pk_mul_f32 v[182:183], v[182:183], v[34:35]
    v_exp_f32 v176, v176
    v_exp_f32 v177, v177
    v_exp_f32 v178, v178
    v_exp_f32 v179, v179
    v_exp_f32 v180, v180
    v_exp_f32 v181, v181
    v_exp_f32 v182, v182
    v_exp_f32 v183, v183
    v_pk_add_f32 v[176:177], v[176:177], v[216:217]
    v_pk_add_f32 v[178:179], v[178:179], v[216:217]
    v_pk_add_f32 v[180:181], v[180:181], v[216:217]
    v_pk_add_f32 v[182:183], v[182:183], v[216:217]
    v_rcp_f32 v176, v176
    v_rcp_f32 v177, v177
    v_rcp_f32 v178, v178
    v_rcp_f32 v179, v179
    v_rcp_f32 v180, v180
    v_rcp_f32 v181, v181
    v_rcp_f32 v182, v182
    v_rcp_f32 v183, v183
    v_pk_mul_f32 v[28:29], v[28:29], v[176:177]
    v_pk_mul_f32 v[30:31], v[30:31], v[178:179]
    v_pk_mul_f32 v[32:33], v[32:33], v[180:181]
    v_pk_mul_f32 v[34:35], v[34:35], v[182:183]
    v_cvt_pk_bf16_f32 v200, v28, v29
    v_cvt_pk_bf16_f32 v201, v30, v31
    v_cvt_pk_bf16_f32 v202, v32, v33
    v_cvt_pk_bf16_f32 v203, v34, v35
    buffer_store_dwordx4 v[200:203], v19, s[12:15], s40 offen offset:0 sc1
    v_pk_fma_f32 v[176:177], v[140:141], v[210:211], v[236:237]
    v_pk_fma_f32 v[178:179], v[142:143], v[210:211], v[238:239]
    v_pk_fma_f32 v[180:181], v[144:145], v[210:211], v[240:241]
    v_pk_fma_f32 v[182:183], v[146:147], v[210:211], v[242:243]
    v_pk_fma_f32 v[56:57], v[56:57], v[222:223], v[176:177]
    v_pk_fma_f32 v[58:59], v[58:59], v[222:223], v[178:179]
    v_pk_fma_f32 v[60:61], v[60:61], v[222:223], v[180:181]
    v_pk_fma_f32 v[62:63], v[62:63], v[222:223], v[182:183]
    v_pk_mul_f32 v[176:177], v[56:57], v[56:57]
    v_pk_mul_f32 v[178:179], v[58:59], v[58:59]
    v_pk_mul_f32 v[180:181], v[60:61], v[60:61]
    v_pk_mul_f32 v[182:183], v[62:63], v[62:63]
    v_pk_fma_f32 v[176:177], v[176:177], v[12:13], v[8:9]
    v_pk_fma_f32 v[178:179], v[178:179], v[12:13], v[8:9]
    v_pk_fma_f32 v[180:181], v[180:181], v[12:13], v[8:9]
    v_pk_fma_f32 v[182:183], v[182:183], v[12:13], v[8:9]
    v_pk_mul_f32 v[176:177], v[176:177], v[56:57]
    v_pk_mul_f32 v[178:179], v[178:179], v[58:59]
    v_pk_mul_f32 v[180:181], v[180:181], v[60:61]
    v_pk_mul_f32 v[182:183], v[182:183], v[62:63]
    v_exp_f32 v176, v176
    v_exp_f32 v177, v177
    v_exp_f32 v178, v178
    v_exp_f32 v179, v179
    v_exp_f32 v180, v180
    v_exp_f32 v181, v181
    v_exp_f32 v182, v182
    v_exp_f32 v183, v183
    v_pk_add_f32 v[176:177], v[176:177], v[216:217]
    v_pk_add_f32 v[178:179], v[178:179], v[216:217]
    v_pk_add_f32 v[180:181], v[180:181], v[216:217]
    v_pk_add_f32 v[182:183], v[182:183], v[216:217]
    v_rcp_f32 v176, v176
    v_rcp_f32 v177, v177
    v_rcp_f32 v178, v178
    v_rcp_f32 v179, v179
    v_rcp_f32 v180, v180
    v_rcp_f32 v181, v181
    v_rcp_f32 v182, v182
    v_rcp_f32 v183, v183
    v_pk_mul_f32 v[56:57], v[56:57], v[176:177]
    v_pk_mul_f32 v[58:59], v[58:59], v[178:179]
    v_pk_mul_f32 v[60:61], v[60:61], v[180:181]
    v_pk_mul_f32 v[62:63], v[62:63], v[182:183]
    v_cvt_pk_bf16_f32 v204, v56, v57
    v_cvt_pk_bf16_f32 v205, v58, v59
    v_cvt_pk_bf16_f32 v206, v60, v61
    v_cvt_pk_bf16_f32 v207, v62, v63
    buffer_store_dwordx4 v[204:207], v19, s[12:15], s40 offen offset:1024 sc1
    v_pk_fma_f32 v[176:177], v[140:141], v[212:213], v[236:237]
    v_pk_fma_f32 v[178:179], v[142:143], v[212:213], v[238:239]
    v_pk_fma_f32 v[180:181], v[144:145], v[212:213], v[240:241]
    v_pk_fma_f32 v[182:183], v[146:147], v[212:213], v[242:243]
    v_pk_fma_f32 v[84:85], v[84:85], v[224:225], v[176:177]
    v_pk_fma_f32 v[86:87], v[86:87], v[224:225], v[178:179]
    v_pk_fma_f32 v[88:89], v[88:89], v[224:225], v[180:181]
    v_pk_fma_f32 v[90:91], v[90:91], v[224:225], v[182:183]
    v_pk_mul_f32 v[176:177], v[84:85], v[84:85]
    v_pk_mul_f32 v[178:179], v[86:87], v[86:87]
    v_pk_mul_f32 v[180:181], v[88:89], v[88:89]
    v_pk_mul_f32 v[182:183], v[90:91], v[90:91]
    v_pk_fma_f32 v[176:177], v[176:177], v[12:13], v[8:9]
    v_pk_fma_f32 v[178:179], v[178:179], v[12:13], v[8:9]
    v_pk_fma_f32 v[180:181], v[180:181], v[12:13], v[8:9]
    v_pk_fma_f32 v[182:183], v[182:183], v[12:13], v[8:9]
    v_pk_mul_f32 v[176:177], v[176:177], v[84:85]
    v_pk_mul_f32 v[178:179], v[178:179], v[86:87]
    v_pk_mul_f32 v[180:181], v[180:181], v[88:89]
    v_pk_mul_f32 v[182:183], v[182:183], v[90:91]
    v_exp_f32 v176, v176
    v_exp_f32 v177, v177
    v_exp_f32 v178, v178
    v_exp_f32 v179, v179
    v_exp_f32 v180, v180
    v_exp_f32 v181, v181
    v_exp_f32 v182, v182
    v_exp_f32 v183, v183
    v_pk_add_f32 v[176:177], v[176:177], v[216:217]
    v_pk_add_f32 v[178:179], v[178:179], v[216:217]
    v_pk_add_f32 v[180:181], v[180:181], v[216:217]
    v_pk_add_f32 v[182:183], v[182:183], v[216:217]
    v_rcp_f32 v176, v176
    v_rcp_f32 v177, v177
    v_rcp_f32 v178, v178
    v_rcp_f32 v179, v179
    v_rcp_f32 v180, v180
    v_rcp_f32 v181, v181
    v_rcp_f32 v182, v182
    v_rcp_f32 v183, v183
    v_pk_mul_f32 v[84:85], v[84:85], v[176:177]
    v_pk_mul_f32 v[86:87], v[86:87], v[178:179]
    v_pk_mul_f32 v[88:89], v[88:89], v[180:181]
    v_pk_mul_f32 v[90:91], v[90:91], v[182:183]
    v_cvt_pk_bf16_f32 v184, v84, v85
    v_cvt_pk_bf16_f32 v185, v86, v87
    v_cvt_pk_bf16_f32 v186, v88, v89
    v_cvt_pk_bf16_f32 v187, v90, v91
    buffer_store_dwordx4 v[184:187], v19, s[12:15], s41 offen offset:0 sc1
    v_pk_fma_f32 v[176:177], v[140:141], v[214:215], v[236:237]
    v_pk_fma_f32 v[178:179], v[142:143], v[214:215], v[238:239]
    v_pk_fma_f32 v[180:181], v[144:145], v[214:215], v[240:241]
    v_pk_fma_f32 v[182:183], v[146:147], v[214:215], v[242:243]
    v_pk_fma_f32 v[112:113], v[112:113], v[226:227], v[176:177]
    v_pk_fma_f32 v[114:115], v[114:115], v[226:227], v[178:179]
    v_pk_fma_f32 v[116:117], v[116:117], v[226:227], v[180:181]
    v_pk_fma_f32 v[118:119], v[118:119], v[226:227], v[182:183]
    v_pk_mul_f32 v[176:177], v[112:113], v[112:113]
    v_pk_mul_f32 v[178:179], v[114:115], v[114:115]
    v_pk_mul_f32 v[180:181], v[116:117], v[116:117]
    v_pk_mul_f32 v[182:183], v[118:119], v[118:119]
    v_pk_fma_f32 v[176:177], v[176:177], v[12:13], v[8:9]
    v_pk_fma_f32 v[178:179], v[178:179], v[12:13], v[8:9]
    v_pk_fma_f32 v[180:181], v[180:181], v[12:13], v[8:9]
    v_pk_fma_f32 v[182:183], v[182:183], v[12:13], v[8:9]
    v_pk_mul_f32 v[176:177], v[176:177], v[112:113]
    v_pk_mul_f32 v[178:179], v[178:179], v[114:115]
    v_pk_mul_f32 v[180:181], v[180:181], v[116:117]
    v_pk_mul_f32 v[182:183], v[182:183], v[118:119]
    v_exp_f32 v176, v176
    v_exp_f32 v177, v177
    v_exp_f32 v178, v178
    v_exp_f32 v179, v179
    v_exp_f32 v180, v180
    v_exp_f32 v181, v181
    v_exp_f32 v182, v182
    v_exp_f32 v183, v183
    v_pk_add_f32 v[176:177], v[176:177], v[216:217]
    v_pk_add_f32 v[178:179], v[178:179], v[216:217]
    v_pk_add_f32 v[180:181], v[180:181], v[216:217]
    v_pk_add_f32 v[182:183], v[182:183], v[216:217]
    v_rcp_f32 v176, v176
    v_rcp_f32 v177, v177
    v_rcp_f32 v178, v178
    v_rcp_f32 v179, v179
    v_rcp_f32 v180, v180
    v_rcp_f32 v181, v181
    v_rcp_f32 v182, v182
    v_rcp_f32 v183, v183
    v_pk_mul_f32 v[112:113], v[112:113], v[176:177]
    v_pk_mul_f32 v[114:115], v[114:115], v[178:179]
    v_pk_mul_f32 v[116:117], v[116:117], v[180:181]
    v_pk_mul_f32 v[118:119], v[118:119], v[182:183]
    v_cvt_pk_bf16_f32 v188, v112, v113
    v_cvt_pk_bf16_f32 v189, v114, v115
    v_cvt_pk_bf16_f32 v190, v116, v117
    v_cvt_pk_bf16_f32 v191, v118, v119
    buffer_store_dwordx4 v[188:191], v19, s[12:15], s41 offen offset:1024 sc1
    s_add_u32 s40, s40, 0x20000
    s_add_u32 s41, s41, 0x20000
    v_pk_fma_f32 v[176:177], v[148:149], v[208:209], v[244:245]
    v_pk_fma_f32 v[178:179], v[150:151], v[208:209], v[246:247]
    v_pk_fma_f32 v[180:181], v[152:153], v[208:209], v[248:249]
    v_pk_fma_f32 v[182:183], v[154:155], v[208:209], v[250:251]
    v_pk_fma_f32 v[36:37], v[36:37], v[220:221], v[176:177]
    v_pk_fma_f32 v[38:39], v[38:39], v[220:221], v[178:179]
    v_pk_fma_f32 v[40:41], v[40:41], v[220:221], v[180:181]
    v_pk_fma_f32 v[42:43], v[42:43], v[220:221], v[182:183]
    v_pk_mul_f32 v[176:177], v[36:37], v[36:37]
    v_pk_mul_f32 v[178:179], v[38:39], v[38:39]
    v_pk_mul_f32 v[180:181], v[40:41], v[40:41]
    v_pk_mul_f32 v[182:183], v[42:43], v[42:43]
    v_pk_fma_f32 v[176:177], v[176:177], v[12:13], v[8:9]
    v_pk_fma_f32 v[178:179], v[178:179], v[12:13], v[8:9]
    v_pk_fma_f32 v[180:181], v[180:181], v[12:13], v[8:9]
    v_pk_fma_f32 v[182:183], v[182:183], v[12:13], v[8:9]
    v_pk_mul_f32 v[176:177], v[176:177], v[36:37]
    v_pk_mul_f32 v[178:179], v[178:179], v[38:39]
    v_pk_mul_f32 v[180:181], v[180:181], v[40:41]
    v_pk_mul_f32 v[182:183], v[182:183], v[42:43]
    v_exp_f32 v176, v176
    v_exp_f32 v177, v177
    v_exp_f32 v178, v178
    v_exp_f32 v179, v179
    v_exp_f32 v180, v180
    v_exp_f32 v181, v181
    v_exp_f32 v182, v182
    v_exp_f32 v183, v183
    v_pk_add_f32 v[176:177], v[176:177], v[216:217]
    v_pk_add_f32 v[178:179], v[178:179], v[216:217]
    v_pk_add_f32 v[180:181], v[180:181], v[216:217]
    v_pk_add_f32 v[182:183], v[182:183], v[216:217]
    v_rcp_f32 v176, v176
    v_rcp_f32 v177, v177
    v_rcp_f32 v178, v178
    v_rcp_f32 v179, v179
    v_rcp_f32 v180, v180
    v_rcp_f32 v181, v181
    v_rcp_f32 v182, v182
    v_rcp_f32 v183, v183
    v_pk_mul_f32 v[36:37], v[36:37], v[176:177]
    v_pk_mul_f32 v[38:39], v[38:39], v[178:179]
    v_pk_mul_f32 v[40:41], v[40:41], v[180:181]
    v_pk_mul_f32 v[42:43], v[42:43], v[182:183]
    v_cvt_pk_bf16_f32 v192, v36, v37
    v_cvt_pk_bf16_f32 v193, v38, v39
    v_cvt_pk_bf16_f32 v194, v40, v41
    v_cvt_pk_bf16_f32 v195, v42, v43
    buffer_store_dwordx4 v[192:195], v19, s[12:15], s40 offen offset:0 sc1
    v_pk_fma_f32 v[176:177], v[148:149], v[210:211], v[244:245]
    v_pk_fma_f32 v[178:179], v[150:151], v[210:211], v[246:247]
    v_pk_fma_f32 v[180:181], v[152:153], v[210:211], v[248:249]
    v_pk_fma_f32 v[182:183], v[154:155], v[210:211], v[250:251]
    v_pk_fma_f32 v[64:65], v[64:65], v[222:223], v[176:177]
    v_pk_fma_f32 v[66:67], v[66:67], v[222:223], v[178:179]
    v_pk_fma_f32 v[68:69], v[68:69], v[222:223], v[180:181]
    v_pk_fma_f32 v[70:71], v[70:71], v[222:223], v[182:183]
    v_pk_mul_f32 v[176:177], v[64:65], v[64:65]
    v_pk_mul_f32 v[178:179], v[66:67], v[66:67]
    v_pk_mul_f32 v[180:181], v[68:69], v[68:69]
    v_pk_mul_f32 v[182:183], v[70:71], v[70:71]
    v_pk_fma_f32 v[176:177], v[176:177], v[12:13], v[8:9]
    v_pk_fma_f32 v[178:179], v[178:179], v[12:13], v[8:9]
    v_pk_fma_f32 v[180:181], v[180:181], v[12:13], v[8:9]
    v_pk_fma_f32 v[182:183], v[182:183], v[12:13], v[8:9]
    v_pk_mul_f32 v[176:177], v[176:177], v[64:65]
    v_pk_mul_f32 v[178:179], v[178:179], v[66:67]
    v_pk_mul_f32 v[180:181], v[180:181], v[68:69]
    v_pk_mul_f32 v[182:183], v[182:183], v[70:71]
    v_exp_f32 v176, v176
    v_exp_f32 v177, v177
    v_exp_f32 v178, v178
    v_exp_f32 v179, v179
    v_exp_f32 v180, v180
    v_exp_f32 v181, v181
    v_exp_f32 v182, v182
    v_exp_f32 v183, v183
    v_pk_add_f32 v[176:177], v[176:177], v[216:217]
    v_pk_add_f32 v[178:179], v[178:179], v[216:217]
    v_pk_add_f32 v[180:181], v[180:181], v[216:217]
    v_pk_add_f32 v[182:183], v[182:183], v[216:217]
    v_rcp_f32 v176, v176
    v_rcp_f32 v177, v177
    v_rcp_f32 v178, v178
    v_rcp_f32 v179, v179
    v_rcp_f32 v180, v180
    v_rcp_f32 v181, v181
    v_rcp_f32 v182, v182
    v_rcp_f32 v183, v183
    v_pk_mul_f32 v[64:65], v[64:65], v[176:177]
    v_pk_mul_f32 v[66:67], v[66:67], v[178:179]
    v_pk_mul_f32 v[68:69], v[68:69], v[180:181]
    v_pk_mul_f32 v[70:71], v[70:71], v[182:183]
    v_cvt_pk_bf16_f32 v196, v64, v65
    v_cvt_pk_bf16_f32 v197, v66, v67
    v_cvt_pk_bf16_f32 v198, v68, v69
    v_cvt_pk_bf16_f32 v199, v70, v71
    buffer_store_dwordx4 v[196:199], v19, s[12:15], s40 offen offset:1024 sc1
    v_pk_fma_f32 v[176:177], v[148:149], v[212:213], v[244:245]
    v_pk_fma_f32 v[178:179], v[150:151], v[212:213], v[246:247]
    v_pk_fma_f32 v[180:181], v[152:153], v[212:213], v[248:249]
    v_pk_fma_f32 v[182:183], v[154:155], v[212:213], v[250:251]
    v_pk_fma_f32 v[92:93], v[92:93], v[224:225], v[176:177]
    v_pk_fma_f32 v[94:95], v[94:95], v[224:225], v[178:179]
    v_pk_fma_f32 v[96:97], v[96:97], v[224:225], v[180:181]
    v_pk_fma_f32 v[98:99], v[98:99], v[224:225], v[182:183]
    v_pk_mul_f32 v[176:177], v[92:93], v[92:93]
    v_pk_mul_f32 v[178:179], v[94:95], v[94:95]
    v_pk_mul_f32 v[180:181], v[96:97], v[96:97]
    v_pk_mul_f32 v[182:183], v[98:99], v[98:99]
    v_pk_fma_f32 v[176:177], v[176:177], v[12:13], v[8:9]
    v_pk_fma_f32 v[178:179], v[178:179], v[12:13], v[8:9]
    v_pk_fma_f32 v[180:181], v[180:181], v[12:13], v[8:9]
    v_pk_fma_f32 v[182:183], v[182:183], v[12:13], v[8:9]
    v_pk_mul_f32 v[176:177], v[176:177], v[92:93]
    v_pk_mul_f32 v[178:179], v[178:179], v[94:95]
    v_pk_mul_f32 v[180:181], v[180:181], v[96:97]
    v_pk_mul_f32 v[182:183], v[182:183], v[98:99]
    v_exp_f32 v176, v176
    v_exp_f32 v177, v177
    v_exp_f32 v178, v178
    v_exp_f32 v179, v179
    v_exp_f32 v180, v180
    v_exp_f32 v181, v181
    v_exp_f32 v182, v182
    v_exp_f32 v183, v183
    v_pk_add_f32 v[176:177], v[176:177], v[216:217]
    v_pk_add_f32 v[178:179], v[178:179], v[216:217]
    v_pk_add_f32 v[180:181], v[180:181], v[216:217]
    v_pk_add_f32 v[182:183], v[182:183], v[216:217]
    v_rcp_f32 v176, v176
    v_rcp_f32 v177, v177
    v_rcp_f32 v178, v178
    v_rcp_f32 v179, v179
    v_rcp_f32 v180, v180
    v_rcp_f32 v181, v181
    v_rcp_f32 v182, v182
    v_rcp_f32 v183, v183
    v_pk_mul_f32 v[92:93], v[92:93], v[176:177]
    v_pk_mul_f32 v[94:95], v[94:95], v[178:179]
    v_pk_mul_f32 v[96:97], v[96:97], v[180:181]
    v_pk_mul_f32 v[98:99], v[98:99], v[182:183]
    v_cvt_pk_bf16_f32 v200, v92, v93
    v_cvt_pk_bf16_f32 v201, v94, v95
    v_cvt_pk_bf16_f32 v202, v96, v97
    v_cvt_pk_bf16_f32 v203, v98, v99
    buffer_store_dwordx4 v[200:203], v19, s[12:15], s41 offen offset:0 sc1
    v_pk_fma_f32 v[176:177], v[148:149], v[214:215], v[244:245]
    v_pk_fma_f32 v[178:179], v[150:151], v[214:215], v[246:247]
    v_pk_fma_f32 v[180:181], v[152:153], v[214:215], v[248:249]
    v_pk_fma_f32 v[182:183], v[154:155], v[214:215], v[250:251]
    v_pk_fma_f32 v[120:121], v[120:121], v[226:227], v[176:177]
    v_pk_fma_f32 v[122:123], v[122:123], v[226:227], v[178:179]
    v_pk_fma_f32 v[124:125], v[124:125], v[226:227], v[180:181]
    v_pk_fma_f32 v[126:127], v[126:127], v[226:227], v[182:183]
    v_pk_mul_f32 v[176:177], v[120:121], v[120:121]
    v_pk_mul_f32 v[178:179], v[122:123], v[122:123]
    v_pk_mul_f32 v[180:181], v[124:125], v[124:125]
    v_pk_mul_f32 v[182:183], v[126:127], v[126:127]
    v_pk_fma_f32 v[176:177], v[176:177], v[12:13], v[8:9]
    v_pk_fma_f32 v[178:179], v[178:179], v[12:13], v[8:9]
    v_pk_fma_f32 v[180:181], v[180:181], v[12:13], v[8:9]
    v_pk_fma_f32 v[182:183], v[182:183], v[12:13], v[8:9]
    v_pk_mul_f32 v[176:177], v[176:177], v[120:121]
    v_pk_mul_f32 v[178:179], v[178:179], v[122:123]
    v_pk_mul_f32 v[180:181], v[180:181], v[124:125]
    v_pk_mul_f32 v[182:183], v[182:183], v[126:127]
    v_exp_f32 v176, v176
    v_exp_f32 v177, v177
    v_exp_f32 v178, v178
    v_exp_f32 v179, v179
    v_exp_f32 v180, v180
    v_exp_f32 v181, v181
    v_exp_f32 v182, v182
    v_exp_f32 v183, v183
    v_pk_add_f32 v[176:177], v[176:177], v[216:217]
    v_pk_add_f32 v[178:179], v[178:179], v[216:217]
    v_pk_add_f32 v[180:181], v[180:181], v[216:217]
    v_pk_add_f32 v[182:183], v[182:183], v[216:217]
    v_rcp_f32 v176, v176
    v_rcp_f32 v177, v177
    v_rcp_f32 v178, v178
    v_rcp_f32 v179, v179
    v_rcp_f32 v180, v180
    v_rcp_f32 v181, v181
    v_rcp_f32 v182, v182
    v_rcp_f32 v183, v183
    v_pk_mul_f32 v[120:121], v[120:121], v[176:177]
    v_pk_mul_f32 v[122:123], v[122:123], v[178:179]
    v_pk_mul_f32 v[124:125], v[124:125], v[180:181]
    v_pk_mul_f32 v[126:127], v[126:127], v[182:183]
    v_cvt_pk_bf16_f32 v204, v120, v121
    v_cvt_pk_bf16_f32 v205, v122, v123
    v_cvt_pk_bf16_f32 v206, v124, v125
    v_cvt_pk_bf16_f32 v207, v126, v127
    buffer_store_dwordx4 v[204:207], v19, s[12:15], s41 offen offset:1024 sc1
    v_pk_fma_f32 v[176:177], v[156:157], v[208:209], v[252:253]
    v_pk_fma_f32 v[178:179], v[158:159], v[208:209], v[254:255]
    v_pk_fma_f32 v[180:181], v[156:157], v[210:211], v[252:253]
    v_pk_fma_f32 v[182:183], v[158:159], v[210:211], v[254:255]
    v_pk_fma_f32 v[44:45], v[44:45], v[220:221], v[176:177]
    v_pk_fma_f32 v[46:47], v[46:47], v[220:221], v[178:179]
    v_pk_fma_f32 v[72:73], v[72:73], v[222:223], v[180:181]
    v_pk_fma_f32 v[74:75], v[74:75], v[222:223], v[182:183]
    v_pk_mul_f32 v[176:177], v[44:45], v[44:45]
    v_pk_mul_f32 v[178:179], v[46:47], v[46:47]
    v_pk_mul_f32 v[180:181], v[72:73], v[72:73]
    v_pk_mul_f32 v[182:183], v[74:75], v[74:75]
    v_pk_fma_f32 v[176:177], v[176:177], v[12:13], v[8:9]
    v_pk_fma_f32 v[178:179], v[178:179], v[12:13], v[8:9]
    v_pk_fma_f32 v[180:181], v[180:181], v[12:13], v[8:9]
    v_pk_fma_f32 v[182:183], v[182:183], v[12:13], v[8:9]
    v_pk_mul_f32 v[176:177], v[176:177], v[44:45]
    v_pk_mul_f32 v[178:179], v[178:179], v[46:47]
    v_pk_mul_f32 v[180:181], v[180:181], v[72:73]
    v_pk_mul_f32 v[182:183], v[182:183], v[74:75]
    v_exp_f32 v176, v176
    v_exp_f32 v177, v177
    v_exp_f32 v178, v178
    v_exp_f32 v179, v179
    v_exp_f32 v180, v180
    v_exp_f32 v181, v181
    v_exp_f32 v182, v182
    v_exp_f32 v183, v183
    v_pk_add_f32 v[176:177], v[176:177], v[216:217]
    v_pk_add_f32 v[178:179], v[178:179], v[216:217]
    v_pk_add_f32 v[180:181], v[180:181], v[216:217]
    v_pk_add_f32 v[182:183], v[182:183], v[216:217]
    v_rcp_f32 v176, v176
    v_rcp_f32 v177, v177
    v_rcp_f32 v178, v178
    v_rcp_f32 v179, v179
    v_rcp_f32 v180, v180
    v_rcp_f32 v181, v181
    v_rcp_f32 v182, v182
    v_rcp_f32 v183, v183
    v_pk_mul_f32 v[44:45], v[44:45], v[176:177]
    v_pk_mul_f32 v[46:47], v[46:47], v[178:179]
    v_pk_mul_f32 v[72:73], v[72:73], v[180:181]
    v_pk_mul_f32 v[74:75], v[74:75], v[182:183]
    v_cvt_pk_bf16_f32 v184, v44, v45
    v_cvt_pk_bf16_f32 v185, v46, v47
    v_cvt_pk_bf16_f32 v186, v72, v73
    v_cvt_pk_bf16_f32 v187, v74, v75
    s_nop 1
    v_permlane16_swap_b32 v184, v186
    v_permlane16_swap_b32 v185, v187
    buffer_store_dwordx4 v[184:187], v10, s[12:15], s42 offen sc1
    v_pk_fma_f32 v[176:177], v[156:157], v[212:213], v[252:253]
    v_pk_fma_f32 v[178:179], v[158:159], v[212:213], v[254:255]
    v_pk_fma_f32 v[180:181], v[156:157], v[214:215], v[252:253]
    v_pk_fma_f32 v[182:183], v[158:159], v[214:215], v[254:255]
    v_pk_fma_f32 v[100:101], v[100:101], v[224:225], v[176:177]
    v_pk_fma_f32 v[102:103], v[102:103], v[224:225], v[178:179]
    v_pk_fma_f32 v[128:129], v[128:129], v[226:227], v[180:181]
    v_pk_fma_f32 v[130:131], v[130:131], v[226:227], v[182:183]
    v_pk_mul_f32 v[176:177], v[100:101], v[100:101]
    v_pk_mul_f32 v[178:179], v[102:103], v[102:103]
    v_pk_mul_f32 v[180:181], v[128:129], v[128:129]
    v_pk_mul_f32 v[182:183], v[130:131], v[130:131]
    v_pk_fma_f32 v[176:177], v[176:177], v[12:13], v[8:9]
    v_pk_fma_f32 v[178:179], v[178:179], v[12:13], v[8:9]
    v_pk_fma_f32 v[180:181], v[180:181], v[12:13], v[8:9]
    v_pk_fma_f32 v[182:183], v[182:183], v[12:13], v[8:9]
    v_pk_mul_f32 v[176:177], v[176:177], v[100:101]
    v_pk_mul_f32 v[178:179], v[178:179], v[102:103]
    v_pk_mul_f32 v[180:181], v[180:181], v[128:129]
    v_pk_mul_f32 v[182:183], v[182:183], v[130:131]
    v_exp_f32 v176, v176
    v_exp_f32 v177, v177
    v_exp_f32 v178, v178
    v_exp_f32 v179, v179
    v_exp_f32 v180, v180
    v_exp_f32 v181, v181
    v_exp_f32 v182, v182
    v_exp_f32 v183, v183
    v_pk_add_f32 v[176:177], v[176:177], v[216:217]
    v_pk_add_f32 v[178:179], v[178:179], v[216:217]
    v_pk_add_f32 v[180:181], v[180:181], v[216:217]
    v_pk_add_f32 v[182:183], v[182:183], v[216:217]
    v_rcp_f32 v176, v176
    v_rcp_f32 v177, v177
    v_rcp_f32 v178, v178
    v_rcp_f32 v179, v179
    v_rcp_f32 v180, v180
    v_rcp_f32 v181, v181
    v_rcp_f32 v182, v182
    v_rcp_f32 v183, v183
    v_pk_mul_f32 v[100:101], v[100:101], v[176:177]
    v_pk_mul_f32 v[102:103], v[102:103], v[178:179]
    v_pk_mul_f32 v[128:129], v[128:129], v[180:181]
    v_pk_mul_f32 v[130:131], v[130:131], v[182:183]
    v_cvt_pk_bf16_f32 v188, v100, v101
    v_cvt_pk_bf16_f32 v189, v102, v103
    v_cvt_pk_bf16_f32 v190, v128, v129
    v_cvt_pk_bf16_f32 v191, v130, v131
    s_nop 1
    v_permlane16_swap_b32 v188, v190
    v_permlane16_swap_b32 v189, v191
    buffer_store_dwordx4 v[188:191], v10, s[12:15], s43 offen sc1
    s_lshl_b32 s27, s29, 11
    s_add_u32 s27, s27, 16448
    s_lshr_b32 s26, s30, 2
    s_lshl_b32 s26, s26, 7
    s_add_u32 s26, s26, 256
    v_mov_b32 v22, 0
    s_cmp_lt_u32 s28, 4
    s_cbranch_scc1 L_g2_p0
    s_sub_u32 s35, s28, 4
    s_lshr_b32 s56, s35, 1
    s_lshl_b32 s56, s56, 17
    s_lshl_b32 s34, s29, 14
    s_add_u32 s56, s56, s34
    s_and_b32 s34, s30, 4
    s_lshl_b32 s34, s34, 11
    s_add_u32 s56, s56, s34
    s_and_b32 s34, s35, 1
    s_lshl_b32 s34, s34, 12
    s_add_u32 s56, s56, s34
    v_lshrrev_b32 v25, 3, v1
    v_lshlrev_b32 v25, 11, v25
    v_bfe_u32 v21, v1, 4, 2
    v_lshlrev_b32 v21, 1, v21
    v_and_b32 v23, 7, v1
    v_xor_b32 v21, v21, v23
    v_lshl_add_u32 v25, v21, 4, v25
    s_lshl_b32 s34, s35, 15
    s_and_b32 s57, s30, 8
    s_lshl_b32 s57, s57, 7
    s_add_u32 s34, s34, s57
    s_and_b32 s57, s30, 3
    s_lshl_b32 s57, s57, 8
    s_add_u32 s34, s34, s57
    v_add_u32 v24, s34, v25
    v_add_u32 v25, 128, v24
    v_add_u32 v26, 14336, v24
    v_add_u32 v27, 14464, v24
    s_lshr_b32 s34, s30, 2
    s_mul_i32 s34, s34, 14
    s_mul_i32 s57, s31, 36
    s_add_u32 s57, s57, s34
    s_cmp_ge_u32 s57, 56
    s_cselect_b32 s34, 56, 0
    s_sub_u32 s57, s57, s34
    s_add_u32 s59, s56, 0xe00000
    s_lshl_b32 s34, s57, 18
    s_add_u32 s56, s56, s34
    s_lshl_b32 s57, s57, 17
    s_lshl_b32 s35, s35, 12
    s_mov_b32 s8, s90
    s_mov_b32 s9, s91
    s_mov_b32 s10, 0x700000
    s_mov_b32 s11, 0x00020000
    s_mov_b32 s58, 0xe00000
    s_add_u32 m0, s35, 16384
    s_nop 0
    buffer_load_dwordx4 v24, s[8:11], s57 offen offset:0 lds
    buffer_load_dwordx4 v26, s[8:11], s57 offen offset:2048 lds
    s_add_u32 m0, s35, 17408
    s_nop 0
    buffer_load_dwordx4 v25, s[8:11], s57 offen offset:0 lds
    buffer_load_dwordx4 v27, s[8:11], s57 offen offset:2048 lds
    s_add_u32 s57, s57, 0x20000
    s_cmp_eq_u32 s57, 0x700000
    s_cselect_b32 s57, 0, s57
    s_add_u32 m0, s35, 81920
    s_nop 0
    buffer_load_dwordx4 v24, s[8:11], s57 offen offset:0 lds
    buffer_load_dwordx4 v26, s[8:11], s57 offen offset:2048 lds
    s_add_u32 m0, s35, 82944
    s_nop 0
    buffer_load_dwordx4 v25, s[8:11], s57 offen offset:0 lds
    buffer_load_dwordx4 v27, s[8:11], s57 offen offset:2048 lds
    s_add_u32 s57, s57, 0x20000
    s_cmp_eq_u32 s57, 0x700000
    s_cselect_b32 s57, 0, s57
    s_add_u32 m0, s35, 49152
    s_nop 0
    buffer_load_dwordx4 v24, s[8:11], s57 offen offset:0 lds
    buffer_load_dwordx4 v26, s[8:11], s57 offen offset:2048 lds
    s_add_u32 m0, s35, 50176
    s_nop 0
    buffer_load_dwordx4 v25, s[8:11], s57 offen offset:0 lds
    buffer_load_dwordx4 v27, s[8:11], s57 offen offset:2048 lds
    s_add_u32 s57, s57, 0x20000
    s_cmp_eq_u32 s57, 0x700000
    s_cselect_b32 s57, 0, s57
    s_add_u32 m0, s35, 114688
    s_nop 0
    buffer_load_dwordx4 v24, s[8:11], s57 offen offset:0 lds
    buffer_load_dwordx4 v26, s[8:11], s57 offen offset:2048 lds
    s_add_u32 m0, s35, 115712
    s_nop 0
    buffer_load_dwordx4 v25, s[8:11], s57 offen offset:0 lds
    buffer_load_dwordx4 v27, s[8:11], s57 offen offset:2048 lds
    s_add_u32 s57, s57, 0x20000
    s_cmp_eq_u32 s57, 0x700000
    s_cselect_b32 s57, 0, s57
    s_waitcnt vmcnt(16)
    s_branch L_g2_p1
L_g2_p0:
    v_mov_b32 v23, 1
    v_mul_lo_u32 v21, v1, s26
    s_waitcnt vmcnt(0)
L_g2_p1:
    s_barrier
    s_cmp_lg_u32 s28, 0
    s_cbranch_scc1 L_g2_com
    s_mov_b64 exec, 3
    buffer_atomic_add v23, v21, s[52:55], s27 offen sc1
    s_mov_b64 exec, -1
L_g2_com:
    v_mov_b32 v21, 0
    s_cmp_eq_u32 s31, 0
    s_cselect_b32 s44, 8, 8
    s_cmp_ge_u32 s28, 4
    s_cbranch_scc1 L_g2_loader
    s_add_u32 s23, s27, 128
    s_load_dwordx2 s[4:5], s[0:1], 0
    s_load_dwordx4 s[24:27], s[0:1], 56
    s_lshr_b32 s34, s30, 2
    s_mul_i32 s34, s34, 14
    s_mul_i32 s36, s31, 36
    s_add_u32 s36, s36, s34
    s_add_u32 s36, s36, 4
    s_cmp_ge_u32 s36, 56
    s_cselect_b32 s34, 56, 0
    s_sub_u32 s36, s36, s34
    s_lshl_b32 s36, s36, 17
    s_mov_b32 s12, s90
    s_mov_b32 s13, s91
    s_mov_b32 s14, 0x700000
    s_mov_b32 s15, 0x00020000
    s_lshl_b32 s29, s29, 1
    s_bfe_u32 s34, s30, 0x10002
    s_add_u32 s29, s29, s34
    s_lshr_b32 s34, s30, 3
    s_lshl_b32 s34, s34, 2
    s_and_b32 s30, s30, 3
    s_add_u32 s30, s30, s34
    v_mov_b32 v3, v19
    v_mov_b32 v18, 0
    v_lshrrev_b32 v20, 2, v1
    v_lshlrev_b32 v20, 11, v20
    v_and_b32 v7, 3, v1
    v_lshl_add_u32 v20, v7, 6, v20
    s_lshl_b32 s34, s28, 15
    s_lshl_b32 s37, s30, 8
    s_add_u32 s34, s34, s37
    v_add_u32 v20, s34, v20
    s_cmp_eq_u32 s31, 0
    s_cselect_b32 s37, -1, 3
    s_and_b32 s32, s28, 1
    s_lshr_b32 s33, s28, 1
    s_lshl_b32 s34, s32, 12
    v_add_u32 v8, s34, v3
    v_add_u32 v9, 0x10000, v8
    v_lshrrev_b32 v6, 5, v1
    v_lshlrev_b32 v6, 11, v6
    v_bfe_u32 v7, v1, 2, 3
    v_lshl_add_u32 v6, v7, 7, v6
    v_bfe_u32 v7, v1, 3, 2
    v_lshl_add_u32 v6, v7, 5, v6
    v_and_b32 v7, 3, v1
    v_lshl_add_u32 v6, v7, 3, v6
    s_lshl_b32 s34, s33, 10
    s_add_u32 s34, s34, 16384
    v_add_u32 v10, s34, v6
    v_xor_b32 v11, 32, v10
    v_xor_b32 v12, 64, v10
    v_xor_b32 v13, 96, v10
    v_add_u32 v14, 0x10000, v10
    v_add_u32 v15, 0x10000, v11
    v_add_u32 v16, 0x10000, v12
    v_add_u32 v17, 0x10000, v13
    v_and_b32 v19, 15, v1
    v_lshlrev_b32 v19, 11, v19
    v_lshrrev_b32 v7, 4, v1
    v_lshlrev_b32 v7, 3, v7
    s_lshl_b32 s38, s30, 8
    s_lshl_b32 s39, s33, 7
    s_add_u32 s38, s38, s39
    s_lshl_b32 s39, s29, 18
    s_lshl_b32 s47, s32, 17
    s_add_u32 s39, s39, s47
    s_add_u32 s39, s39, s38
    s_lshl_b32 s48, s29, 3
    s_add_u32 s48, s48, s30
    s_lshl_b32 s48, s48, 2
    s_add_u32 s48, s48, s28
    s_lshl_b32 s49, s48, 5
    s_add_u32 s49, s49, 0x800000
    s_lshl_b32 s48, s48, 14
    s_add_u32 s8, s6, 0x2800000
    s_addc_u32 s9, s7, 0
    s_mov_b32 s10, 0x804000
    s_mov_b32 s11, 0x00020000
    v_mov_b32 v24, 0
    v_mov_b32 v25, 0
    v_mov_b32 v26, 0
    v_mov_b32 v27, 0
    v_mov_b32 v28, 0
    v_mov_b32 v29, 0
    v_mov_b32 v30, 0
    v_mov_b32 v31, 0
    v_mov_b32 v32, 0
    v_mov_b32 v33, 0
    v_mov_b32 v34, 0
    v_mov_b32 v35, 0
    v_mov_b32 v36, 0
    v_mov_b32 v37, 0
    v_mov_b32 v38, 0
    v_mov_b32 v39, 0
    v_mov_b32 v40, 0
    v_mov_b32 v41, 0
    v_mov_b32 v42, 0
    v_mov_b32 v43, 0
    v_mov_b32 v44, 0
    v_mov_b32 v45, 0
    v_mov_b32 v46, 0
    v_mov_b32 v47, 0
    v_mov_b32 v48, 0
    v_mov_b32 v49, 0
    v_mov_b32 v50, 0
    v_mov_b32 v51, 0
    v_mov_b32 v52, 0
    v_mov_b32 v53, 0
    v_mov_b32 v54, 0
    v_mov_b32 v55, 0
    v_mov_b32 v56, 0
    v_mov_b32 v57, 0
    v_mov_b32 v58, 0
    v_mov_b32 v59, 0
    v_mov_b32 v60, 0
    v_mov_b32 v61, 0
    v_mov_b32 v62, 0
    v_mov_b32 v63, 0
    v_mov_b32 v64, 0
    v_mov_b32 v65, 0
    v_mov_b32 v66, 0
    v_mov_b32 v67, 0
    v_mov_b32 v68, 0
    v_mov_b32 v69, 0
    v_mov_b32 v70, 0
    v_mov_b32 v71, 0
    v_mov_b32 v72, 0
    v_mov_b32 v73, 0
    v_mov_b32 v74, 0
    v_mov_b32 v75, 0
    v_mov_b32 v76, 0
    v_mov_b32 v77, 0
    v_mov_b32 v78, 0
    v_mov_b32 v79, 0
    v_mov_b32 v80, 0
    v_mov_b32 v81, 0
    v_mov_b32 v82, 0
    v_mov_b32 v83, 0
    v_mov_b32 v84, 0
    v_mov_b32 v85, 0
    v_mov_b32 v86, 0
    v_mov_b32 v87, 0
    v_lshrrev_b32 v23, 4, v1
    v_and_b32 v6, 1, v23
    v_lshlrev_b32 v6, 5, v6
    v_lshrrev_b32 v23, 1, v23
    v_lshl_add_u32 v6, v23, 4, v6
    v_add_u32 v6, v6, v19
    s_cmp_lg_u32 s31, 0
    s_cbranch_scc1 L_g2_zero
    s_waitcnt lgkmcnt(0)
    s_mov_b32 s16, s4
    s_mov_b32 s17, s5
    s_mov_b32 s18, 0x400000
    s_mov_b32 s19, 0x00020000
    s_mov_b32 s40, s24
    s_mov_b32 s41, s25
    s_mov_b32 s42, 0x800
    s_mov_b32 s43, 0x00020000
    buffer_load_dwordx2 v[184:185], v7, s[40:43], s38 offen offset:0
    buffer_load_dwordx2 v[186:187], v7, s[40:43], s38 offen offset:32
    buffer_load_dwordx2 v[188:189], v7, s[40:43], s38 offen offset:64
    buffer_load_dwordx2 v[190:191], v7, s[40:43], s38 offen offset:96
    s_add_u32 s47, s39, 0
    buffer_load_dwordx4 v[152:155], v6, s[16:19], s47 offen offset:0
    buffer_load_dwordx4 v[156:159], v6, s[16:19], s47 offen offset:64
    s_add_u32 s47, s39, 32768
    buffer_load_dwordx4 v[160:163], v6, s[16:19], s47 offen offset:0
    buffer_load_dwordx4 v[164:167], v6, s[16:19], s47 offen offset:64
    s_add_u32 s47, s39, 65536
    buffer_load_dwordx4 v[168:171], v6, s[16:19], s47 offen offset:0
    buffer_load_dwordx4 v[172:175], v6, s[16:19], s47 offen offset:64
    s_add_u32 s47, s39, 98304
    buffer_load_dwordx4 v[176:179], v6, s[16:19], s47 offen offset:0
    buffer_load_dwordx4 v[180:183], v6, s[16:19], s47 offen offset:64
    s_waitcnt vmcnt(0)
    v_lshlrev_b32 v192, 16, v184
    v_and_b32 v193, 0xffff0000, v184
    v_lshlrev_b32 v194, 16, v185
    v_and_b32 v195, 0xffff0000, v185
    v_lshlrev_b32 v196, 16, v186
    v_and_b32 v197, 0xffff0000, v186
    v_lshlrev_b32 v198, 16, v187
    v_and_b32 v199, 0xffff0000, v187
    v_lshlrev_b32 v200, 16, v188
    v_and_b32 v201, 0xffff0000, v188
    v_lshlrev_b32 v202, 16, v189
    v_and_b32 v203, 0xffff0000, v189
    v_lshlrev_b32 v204, 16, v190
    v_and_b32 v205, 0xffff0000, v190
    v_lshlrev_b32 v206, 16, v191
    v_and_b32 v207, 0xffff0000, v191
    v_permlane16_swap_b32 v152, v154
    v_permlane16_swap_b32 v153, v155
    v_permlane16_swap_b32 v156, v158
    v_permlane16_swap_b32 v157, v159
    v_permlane16_swap_b32 v160, v162
    v_permlane16_swap_b32 v161, v163
    v_permlane16_swap_b32 v164, v166
    v_permlane16_swap_b32 v165, v167
    v_permlane16_swap_b32 v168, v170
    v_permlane16_swap_b32 v169, v171
    v_permlane16_swap_b32 v172, v174
    v_permlane16_swap_b32 v173, v175
    v_permlane16_swap_b32 v176, v178
    v_permlane16_swap_b32 v177, v179
    v_permlane16_swap_b32 v180, v182
    v_permlane16_swap_b32 v181, v183
    v_lshlrev_b32 v24, 16, v152
    v_and_b32 v25, 0xffff0000, v152
    v_lshlrev_b32 v26, 16, v153
    v_and_b32 v27, 0xffff0000, v153
    v_pk_add_f32 v[24:25], v[24:25], v[192:193]
    v_pk_add_f32 v[26:27], v[26:27], v[194:195]
    v_lshlrev_b32 v28, 16, v154
    v_and_b32 v29, 0xffff0000, v154
    v_lshlrev_b32 v30, 16, v155
    v_and_b32 v31, 0xffff0000, v155
    v_pk_add_f32 v[28:29], v[28:29], v[196:197]
    v_pk_add_f32 v[30:31], v[30:31], v[198:199]
    v_lshlrev_b32 v32, 16, v156
    v_and_b32 v33, 0xffff0000, v156
    v_lshlrev_b32 v34, 16, v157
    v_and_b32 v35, 0xffff0000, v157
    v_pk_add_f32 v[32:33], v[32:33], v[200:201]
    v_pk_add_f32 v[34:35], v[34:35], v[202:203]
    v_lshlrev_b32 v36, 16, v158
    v_and_b32 v37, 0xffff0000, v158
    v_lshlrev_b32 v38, 16, v159
    v_and_b32 v39, 0xffff0000, v159
    v_pk_add_f32 v[36:37], v[36:37], v[204:205]
    v_pk_add_f32 v[38:39], v[38:39], v[206:207]
    v_lshlrev_b32 v40, 16, v160
    v_and_b32 v41, 0xffff0000, v160
    v_lshlrev_b32 v42, 16, v161
    v_and_b32 v43, 0xffff0000, v161
    v_pk_add_f32 v[40:41], v[40:41], v[192:193]
    v_pk_add_f32 v[42:43], v[42:43], v[194:195]
    v_lshlrev_b32 v44, 16, v162
    v_and_b32 v45, 0xffff0000, v162
    v_lshlrev_b32 v46, 16, v163
    v_and_b32 v47, 0xffff0000, v163
    v_pk_add_f32 v[44:45], v[44:45], v[196:197]
    v_pk_add_f32 v[46:47], v[46:47], v[198:199]
    v_lshlrev_b32 v48, 16, v164
    v_and_b32 v49, 0xffff0000, v164
    v_lshlrev_b32 v50, 16, v165
    v_and_b32 v51, 0xffff0000, v165
    v_pk_add_f32 v[48:49], v[48:49], v[200:201]
    v_pk_add_f32 v[50:51], v[50:51], v[202:203]
    v_lshlrev_b32 v52, 16, v166
    v_and_b32 v53, 0xffff0000, v166
    v_lshlrev_b32 v54, 16, v167
    v_and_b32 v55, 0xffff0000, v167
    v_pk_add_f32 v[52:53], v[52:53], v[204:205]
    v_pk_add_f32 v[54:55], v[54:55], v[206:207]
    v_lshlrev_b32 v56, 16, v168
    v_and_b32 v57, 0xffff0000, v168
    v_lshlrev_b32 v58, 16, v169
    v_and_b32 v59, 0xffff0000, v169
    v_pk_add_f32 v[56:57], v[56:57], v[192:193]
    v_pk_add_f32 v[58:59], v[58:59], v[194:195]
    v_lshlrev_b32 v60, 16, v170
    v_and_b32 v61, 0xffff0000, v170
    v_lshlrev_b32 v62, 16, v171
    v_and_b32 v63, 0xffff0000, v171
    v_pk_add_f32 v[60:61], v[60:61], v[196:197]
    v_pk_add_f32 v[62:63], v[62:63], v[198:199]
    v_lshlrev_b32 v64, 16, v172
    v_and_b32 v65, 0xffff0000, v172
    v_lshlrev_b32 v66, 16, v173
    v_and_b32 v67, 0xffff0000, v173
    v_pk_add_f32 v[64:65], v[64:65], v[200:201]
    v_pk_add_f32 v[66:67], v[66:67], v[202:203]
    v_lshlrev_b32 v68, 16, v174
    v_and_b32 v69, 0xffff0000, v174
    v_lshlrev_b32 v70, 16, v175
    v_and_b32 v71, 0xffff0000, v175
    v_pk_add_f32 v[68:69], v[68:69], v[204:205]
    v_pk_add_f32 v[70:71], v[70:71], v[206:207]
    v_lshlrev_b32 v72, 16, v176
    v_and_b32 v73, 0xffff0000, v176
    v_lshlrev_b32 v74, 16, v177
    v_and_b32 v75, 0xffff0000, v177
    v_pk_add_f32 v[72:73], v[72:73], v[192:193]
    v_pk_add_f32 v[74:75], v[74:75], v[194:195]
    v_lshlrev_b32 v76, 16, v178
    v_and_b32 v77, 0xffff0000, v178
    v_lshlrev_b32 v78, 16, v179
    v_and_b32 v79, 0xffff0000, v179
    v_pk_add_f32 v[76:77], v[76:77], v[196:197]
    v_pk_add_f32 v[78:79], v[78:79], v[198:199]
    v_lshlrev_b32 v80, 16, v180
    v_and_b32 v81, 0xffff0000, v180
    v_lshlrev_b32 v82, 16, v181
    v_and_b32 v83, 0xffff0000, v181
    v_pk_add_f32 v[80:81], v[80:81], v[200:201]
    v_pk_add_f32 v[82:83], v[82:83], v[202:203]
    v_lshlrev_b32 v84, 16, v182
    v_and_b32 v85, 0xffff0000, v182
    v_lshlrev_b32 v86, 16, v183
    v_and_b32 v87, 0xffff0000, v183
    v_pk_add_f32 v[84:85], v[84:85], v[204:205]
    v_pk_add_f32 v[86:87], v[86:87], v[206:207]
L_g2_zero:
    s_waitcnt lgkmcnt(0)
    s_barrier
    ds_read_b128 v[88:91], v8 offset:0
    ds_read_b64_tr_b16 v[104:105], v10 offset:0
    ds_read_b64_tr_b16 v[106:107], v10 offset:4096
    ds_read_b64_tr_b16 v[108:109], v11 offset:0
    ds_read_b64_tr_b16 v[110:111], v11 offset:4096
    ds_read_b64_tr_b16 v[112:113], v12 offset:0
    ds_read_b64_tr_b16 v[114:115], v12 offset:4096
    ds_read_b64_tr_b16 v[116:117], v13 offset:0
    ds_read_b64_tr_b16 v[118:119], v13 offset:4096
    ds_read_b128 v[92:95], v8 offset:1024
    ds_read_b128 v[96:99], v8 offset:2048
    ds_read_b128 v[100:103], v8 offset:3072
    s_waitcnt lgkmcnt(0)
    v_mfma_f32_16x16x32_bf16 v[24:27], v[104:107], v[88:91], v[24:27]
    ds_read_b128 v[120:123], v8 offset:8192
    v_mfma_f32_16x16x32_bf16 v[28:31], v[108:111], v[88:91], v[28:31]
    ds_read_b64_tr_b16 v[136:137], v10 offset:8192
    v_mfma_f32_16x16x32_bf16 v[32:35], v[112:115], v[88:91], v[32:35]
    ds_read_b64_tr_b16 v[138:139], v10 offset:12288
    v_mfma_f32_16x16x32_bf16 v[36:39], v[116:119], v[88:91], v[36:39]
    ds_read_b64_tr_b16 v[140:141], v11 offset:8192
    v_mfma_f32_16x16x32_bf16 v[40:43], v[104:107], v[92:95], v[40:43]
    ds_read_b64_tr_b16 v[142:143], v11 offset:12288
    v_mfma_f32_16x16x32_bf16 v[44:47], v[108:111], v[92:95], v[44:47]
    ds_read_b64_tr_b16 v[144:145], v12 offset:8192
    v_mfma_f32_16x16x32_bf16 v[48:51], v[112:115], v[92:95], v[48:51]
    ds_read_b64_tr_b16 v[146:147], v12 offset:12288
    v_mfma_f32_16x16x32_bf16 v[52:55], v[116:119], v[92:95], v[52:55]
    ds_read_b64_tr_b16 v[148:149], v13 offset:8192
    v_mfma_f32_16x16x32_bf16 v[56:59], v[104:107], v[96:99], v[56:59]
    ds_read_b64_tr_b16 v[150:151], v13 offset:12288
    v_mfma_f32_16x16x32_bf16 v[60:63], v[108:111], v[96:99], v[60:63]
    ds_read_b128 v[124:127], v8 offset:9216
    v_mfma_f32_16x16x32_bf16 v[64:67], v[112:115], v[96:99], v[64:67]
    ds_read_b128 v[128:131], v8 offset:10240
    v_mfma_f32_16x16x32_bf16 v[68:71], v[116:119], v[96:99], v[68:71]
    ds_read_b128 v[132:135], v8 offset:11264
    v_mfma_f32_16x16x32_bf16 v[72:75], v[104:107], v[100:103], v[72:75]
    v_mfma_f32_16x16x32_bf16 v[76:79], v[108:111], v[100:103], v[76:79]
    v_mfma_f32_16x16x32_bf16 v[80:83], v[112:115], v[100:103], v[80:83]
    v_mfma_f32_16x16x32_bf16 v[84:87], v[116:119], v[100:103], v[84:87]
    s_lshl_b32 s50, s28, 1
    s_add_u32 s50, s50, s31
    s_cmp_lg_u32 s50, 1
    s_cbranch_scc1 L_g2_loop
    v_mov_b32 v22, 1
    s_mov_b64 exec, 1
    buffer_atomic_add v22, v21, s[52:55], s23 offen sc1
    s_mov_b64 exec, -1
L_g2_loop:
    s_waitcnt lgkmcnt(0)
    s_barrier
    v_mfma_f32_16x16x32_bf16 v[24:27], v[136:139], v[120:123], v[24:27]
    ds_read_b128 v[88:91], v9 offset:0
    v_mfma_f32_16x16x32_bf16 v[28:31], v[140:143], v[120:123], v[28:31]
    ds_read_b64_tr_b16 v[104:105], v14 offset:0
    v_mfma_f32_16x16x32_bf16 v[32:35], v[144:147], v[120:123], v[32:35]
    ds_read_b64_tr_b16 v[106:107], v14 offset:4096
    v_mfma_f32_16x16x32_bf16 v[36:39], v[148:151], v[120:123], v[36:39]
    ds_read_b64_tr_b16 v[108:109], v15 offset:0
    v_mfma_f32_16x16x32_bf16 v[40:43], v[136:139], v[124:127], v[40:43]
    ds_read_b64_tr_b16 v[110:111], v15 offset:4096
    v_mfma_f32_16x16x32_bf16 v[44:47], v[140:143], v[124:127], v[44:47]
    ds_read_b64_tr_b16 v[112:113], v16 offset:0
    v_mfma_f32_16x16x32_bf16 v[48:51], v[144:147], v[124:127], v[48:51]
    ds_read_b64_tr_b16 v[114:115], v16 offset:4096
    v_mfma_f32_16x16x32_bf16 v[52:55], v[148:151], v[124:127], v[52:55]
    ds_read_b64_tr_b16 v[116:117], v17 offset:0
    v_mfma_f32_16x16x32_bf16 v[56:59], v[136:139], v[128:131], v[56:59]
    ds_read_b64_tr_b16 v[118:119], v17 offset:4096
    v_mfma_f32_16x16x32_bf16 v[60:63], v[140:143], v[128:131], v[60:63]
    ds_read_b128 v[92:95], v9 offset:1024
    v_mfma_f32_16x16x32_bf16 v[64:67], v[144:147], v[128:131], v[64:67]
    ds_read_b128 v[96:99], v9 offset:2048
    v_mfma_f32_16x16x32_bf16 v[68:71], v[148:151], v[128:131], v[68:71]
    ds_read_b128 v[100:103], v9 offset:3072
    v_mfma_f32_16x16x32_bf16 v[72:75], v[136:139], v[132:135], v[72:75]
    v_mfma_f32_16x16x32_bf16 v[76:79], v[140:143], v[132:135], v[76:79]
    v_mfma_f32_16x16x32_bf16 v[80:83], v[144:147], v[132:135], v[80:83]
    v_mfma_f32_16x16x32_bf16 v[84:87], v[148:151], v[132:135], v[84:87]
    s_waitcnt lgkmcnt(0)
    v_mfma_f32_16x16x32_bf16 v[24:27], v[104:107], v[88:91], v[24:27]
    ds_read_b128 v[120:123], v9 offset:8192
    v_mfma_f32_16x16x32_bf16 v[28:31], v[108:111], v[88:91], v[28:31]
    ds_read_b64_tr_b16 v[136:137], v14 offset:8192
    v_mfma_f32_16x16x32_bf16 v[32:35], v[112:115], v[88:91], v[32:35]
    ds_read_b64_tr_b16 v[138:139], v14 offset:12288
    v_mfma_f32_16x16x32_bf16 v[36:39], v[116:119], v[88:91], v[36:39]
    ds_read_b64_tr_b16 v[140:141], v15 offset:8192
    v_mfma_f32_16x16x32_bf16 v[40:43], v[104:107], v[92:95], v[40:43]
    ds_read_b64_tr_b16 v[142:143], v15 offset:12288
    v_mfma_f32_16x16x32_bf16 v[44:47], v[108:111], v[92:95], v[44:47]
    ds_read_b64_tr_b16 v[144:145], v16 offset:8192
    v_mfma_f32_16x16x32_bf16 v[48:51], v[112:115], v[92:95], v[48:51]
    ds_read_b64_tr_b16 v[146:147], v16 offset:12288
    v_mfma_f32_16x16x32_bf16 v[52:55], v[116:119], v[92:95], v[52:55]
    ds_read_b64_tr_b16 v[148:149], v17 offset:8192
    v_mfma_f32_16x16x32_bf16 v[56:59], v[104:107], v[96:99], v[56:59]
    ds_read_b64_tr_b16 v[150:151], v17 offset:12288
    v_mfma_f32_16x16x32_bf16 v[60:63], v[108:111], v[96:99], v[60:63]
    ds_read_b128 v[124:127], v9 offset:9216
    v_mfma_f32_16x16x32_bf16 v[64:67], v[112:115], v[96:99], v[64:67]
    ds_read_b128 v[128:131], v9 offset:10240
    v_mfma_f32_16x16x32_bf16 v[68:71], v[116:119], v[96:99], v[68:71]
    ds_read_b128 v[132:135], v9 offset:11264
    v_mfma_f32_16x16x32_bf16 v[72:75], v[104:107], v[100:103], v[72:75]
    v_mfma_f32_16x16x32_bf16 v[76:79], v[108:111], v[100:103], v[76:79]
    v_mfma_f32_16x16x32_bf16 v[80:83], v[112:115], v[100:103], v[80:83]
    v_mfma_f32_16x16x32_bf16 v[84:87], v[116:119], v[100:103], v[84:87]
    s_waitcnt lgkmcnt(0)
    s_barrier
    v_mfma_f32_16x16x32_bf16 v[24:27], v[136:139], v[120:123], v[24:27]
    ds_read_b128 v[88:91], v8 offset:32768
    v_mfma_f32_16x16x32_bf16 v[28:31], v[140:143], v[120:123], v[28:31]
    ds_read_b64_tr_b16 v[104:105], v10 offset:32768
    v_mfma_f32_16x16x32_bf16 v[32:35], v[144:147], v[120:123], v[32:35]
    ds_read_b64_tr_b16 v[106:107], v10 offset:36864
    v_mfma_f32_16x16x32_bf16 v[36:39], v[148:151], v[120:123], v[36:39]
    ds_read_b64_tr_b16 v[108:109], v11 offset:32768
    v_mfma_f32_16x16x32_bf16 v[40:43], v[136:139], v[124:127], v[40:43]
    ds_read_b64_tr_b16 v[110:111], v11 offset:36864
    v_mfma_f32_16x16x32_bf16 v[44:47], v[140:143], v[124:127], v[44:47]
    ds_read_b64_tr_b16 v[112:113], v12 offset:32768
    v_mfma_f32_16x16x32_bf16 v[48:51], v[144:147], v[124:127], v[48:51]
    ds_read_b64_tr_b16 v[114:115], v12 offset:36864
    v_mfma_f32_16x16x32_bf16 v[52:55], v[148:151], v[124:127], v[52:55]
    ds_read_b64_tr_b16 v[116:117], v13 offset:32768
    v_mfma_f32_16x16x32_bf16 v[56:59], v[136:139], v[128:131], v[56:59]
    ds_read_b64_tr_b16 v[118:119], v13 offset:36864
    v_mfma_f32_16x16x32_bf16 v[60:63], v[140:143], v[128:131], v[60:63]
    ds_read_b128 v[92:95], v8 offset:33792
    v_mfma_f32_16x16x32_bf16 v[64:67], v[144:147], v[128:131], v[64:67]
    ds_read_b128 v[96:99], v8 offset:34816
    v_mfma_f32_16x16x32_bf16 v[68:71], v[148:151], v[128:131], v[68:71]
    ds_read_b128 v[100:103], v8 offset:35840
    v_mfma_f32_16x16x32_bf16 v[72:75], v[136:139], v[132:135], v[72:75]
    v_mfma_f32_16x16x32_bf16 v[76:79], v[140:143], v[132:135], v[76:79]
    v_mfma_f32_16x16x32_bf16 v[80:83], v[144:147], v[132:135], v[80:83]
    v_mfma_f32_16x16x32_bf16 v[84:87], v[148:151], v[132:135], v[84:87]
    s_waitcnt lgkmcnt(0)
    v_mfma_f32_16x16x32_bf16 v[24:27], v[104:107], v[88:91], v[24:27]
    ds_read_b128 v[120:123], v8 offset:40960
    v_mfma_f32_16x16x32_bf16 v[28:31], v[108:111], v[88:91], v[28:31]
    ds_read_b64_tr_b16 v[136:137], v10 offset:40960
    v_mfma_f32_16x16x32_bf16 v[32:35], v[112:115], v[88:91], v[32:35]
    ds_read_b64_tr_b16 v[138:139], v10 offset:45056
    v_mfma_f32_16x16x32_bf16 v[36:39], v[116:119], v[88:91], v[36:39]
    ds_read_b64_tr_b16 v[140:141], v11 offset:40960
    v_mfma_f32_16x16x32_bf16 v[40:43], v[104:107], v[92:95], v[40:43]
    ds_read_b64_tr_b16 v[142:143], v11 offset:45056
    v_mfma_f32_16x16x32_bf16 v[44:47], v[108:111], v[92:95], v[44:47]
    ds_read_b64_tr_b16 v[144:145], v12 offset:40960
    v_mfma_f32_16x16x32_bf16 v[48:51], v[112:115], v[92:95], v[48:51]
    ds_read_b64_tr_b16 v[146:147], v12 offset:45056
    v_mfma_f32_16x16x32_bf16 v[52:55], v[116:119], v[92:95], v[52:55]
    ds_read_b64_tr_b16 v[148:149], v13 offset:40960
    v_mfma_f32_16x16x32_bf16 v[56:59], v[104:107], v[96:99], v[56:59]
    ds_read_b64_tr_b16 v[150:151], v13 offset:45056
    v_mfma_f32_16x16x32_bf16 v[60:63], v[108:111], v[96:99], v[60:63]
    ds_read_b128 v[124:127], v8 offset:41984
    v_mfma_f32_16x16x32_bf16 v[64:67], v[112:115], v[96:99], v[64:67]
    ds_read_b128 v[128:131], v8 offset:43008
    v_mfma_f32_16x16x32_bf16 v[68:71], v[116:119], v[96:99], v[68:71]
    ds_read_b128 v[132:135], v8 offset:44032
    v_mfma_f32_16x16x32_bf16 v[72:75], v[104:107], v[100:103], v[72:75]
    v_mfma_f32_16x16x32_bf16 v[76:79], v[108:111], v[100:103], v[76:79]
    v_mfma_f32_16x16x32_bf16 v[80:83], v[112:115], v[100:103], v[80:83]
    v_mfma_f32_16x16x32_bf16 v[84:87], v[116:119], v[100:103], v[84:87]
    s_waitcnt lgkmcnt(0)
    s_barrier
    v_mfma_f32_16x16x32_bf16 v[24:27], v[136:139], v[120:123], v[24:27]
    ds_read_b128 v[88:91], v9 offset:32768
    v_mfma_f32_16x16x32_bf16 v[28:31], v[140:143], v[120:123], v[28:31]
    ds_read_b64_tr_b16 v[104:105], v14 offset:32768
    v_mfma_f32_16x16x32_bf16 v[32:35], v[144:147], v[120:123], v[32:35]
    ds_read_b64_tr_b16 v[106:107], v14 offset:36864
    v_mfma_f32_16x16x32_bf16 v[36:39], v[148:151], v[120:123], v[36:39]
    ds_read_b64_tr_b16 v[108:109], v15 offset:32768
    v_mfma_f32_16x16x32_bf16 v[40:43], v[136:139], v[124:127], v[40:43]
    ds_read_b64_tr_b16 v[110:111], v15 offset:36864
    v_mfma_f32_16x16x32_bf16 v[44:47], v[140:143], v[124:127], v[44:47]
    ds_read_b64_tr_b16 v[112:113], v16 offset:32768
    v_mfma_f32_16x16x32_bf16 v[48:51], v[144:147], v[124:127], v[48:51]
    ds_read_b64_tr_b16 v[114:115], v16 offset:36864
    v_mfma_f32_16x16x32_bf16 v[52:55], v[148:151], v[124:127], v[52:55]
    ds_read_b64_tr_b16 v[116:117], v17 offset:32768
    v_mfma_f32_16x16x32_bf16 v[56:59], v[136:139], v[128:131], v[56:59]
    ds_read_b64_tr_b16 v[118:119], v17 offset:36864
    v_mfma_f32_16x16x32_bf16 v[60:63], v[140:143], v[128:131], v[60:63]
    ds_read_b128 v[92:95], v9 offset:33792
    v_mfma_f32_16x16x32_bf16 v[64:67], v[144:147], v[128:131], v[64:67]
    ds_read_b128 v[96:99], v9 offset:34816
    v_mfma_f32_16x16x32_bf16 v[68:71], v[148:151], v[128:131], v[68:71]
    ds_read_b128 v[100:103], v9 offset:35840
    v_mfma_f32_16x16x32_bf16 v[72:75], v[136:139], v[132:135], v[72:75]
    v_mfma_f32_16x16x32_bf16 v[76:79], v[140:143], v[132:135], v[76:79]
    v_mfma_f32_16x16x32_bf16 v[80:83], v[144:147], v[132:135], v[80:83]
    v_mfma_f32_16x16x32_bf16 v[84:87], v[148:151], v[132:135], v[84:87]
    s_waitcnt lgkmcnt(0)
    v_mfma_f32_16x16x32_bf16 v[24:27], v[104:107], v[88:91], v[24:27]
    ds_read_b128 v[120:123], v9 offset:40960
    v_mfma_f32_16x16x32_bf16 v[28:31], v[108:111], v[88:91], v[28:31]
    ds_read_b64_tr_b16 v[136:137], v14 offset:40960
    v_mfma_f32_16x16x32_bf16 v[32:35], v[112:115], v[88:91], v[32:35]
    ds_read_b64_tr_b16 v[138:139], v14 offset:45056
    v_mfma_f32_16x16x32_bf16 v[36:39], v[116:119], v[88:91], v[36:39]
    ds_read_b64_tr_b16 v[140:141], v15 offset:40960
    v_mfma_f32_16x16x32_bf16 v[40:43], v[104:107], v[92:95], v[40:43]
    ds_read_b64_tr_b16 v[142:143], v15 offset:45056
    v_mfma_f32_16x16x32_bf16 v[44:47], v[108:111], v[92:95], v[44:47]
    ds_read_b64_tr_b16 v[144:145], v16 offset:40960
    v_mfma_f32_16x16x32_bf16 v[48:51], v[112:115], v[92:95], v[48:51]
    ds_read_b64_tr_b16 v[146:147], v16 offset:45056
    v_mfma_f32_16x16x32_bf16 v[52:55], v[116:119], v[92:95], v[52:55]
    ds_read_b64_tr_b16 v[148:149], v17 offset:40960
    v_mfma_f32_16x16x32_bf16 v[56:59], v[104:107], v[96:99], v[56:59]
    ds_read_b64_tr_b16 v[150:151], v17 offset:45056
    v_mfma_f32_16x16x32_bf16 v[60:63], v[108:111], v[96:99], v[60:63]
    ds_read_b128 v[124:127], v9 offset:41984
    v_mfma_f32_16x16x32_bf16 v[64:67], v[112:115], v[96:99], v[64:67]
    ds_read_b128 v[128:131], v9 offset:43008
    v_mfma_f32_16x16x32_bf16 v[68:71], v[116:119], v[96:99], v[68:71]
    ds_read_b128 v[132:135], v9 offset:44032
    v_mfma_f32_16x16x32_bf16 v[72:75], v[104:107], v[100:103], v[72:75]
    v_mfma_f32_16x16x32_bf16 v[76:79], v[108:111], v[100:103], v[76:79]
    v_mfma_f32_16x16x32_bf16 v[80:83], v[112:115], v[100:103], v[80:83]
    v_mfma_f32_16x16x32_bf16 v[84:87], v[116:119], v[100:103], v[84:87]
    s_waitcnt lgkmcnt(0)
    s_barrier
    v_mfma_f32_16x16x32_bf16 v[24:27], v[136:139], v[120:123], v[24:27]
    ds_read_b128 v[88:91], v8 offset:0
    v_mfma_f32_16x16x32_bf16 v[28:31], v[140:143], v[120:123], v[28:31]
    ds_read_b64_tr_b16 v[104:105], v10 offset:0
    v_mfma_f32_16x16x32_bf16 v[32:35], v[144:147], v[120:123], v[32:35]
    ds_read_b64_tr_b16 v[106:107], v10 offset:4096
    v_mfma_f32_16x16x32_bf16 v[36:39], v[148:151], v[120:123], v[36:39]
    ds_read_b64_tr_b16 v[108:109], v11 offset:0
    v_mfma_f32_16x16x32_bf16 v[40:43], v[136:139], v[124:127], v[40:43]
    ds_read_b64_tr_b16 v[110:111], v11 offset:4096
    v_mfma_f32_16x16x32_bf16 v[44:47], v[140:143], v[124:127], v[44:47]
    ds_read_b64_tr_b16 v[112:113], v12 offset:0
    v_mfma_f32_16x16x32_bf16 v[48:51], v[144:147], v[124:127], v[48:51]
    ds_read_b64_tr_b16 v[114:115], v12 offset:4096
    v_mfma_f32_16x16x32_bf16 v[52:55], v[148:151], v[124:127], v[52:55]
    ds_read_b64_tr_b16 v[116:117], v13 offset:0
    v_mfma_f32_16x16x32_bf16 v[56:59], v[136:139], v[128:131], v[56:59]
    ds_read_b64_tr_b16 v[118:119], v13 offset:4096
    v_mfma_f32_16x16x32_bf16 v[60:63], v[140:143], v[128:131], v[60:63]
    ds_read_b128 v[92:95], v8 offset:1024
    v_mfma_f32_16x16x32_bf16 v[64:67], v[144:147], v[128:131], v[64:67]
    ds_read_b128 v[96:99], v8 offset:2048
    v_mfma_f32_16x16x32_bf16 v[68:71], v[148:151], v[128:131], v[68:71]
    ds_read_b128 v[100:103], v8 offset:3072
    v_mfma_f32_16x16x32_bf16 v[72:75], v[136:139], v[132:135], v[72:75]
    v_mfma_f32_16x16x32_bf16 v[76:79], v[140:143], v[132:135], v[76:79]
    v_mfma_f32_16x16x32_bf16 v[80:83], v[144:147], v[132:135], v[80:83]
    v_mfma_f32_16x16x32_bf16 v[84:87], v[148:151], v[132:135], v[84:87]
    s_waitcnt lgkmcnt(0)
    v_mfma_f32_16x16x32_bf16 v[24:27], v[104:107], v[88:91], v[24:27]
    ds_read_b128 v[120:123], v8 offset:8192
    v_mfma_f32_16x16x32_bf16 v[28:31], v[108:111], v[88:91], v[28:31]
    ds_read_b64_tr_b16 v[136:137], v10 offset:8192
    v_mfma_f32_16x16x32_bf16 v[32:35], v[112:115], v[88:91], v[32:35]
    ds_read_b64_tr_b16 v[138:139], v10 offset:12288
    v_mfma_f32_16x16x32_bf16 v[36:39], v[116:119], v[88:91], v[36:39]
    ds_read_b64_tr_b16 v[140:141], v11 offset:8192
    v_mfma_f32_16x16x32_bf16 v[40:43], v[104:107], v[92:95], v[40:43]
    ds_read_b64_tr_b16 v[142:143], v11 offset:12288
    v_mfma_f32_16x16x32_bf16 v[44:47], v[108:111], v[92:95], v[44:47]
    ds_read_b64_tr_b16 v[144:145], v12 offset:8192
    v_mfma_f32_16x16x32_bf16 v[48:51], v[112:115], v[92:95], v[48:51]
    ds_read_b64_tr_b16 v[146:147], v12 offset:12288
    v_mfma_f32_16x16x32_bf16 v[52:55], v[116:119], v[92:95], v[52:55]
    ds_read_b64_tr_b16 v[148:149], v13 offset:8192
    v_mfma_f32_16x16x32_bf16 v[56:59], v[104:107], v[96:99], v[56:59]
    ds_read_b64_tr_b16 v[150:151], v13 offset:12288
    v_mfma_f32_16x16x32_bf16 v[60:63], v[108:111], v[96:99], v[60:63]
    ds_read_b128 v[124:127], v8 offset:9216
    v_mfma_f32_16x16x32_bf16 v[64:67], v[112:115], v[96:99], v[64:67]
    ds_read_b128 v[128:131], v8 offset:10240
    v_mfma_f32_16x16x32_bf16 v[68:71], v[116:119], v[96:99], v[68:71]
    ds_read_b128 v[132:135], v8 offset:11264
    v_mfma_f32_16x16x32_bf16 v[72:75], v[104:107], v[100:103], v[72:75]
    v_mfma_f32_16x16x32_bf16 v[76:79], v[108:111], v[100:103], v[76:79]
    v_mfma_f32_16x16x32_bf16 v[80:83], v[112:115], v[100:103], v[80:83]
    v_mfma_f32_16x16x32_bf16 v[84:87], v[116:119], v[100:103], v[84:87]
    s_sub_u32 s44, s44, 1
    s_waitcnt vmcnt(0)
    v_readfirstlane_b32 s50, v18
    buffer_load_dword v18, v21, s[8:11], s49 offen sc1
    s_cmp_lg_u32 s44, 0
    s_cbranch_scc1 L_g2_loop
    s_cmp_lg_u32 s31, 0
    s_cbranch_scc1 L_g2_poll
    s_mov_b32 s50, 1
    s_branch L_g2_np0
L_g2_poll:
    s_cmp_eq_u32 s50, 0
    s_cbranch_scc1 L_g2_np0
    s_add_u32 s47, s48, 0
    buffer_load_dwordx4 v[152:155], v3, s[8:11], s47 offen offset:0 sc1
    buffer_load_dwordx4 v[156:159], v3, s[8:11], s47 offen offset:1024 sc1
    buffer_load_dwordx4 v[160:163], v3, s[8:11], s47 offen offset:2048 sc1
    buffer_load_dwordx4 v[164:167], v3, s[8:11], s47 offen offset:3072 sc1
    s_add_u32 s47, s48, 4096
    buffer_load_dwordx4 v[168:171], v3, s[8:11], s47 offen offset:0 sc1
    buffer_load_dwordx4 v[172:175], v3, s[8:11], s47 offen offset:1024 sc1
    buffer_load_dwordx4 v[176:179], v3, s[8:11], s47 offen offset:2048 sc1
    buffer_load_dwordx4 v[180:183], v3, s[8:11], s47 offen offset:3072 sc1
    s_add_u32 s47, s48, 8192
    buffer_load_dwordx4 v[184:187], v3, s[8:11], s47 offen offset:0 sc1
    buffer_load_dwordx4 v[188:191], v3, s[8:11], s47 offen offset:1024 sc1
    buffer_load_dwordx4 v[192:195], v3, s[8:11], s47 offen offset:2048 sc1
    buffer_load_dwordx4 v[196:199], v3, s[8:11], s47 offen offset:3072 sc1
    s_add_u32 s47, s48, 12288
    buffer_load_dwordx4 v[200:203], v3, s[8:11], s47 offen offset:0 sc1
    buffer_load_dwordx4 v[204:207], v3, s[8:11], s47 offen offset:1024 sc1
    buffer_load_dwordx4 v[208:211], v3, s[8:11], s47 offen offset:2048 sc1
    buffer_load_dwordx4 v[212:215], v3, s[8:11], s47 offen offset:3072 sc1
L_g2_np0:
    s_waitcnt lgkmcnt(0)
    s_barrier
    v_mfma_f32_16x16x32_bf16 v[24:27], v[136:139], v[120:123], v[24:27]
    ds_read_b128 v[88:91], v9 offset:0
    v_mfma_f32_16x16x32_bf16 v[28:31], v[140:143], v[120:123], v[28:31]
    ds_read_b64_tr_b16 v[104:105], v14 offset:0
    v_mfma_f32_16x16x32_bf16 v[32:35], v[144:147], v[120:123], v[32:35]
    ds_read_b64_tr_b16 v[106:107], v14 offset:4096
    v_mfma_f32_16x16x32_bf16 v[36:39], v[148:151], v[120:123], v[36:39]
    ds_read_b64_tr_b16 v[108:109], v15 offset:0
    v_mfma_f32_16x16x32_bf16 v[40:43], v[136:139], v[124:127], v[40:43]
    ds_read_b64_tr_b16 v[110:111], v15 offset:4096
    v_mfma_f32_16x16x32_bf16 v[44:47], v[140:143], v[124:127], v[44:47]
    ds_read_b64_tr_b16 v[112:113], v16 offset:0
    v_mfma_f32_16x16x32_bf16 v[48:51], v[144:147], v[124:127], v[48:51]
    ds_read_b64_tr_b16 v[114:115], v16 offset:4096
    v_mfma_f32_16x16x32_bf16 v[52:55], v[148:151], v[124:127], v[52:55]
    ds_read_b64_tr_b16 v[116:117], v17 offset:0
    v_mfma_f32_16x16x32_bf16 v[56:59], v[136:139], v[128:131], v[56:59]
    ds_read_b64_tr_b16 v[118:119], v17 offset:4096
    v_mfma_f32_16x16x32_bf16 v[60:63], v[140:143], v[128:131], v[60:63]
    ds_read_b128 v[92:95], v9 offset:1024
    v_mfma_f32_16x16x32_bf16 v[64:67], v[144:147], v[128:131], v[64:67]
    ds_read_b128 v[96:99], v9 offset:2048
    v_mfma_f32_16x16x32_bf16 v[68:71], v[148:151], v[128:131], v[68:71]
    ds_read_b128 v[100:103], v9 offset:3072
    v_mfma_f32_16x16x32_bf16 v[72:75], v[136:139], v[132:135], v[72:75]
    v_mfma_f32_16x16x32_bf16 v[76:79], v[140:143], v[132:135], v[76:79]
    v_mfma_f32_16x16x32_bf16 v[80:83], v[144:147], v[132:135], v[80:83]
    v_mfma_f32_16x16x32_bf16 v[84:87], v[148:151], v[132:135], v[84:87]
    s_waitcnt lgkmcnt(0)
    v_mfma_f32_16x16x32_bf16 v[24:27], v[104:107], v[88:91], v[24:27]
    ds_read_b128 v[120:123], v9 offset:8192
    v_mfma_f32_16x16x32_bf16 v[28:31], v[108:111], v[88:91], v[28:31]
    ds_read_b64_tr_b16 v[136:137], v14 offset:8192
    v_mfma_f32_16x16x32_bf16 v[32:35], v[112:115], v[88:91], v[32:35]
    ds_read_b64_tr_b16 v[138:139], v14 offset:12288
    v_mfma_f32_16x16x32_bf16 v[36:39], v[116:119], v[88:91], v[36:39]
    ds_read_b64_tr_b16 v[140:141], v15 offset:8192
    v_mfma_f32_16x16x32_bf16 v[40:43], v[104:107], v[92:95], v[40:43]
    ds_read_b64_tr_b16 v[142:143], v15 offset:12288
    v_mfma_f32_16x16x32_bf16 v[44:47], v[108:111], v[92:95], v[44:47]
    ds_read_b64_tr_b16 v[144:145], v16 offset:8192
    v_mfma_f32_16x16x32_bf16 v[48:51], v[112:115], v[92:95], v[48:51]
    ds_read_b64_tr_b16 v[146:147], v16 offset:12288
    v_mfma_f32_16x16x32_bf16 v[52:55], v[116:119], v[92:95], v[52:55]
    ds_read_b64_tr_b16 v[148:149], v17 offset:8192
    v_mfma_f32_16x16x32_bf16 v[56:59], v[104:107], v[96:99], v[56:59]
    ds_read_b64_tr_b16 v[150:151], v17 offset:12288
    v_mfma_f32_16x16x32_bf16 v[60:63], v[108:111], v[96:99], v[60:63]
    ds_read_b128 v[124:127], v9 offset:9216
    v_mfma_f32_16x16x32_bf16 v[64:67], v[112:115], v[96:99], v[64:67]
    ds_read_b128 v[128:131], v9 offset:10240
    v_mfma_f32_16x16x32_bf16 v[68:71], v[116:119], v[96:99], v[68:71]
    ds_read_b128 v[132:135], v9 offset:11264
    v_mfma_f32_16x16x32_bf16 v[72:75], v[104:107], v[100:103], v[72:75]
    v_mfma_f32_16x16x32_bf16 v[76:79], v[108:111], v[100:103], v[76:79]
    v_mfma_f32_16x16x32_bf16 v[80:83], v[112:115], v[100:103], v[80:83]
    v_mfma_f32_16x16x32_bf16 v[84:87], v[116:119], v[100:103], v[84:87]
    s_waitcnt lgkmcnt(0)
    s_barrier
    v_mfma_f32_16x16x32_bf16 v[24:27], v[136:139], v[120:123], v[24:27]
    ds_read_b128 v[88:91], v8 offset:32768
    v_mfma_f32_16x16x32_bf16 v[28:31], v[140:143], v[120:123], v[28:31]
    ds_read_b64_tr_b16 v[104:105], v10 offset:32768
    v_mfma_f32_16x16x32_bf16 v[32:35], v[144:147], v[120:123], v[32:35]
    ds_read_b64_tr_b16 v[106:107], v10 offset:36864
    v_mfma_f32_16x16x32_bf16 v[36:39], v[148:151], v[120:123], v[36:39]
    ds_read_b64_tr_b16 v[108:109], v11 offset:32768
    v_mfma_f32_16x16x32_bf16 v[40:43], v[136:139], v[124:127], v[40:43]
    ds_read_b64_tr_b16 v[110:111], v11 offset:36864
    v_mfma_f32_16x16x32_bf16 v[44:47], v[140:143], v[124:127], v[44:47]
    ds_read_b64_tr_b16 v[112:113], v12 offset:32768
    v_mfma_f32_16x16x32_bf16 v[48:51], v[144:147], v[124:127], v[48:51]
    ds_read_b64_tr_b16 v[114:115], v12 offset:36864
    v_mfma_f32_16x16x32_bf16 v[52:55], v[148:151], v[124:127], v[52:55]
    ds_read_b64_tr_b16 v[116:117], v13 offset:32768
    v_mfma_f32_16x16x32_bf16 v[56:59], v[136:139], v[128:131], v[56:59]
    ds_read_b64_tr_b16 v[118:119], v13 offset:36864
    v_mfma_f32_16x16x32_bf16 v[60:63], v[140:143], v[128:131], v[60:63]
    ds_read_b128 v[92:95], v8 offset:33792
    v_mfma_f32_16x16x32_bf16 v[64:67], v[144:147], v[128:131], v[64:67]
    ds_read_b128 v[96:99], v8 offset:34816
    v_mfma_f32_16x16x32_bf16 v[68:71], v[148:151], v[128:131], v[68:71]
    ds_read_b128 v[100:103], v8 offset:35840
    v_mfma_f32_16x16x32_bf16 v[72:75], v[136:139], v[132:135], v[72:75]
    v_mfma_f32_16x16x32_bf16 v[76:79], v[140:143], v[132:135], v[76:79]
    v_mfma_f32_16x16x32_bf16 v[80:83], v[144:147], v[132:135], v[80:83]
    v_mfma_f32_16x16x32_bf16 v[84:87], v[148:151], v[132:135], v[84:87]
    s_waitcnt lgkmcnt(0)
    v_mfma_f32_16x16x32_bf16 v[24:27], v[104:107], v[88:91], v[24:27]
    ds_read_b128 v[120:123], v8 offset:40960
    v_mfma_f32_16x16x32_bf16 v[28:31], v[108:111], v[88:91], v[28:31]
    ds_read_b64_tr_b16 v[136:137], v10 offset:40960
    v_mfma_f32_16x16x32_bf16 v[32:35], v[112:115], v[88:91], v[32:35]
    ds_read_b64_tr_b16 v[138:139], v10 offset:45056
    v_mfma_f32_16x16x32_bf16 v[36:39], v[116:119], v[88:91], v[36:39]
    ds_read_b64_tr_b16 v[140:141], v11 offset:40960
    v_mfma_f32_16x16x32_bf16 v[40:43], v[104:107], v[92:95], v[40:43]
    ds_read_b64_tr_b16 v[142:143], v11 offset:45056
    v_mfma_f32_16x16x32_bf16 v[44:47], v[108:111], v[92:95], v[44:47]
    ds_read_b64_tr_b16 v[144:145], v12 offset:40960
    v_mfma_f32_16x16x32_bf16 v[48:51], v[112:115], v[92:95], v[48:51]
    ds_read_b64_tr_b16 v[146:147], v12 offset:45056
    v_mfma_f32_16x16x32_bf16 v[52:55], v[116:119], v[92:95], v[52:55]
    ds_read_b64_tr_b16 v[148:149], v13 offset:40960
    v_mfma_f32_16x16x32_bf16 v[56:59], v[104:107], v[96:99], v[56:59]
    ds_read_b64_tr_b16 v[150:151], v13 offset:45056
    v_mfma_f32_16x16x32_bf16 v[60:63], v[108:111], v[96:99], v[60:63]
    ds_read_b128 v[124:127], v8 offset:41984
    v_mfma_f32_16x16x32_bf16 v[64:67], v[112:115], v[96:99], v[64:67]
    ds_read_b128 v[128:131], v8 offset:43008
    v_mfma_f32_16x16x32_bf16 v[68:71], v[116:119], v[96:99], v[68:71]
    ds_read_b128 v[132:135], v8 offset:44032
    v_mfma_f32_16x16x32_bf16 v[72:75], v[104:107], v[100:103], v[72:75]
    v_mfma_f32_16x16x32_bf16 v[76:79], v[108:111], v[100:103], v[76:79]
    v_mfma_f32_16x16x32_bf16 v[80:83], v[112:115], v[100:103], v[80:83]
    v_mfma_f32_16x16x32_bf16 v[84:87], v[116:119], v[100:103], v[84:87]
    s_cmp_lg_u32 s50, 0
    s_cbranch_scc1 L_g2_np1
    s_waitcnt vmcnt(0)
    v_readfirstlane_b32 s50, v18
    s_cmp_eq_u32 s50, 0
    s_cbranch_scc1 L_g2_np1
    s_add_u32 s47, s48, 0
    buffer_load_dwordx4 v[152:155], v3, s[8:11], s47 offen offset:0 sc1
    buffer_load_dwordx4 v[156:159], v3, s[8:11], s47 offen offset:1024 sc1
    buffer_load_dwordx4 v[160:163], v3, s[8:11], s47 offen offset:2048 sc1
    buffer_load_dwordx4 v[164:167], v3, s[8:11], s47 offen offset:3072 sc1
    s_add_u32 s47, s48, 4096
    buffer_load_dwordx4 v[168:171], v3, s[8:11], s47 offen offset:0 sc1
    buffer_load_dwordx4 v[172:175], v3, s[8:11], s47 offen offset:1024 sc1
    buffer_load_dwordx4 v[176:179], v3, s[8:11], s47 offen offset:2048 sc1
    buffer_load_dwordx4 v[180:183], v3, s[8:11], s47 offen offset:3072 sc1
    s_add_u32 s47, s48, 8192
    buffer_load_dwordx4 v[184:187], v3, s[8:11], s47 offen offset:0 sc1
    buffer_load_dwordx4 v[188:191], v3, s[8:11], s47 offen offset:1024 sc1
    buffer_load_dwordx4 v[192:195], v3, s[8:11], s47 offen offset:2048 sc1
    buffer_load_dwordx4 v[196:199], v3, s[8:11], s47 offen offset:3072 sc1
    s_add_u32 s47, s48, 12288
    buffer_load_dwordx4 v[200:203], v3, s[8:11], s47 offen offset:0 sc1
    buffer_load_dwordx4 v[204:207], v3, s[8:11], s47 offen offset:1024 sc1
    buffer_load_dwordx4 v[208:211], v3, s[8:11], s47 offen offset:2048 sc1
    buffer_load_dwordx4 v[212:215], v3, s[8:11], s47 offen offset:3072 sc1
L_g2_np1:
    s_waitcnt lgkmcnt(0)
    s_barrier
    v_mfma_f32_16x16x32_bf16 v[24:27], v[136:139], v[120:123], v[24:27]
    ds_read_b128 v[88:91], v9 offset:32768
    v_mfma_f32_16x16x32_bf16 v[28:31], v[140:143], v[120:123], v[28:31]
    ds_read_b64_tr_b16 v[104:105], v14 offset:32768
    v_mfma_f32_16x16x32_bf16 v[32:35], v[144:147], v[120:123], v[32:35]
    ds_read_b64_tr_b16 v[106:107], v14 offset:36864
    v_mfma_f32_16x16x32_bf16 v[36:39], v[148:151], v[120:123], v[36:39]
    ds_read_b64_tr_b16 v[108:109], v15 offset:32768
    v_mfma_f32_16x16x32_bf16 v[40:43], v[136:139], v[124:127], v[40:43]
    ds_read_b64_tr_b16 v[110:111], v15 offset:36864
    v_mfma_f32_16x16x32_bf16 v[44:47], v[140:143], v[124:127], v[44:47]
    ds_read_b64_tr_b16 v[112:113], v16 offset:32768
    v_mfma_f32_16x16x32_bf16 v[48:51], v[144:147], v[124:127], v[48:51]
    ds_read_b64_tr_b16 v[114:115], v16 offset:36864
    v_mfma_f32_16x16x32_bf16 v[52:55], v[148:151], v[124:127], v[52:55]
    ds_read_b64_tr_b16 v[116:117], v17 offset:32768
    v_mfma_f32_16x16x32_bf16 v[56:59], v[136:139], v[128:131], v[56:59]
    ds_read_b64_tr_b16 v[118:119], v17 offset:36864
    v_mfma_f32_16x16x32_bf16 v[60:63], v[140:143], v[128:131], v[60:63]
    ds_read_b128 v[92:95], v9 offset:33792
    v_mfma_f32_16x16x32_bf16 v[64:67], v[144:147], v[128:131], v[64:67]
    ds_read_b128 v[96:99], v9 offset:34816
    v_mfma_f32_16x16x32_bf16 v[68:71], v[148:151], v[128:131], v[68:71]
    ds_read_b128 v[100:103], v9 offset:35840
    v_mfma_f32_16x16x32_bf16 v[72:75], v[136:139], v[132:135], v[72:75]
    v_mfma_f32_16x16x32_bf16 v[76:79], v[140:143], v[132:135], v[76:79]
    v_mfma_f32_16x16x32_bf16 v[80:83], v[144:147], v[132:135], v[80:83]
    v_mfma_f32_16x16x32_bf16 v[84:87], v[148:151], v[132:135], v[84:87]
    s_waitcnt lgkmcnt(0)
    v_mfma_f32_16x16x32_bf16 v[24:27], v[104:107], v[88:91], v[24:27]
    ds_read_b128 v[120:123], v9 offset:40960
    v_mfma_f32_16x16x32_bf16 v[28:31], v[108:111], v[88:91], v[28:31]
    ds_read_b64_tr_b16 v[136:137], v14 offset:40960
    v_mfma_f32_16x16x32_bf16 v[32:35], v[112:115], v[88:91], v[32:35]
    ds_read_b64_tr_b16 v[138:139], v14 offset:45056
    v_mfma_f32_16x16x32_bf16 v[36:39], v[116:119], v[88:91], v[36:39]
    ds_read_b64_tr_b16 v[140:141], v15 offset:40960
    v_mfma_f32_16x16x32_bf16 v[40:43], v[104:107], v[92:95], v[40:43]
    ds_read_b64_tr_b16 v[142:143], v15 offset:45056
    v_mfma_f32_16x16x32_bf16 v[44:47], v[108:111], v[92:95], v[44:47]
    ds_read_b64_tr_b16 v[144:145], v16 offset:40960
    v_mfma_f32_16x16x32_bf16 v[48:51], v[112:115], v[92:95], v[48:51]
    ds_read_b64_tr_b16 v[146:147], v16 offset:45056
    v_mfma_f32_16x16x32_bf16 v[52:55], v[116:119], v[92:95], v[52:55]
    ds_read_b64_tr_b16 v[148:149], v17 offset:40960
    v_mfma_f32_16x16x32_bf16 v[56:59], v[104:107], v[96:99], v[56:59]
    ds_read_b64_tr_b16 v[150:151], v17 offset:45056
    v_mfma_f32_16x16x32_bf16 v[60:63], v[108:111], v[96:99], v[60:63]
    ds_read_b128 v[124:127], v9 offset:41984
    v_mfma_f32_16x16x32_bf16 v[64:67], v[112:115], v[96:99], v[64:67]
    ds_read_b128 v[128:131], v9 offset:43008
    v_mfma_f32_16x16x32_bf16 v[68:71], v[116:119], v[96:99], v[68:71]
    ds_read_b128 v[132:135], v9 offset:44032
    v_mfma_f32_16x16x32_bf16 v[72:75], v[104:107], v[100:103], v[72:75]
    v_mfma_f32_16x16x32_bf16 v[76:79], v[108:111], v[100:103], v[76:79]
    v_mfma_f32_16x16x32_bf16 v[80:83], v[112:115], v[100:103], v[80:83]
    v_mfma_f32_16x16x32_bf16 v[84:87], v[116:119], v[100:103], v[84:87]
    s_waitcnt lgkmcnt(0)
    v_mfma_f32_16x16x32_bf16 v[24:27], v[136:139], v[120:123], v[24:27]
    v_mfma_f32_16x16x32_bf16 v[28:31], v[140:143], v[120:123], v[28:31]
    v_mfma_f32_16x16x32_bf16 v[32:35], v[144:147], v[120:123], v[32:35]
    v_mfma_f32_16x16x32_bf16 v[36:39], v[148:151], v[120:123], v[36:39]
    v_mfma_f32_16x16x32_bf16 v[40:43], v[136:139], v[124:127], v[40:43]
    v_mfma_f32_16x16x32_bf16 v[44:47], v[140:143], v[124:127], v[44:47]
    v_mfma_f32_16x16x32_bf16 v[48:51], v[144:147], v[124:127], v[48:51]
    v_mfma_f32_16x16x32_bf16 v[52:55], v[148:151], v[124:127], v[52:55]
    v_mfma_f32_16x16x32_bf16 v[56:59], v[136:139], v[128:131], v[56:59]
    v_mfma_f32_16x16x32_bf16 v[60:63], v[140:143], v[128:131], v[60:63]
    v_mfma_f32_16x16x32_bf16 v[64:67], v[144:147], v[128:131], v[64:67]
    v_mfma_f32_16x16x32_bf16 v[68:71], v[148:151], v[128:131], v[68:71]
    v_mfma_f32_16x16x32_bf16 v[72:75], v[136:139], v[132:135], v[72:75]
    v_mfma_f32_16x16x32_bf16 v[76:79], v[140:143], v[132:135], v[76:79]
    v_mfma_f32_16x16x32_bf16 v[80:83], v[144:147], v[132:135], v[80:83]
    v_mfma_f32_16x16x32_bf16 v[84:87], v[148:151], v[132:135], v[84:87]
    s_cmp_lg_u32 s50, 0
    s_cbranch_scc1 L_g2_np2
L_g2_poll1:
    buffer_load_dword v18, v21, s[8:11], s49 offen sc1
    s_waitcnt vmcnt(0)
    v_readfirstlane_b32 s50, v18
    s_cmp_lg_u32 s50, 0
    s_cbranch_scc1 L_g2_poll2
    s_sleep 2
    s_branch L_g2_poll1
L_g2_poll2:
    s_add_u32 s47, s48, 0
    buffer_load_dwordx4 v[152:155], v3, s[8:11], s47 offen offset:0 sc1
    buffer_load_dwordx4 v[156:159], v3, s[8:11], s47 offen offset:1024 sc1
    buffer_load_dwordx4 v[160:163], v3, s[8:11], s47 offen offset:2048 sc1
    buffer_load_dwordx4 v[164:167], v3, s[8:11], s47 offen offset:3072 sc1
    s_add_u32 s47, s48, 4096
    buffer_load_dwordx4 v[168:171], v3, s[8:11], s47 offen offset:0 sc1
    buffer_load_dwordx4 v[172:175], v3, s[8:11], s47 offen offset:1024 sc1
    buffer_load_dwordx4 v[176:179], v3, s[8:11], s47 offen offset:2048 sc1
    buffer_load_dwordx4 v[180:183], v3, s[8:11], s47 offen offset:3072 sc1
    s_add_u32 s47, s48, 8192
    buffer_load_dwordx4 v[184:187], v3, s[8:11], s47 offen offset:0 sc1
    buffer_load_dwordx4 v[188:191], v3, s[8:11], s47 offen offset:1024 sc1
    buffer_load_dwordx4 v[192:195], v3, s[8:11], s47 offen offset:2048 sc1
    buffer_load_dwordx4 v[196:199], v3, s[8:11], s47 offen offset:3072 sc1
    s_add_u32 s47, s48, 12288
    buffer_load_dwordx4 v[200:203], v3, s[8:11], s47 offen offset:0 sc1
    buffer_load_dwordx4 v[204:207], v3, s[8:11], s47 offen offset:1024 sc1
    buffer_load_dwordx4 v[208:211], v3, s[8:11], s47 offen offset:2048 sc1
    buffer_load_dwordx4 v[212:215], v3, s[8:11], s47 offen offset:3072 sc1
L_g2_np2:
    s_nop 7
    s_cmp_lg_u32 s31, 0
    s_cbranch_scc1 L_g2_fin
    s_add_u32 s47, s48, 0
    buffer_store_dwordx4 v[24:27], v3, s[8:11], s47 offen offset:0 sc1
    buffer_store_dwordx4 v[28:31], v3, s[8:11], s47 offen offset:1024 sc1
    buffer_store_dwordx4 v[32:35], v3, s[8:11], s47 offen offset:2048 sc1
    buffer_store_dwordx4 v[36:39], v3, s[8:11], s47 offen offset:3072 sc1
    s_add_u32 s47, s48, 4096
    buffer_store_dwordx4 v[40:43], v3, s[8:11], s47 offen offset:0 sc1
    buffer_store_dwordx4 v[44:47], v3, s[8:11], s47 offen offset:1024 sc1
    buffer_store_dwordx4 v[48:51], v3, s[8:11], s47 offen offset:2048 sc1
    buffer_store_dwordx4 v[52:55], v3, s[8:11], s47 offen offset:3072 sc1
    s_add_u32 s47, s48, 8192
    buffer_store_dwordx4 v[56:59], v3, s[8:11], s47 offen offset:0 sc1
    buffer_store_dwordx4 v[60:63], v3, s[8:11], s47 offen offset:1024 sc1
    buffer_store_dwordx4 v[64:67], v3, s[8:11], s47 offen offset:2048 sc1
    buffer_store_dwordx4 v[68:71], v3, s[8:11], s47 offen offset:3072 sc1
    s_add_u32 s47, s48, 12288
    buffer_store_dwordx4 v[72:75], v3, s[8:11], s47 offen offset:0 sc1
    buffer_store_dwordx4 v[76:79], v3, s[8:11], s47 offen offset:1024 sc1
    buffer_store_dwordx4 v[80:83], v3, s[8:11], s47 offen offset:2048 sc1
    buffer_store_dwordx4 v[84:87], v3, s[8:11], s47 offen offset:3072 sc1
    v_mov_b32 v22, 1
    s_waitcnt vmcnt(0)
    s_mov_b64 exec, 1
    buffer_store_dword v22, v21, s[8:11], s49 offen sc1
    s_mov_b64 exec, -1
    s_endpgm
L_g2_fin:
    s_mov_b32 s16, s26
    s_mov_b32 s17, s27
    s_mov_b32 s18, 0x400000
    s_mov_b32 s19, 0x00020000
    s_waitcnt vmcnt(12)
    v_pk_add_f32 v[24:25], v[24:25], v[152:153]
    v_pk_add_f32 v[26:27], v[26:27], v[154:155]
    v_pk_add_f32 v[28:29], v[28:29], v[156:157]
    v_pk_add_f32 v[30:31], v[30:31], v[158:159]
    v_pk_add_f32 v[32:33], v[32:33], v[160:161]
    v_pk_add_f32 v[34:35], v[34:35], v[162:163]
    v_pk_add_f32 v[36:37], v[36:37], v[164:165]
    v_pk_add_f32 v[38:39], v[38:39], v[166:167]
    s_add_u32 s47, s39, 0
    v_cvt_pk_bf16_f32 v88, v24, v25
    v_cvt_pk_bf16_f32 v89, v26, v27
    v_cvt_pk_bf16_f32 v90, v28, v29
    v_cvt_pk_bf16_f32 v91, v30, v31
    s_nop 1
    v_permlane16_swap_b32 v88, v90
    v_permlane16_swap_b32 v89, v91
    buffer_store_dwordx4 v[88:91], v6, s[16:19], s47 offen offset:0 sc1
    v_cvt_pk_bf16_f32 v92, v32, v33
    v_cvt_pk_bf16_f32 v93, v34, v35
    v_cvt_pk_bf16_f32 v94, v36, v37
    v_cvt_pk_bf16_f32 v95, v38, v39
    s_nop 1
    v_permlane16_swap_b32 v92, v94
    v_permlane16_swap_b32 v93, v95
    buffer_store_dwordx4 v[92:95], v6, s[16:19], s47 offen offset:64 sc1
    s_waitcnt vmcnt(10)
    v_pk_add_f32 v[40:41], v[40:41], v[168:169]
    v_pk_add_f32 v[42:43], v[42:43], v[170:171]
    v_pk_add_f32 v[44:45], v[44:45], v[172:173]
    v_pk_add_f32 v[46:47], v[46:47], v[174:175]
    v_pk_add_f32 v[48:49], v[48:49], v[176:177]
    v_pk_add_f32 v[50:51], v[50:51], v[178:179]
    v_pk_add_f32 v[52:53], v[52:53], v[180:181]
    v_pk_add_f32 v[54:55], v[54:55], v[182:183]
    s_add_u32 s47, s39, 32768
    v_cvt_pk_bf16_f32 v96, v40, v41
    v_cvt_pk_bf16_f32 v97, v42, v43
    v_cvt_pk_bf16_f32 v98, v44, v45
    v_cvt_pk_bf16_f32 v99, v46, v47
    s_nop 1
    v_permlane16_swap_b32 v96, v98
    v_permlane16_swap_b32 v97, v99
    buffer_store_dwordx4 v[96:99], v6, s[16:19], s47 offen offset:0 sc1
    v_cvt_pk_bf16_f32 v100, v48, v49
    v_cvt_pk_bf16_f32 v101, v50, v51
    v_cvt_pk_bf16_f32 v102, v52, v53
    v_cvt_pk_bf16_f32 v103, v54, v55
    s_nop 1
    v_permlane16_swap_b32 v100, v102
    v_permlane16_swap_b32 v101, v103
    buffer_store_dwordx4 v[100:103], v6, s[16:19], s47 offen offset:64 sc1
    s_waitcnt vmcnt(8)
    v_pk_add_f32 v[56:57], v[56:57], v[184:185]
    v_pk_add_f32 v[58:59], v[58:59], v[186:187]
    v_pk_add_f32 v[60:61], v[60:61], v[188:189]
    v_pk_add_f32 v[62:63], v[62:63], v[190:191]
    v_pk_add_f32 v[64:65], v[64:65], v[192:193]
    v_pk_add_f32 v[66:67], v[66:67], v[194:195]
    v_pk_add_f32 v[68:69], v[68:69], v[196:197]
    v_pk_add_f32 v[70:71], v[70:71], v[198:199]
    s_add_u32 s47, s39, 65536
    v_cvt_pk_bf16_f32 v104, v56, v57
    v_cvt_pk_bf16_f32 v105, v58, v59
    v_cvt_pk_bf16_f32 v106, v60, v61
    v_cvt_pk_bf16_f32 v107, v62, v63
    s_nop 1
    v_permlane16_swap_b32 v104, v106
    v_permlane16_swap_b32 v105, v107
    buffer_store_dwordx4 v[104:107], v6, s[16:19], s47 offen offset:0 sc1
    v_cvt_pk_bf16_f32 v108, v64, v65
    v_cvt_pk_bf16_f32 v109, v66, v67
    v_cvt_pk_bf16_f32 v110, v68, v69
    v_cvt_pk_bf16_f32 v111, v70, v71
    s_nop 1
    v_permlane16_swap_b32 v108, v110
    v_permlane16_swap_b32 v109, v111
    buffer_store_dwordx4 v[108:111], v6, s[16:19], s47 offen offset:64 sc1
    s_waitcnt vmcnt(6)
    v_pk_add_f32 v[72:73], v[72:73], v[200:201]
    v_pk_add_f32 v[74:75], v[74:75], v[202:203]
    v_pk_add_f32 v[76:77], v[76:77], v[204:205]
    v_pk_add_f32 v[78:79], v[78:79], v[206:207]
    v_pk_add_f32 v[80:81], v[80:81], v[208:209]
    v_pk_add_f32 v[82:83], v[82:83], v[210:211]
    v_pk_add_f32 v[84:85], v[84:85], v[212:213]
    v_pk_add_f32 v[86:87], v[86:87], v[214:215]
    s_add_u32 s47, s39, 98304
    v_cvt_pk_bf16_f32 v112, v72, v73
    v_cvt_pk_bf16_f32 v113, v74, v75
    v_cvt_pk_bf16_f32 v114, v76, v77
    v_cvt_pk_bf16_f32 v115, v78, v79
    s_nop 1
    v_permlane16_swap_b32 v112, v114
    v_permlane16_swap_b32 v113, v115
    buffer_store_dwordx4 v[112:115], v6, s[16:19], s47 offen offset:0 sc1
    v_cvt_pk_bf16_f32 v116, v80, v81
    v_cvt_pk_bf16_f32 v117, v82, v83
    v_cvt_pk_bf16_f32 v118, v84, v85
    v_cvt_pk_bf16_f32 v119, v86, v87
    s_nop 1
    v_permlane16_swap_b32 v116, v118
    v_permlane16_swap_b32 v117, v119
    buffer_store_dwordx4 v[116:119], v6, s[16:19], s47 offen offset:64 sc1
    s_endpgm
L_g2_loader:
    s_setprio 3
    s_add_u32 s38, s27, s26
    s_add_u32 s39, s27, 128
    s_cmp_eq_u32 s31, 0
    s_cselect_b32 s38, s38, s27
    s_cselect_b32 s39, s27, s39
    s_cselect_b32 s41, 4, 16
    s_cselect_b32 s46, 10, 16
    s_cmp_eq_u32 s68, 0
    s_cbranch_scc1 L_g2_hchk
    v_mov_b32 v22, 0
    s_waitcnt vmcnt(16)
    s_barrier
    s_branch L_g2_lloop
L_g2_hpoll:
    s_sleep 8
    buffer_load_dword v22, v21, s[52:55], s38 offen sc1
    s_waitcnt vmcnt(0)
L_g2_hchk:
    v_readfirstlane_b32 s40, v22
    s_cmp_lt_u32 s40, s41
    s_cbranch_scc1 L_g2_hpoll
    v_mov_b32 v22, 0
    s_add_u32 m0, s35, 0
    s_nop 0
    buffer_load_dwordx4 v19, s[12:15], s56 offen offset:0 lds
    buffer_load_dwordx4 v19, s[12:15], s56 offen offset:1024 lds
    buffer_load_dwordx4 v19, s[12:15], s56 offen offset:2048 lds
    buffer_load_dwordx4 v19, s[12:15], s56 offen offset:3072 lds
    s_add_u32 s56, s56, 0x40000
    s_cmp_ge_u32 s56, s58
    s_cselect_b32 s34, s58, 0
    s_sub_u32 s56, s56, s34
    s_add_u32 m0, s35, 65536
    s_nop 0
    buffer_load_dwordx4 v19, s[12:15], s56 offen offset:0 lds
    buffer_load_dwordx4 v19, s[12:15], s56 offen offset:1024 lds
    buffer_load_dwordx4 v19, s[12:15], s56 offen offset:2048 lds
    buffer_load_dwordx4 v19, s[12:15], s56 offen offset:3072 lds
    s_add_u32 s56, s56, 0x40000
    s_cmp_ge_u32 s56, s58
    s_cselect_b32 s34, s58, 0
    s_sub_u32 s56, s56, s34
    s_add_u32 m0, s35, 32768
    s_nop 0
    buffer_load_dwordx4 v19, s[12:15], s56 offen offset:0 lds
    buffer_load_dwordx4 v19, s[12:15], s56 offen offset:1024 lds
    buffer_load_dwordx4 v19, s[12:15], s56 offen offset:2048 lds
    buffer_load_dwordx4 v19, s[12:15], s56 offen offset:3072 lds
    s_add_u32 s56, s56, 0x40000
    s_cmp_ge_u32 s56, s58
    s_cselect_b32 s34, s58, 0
    s_sub_u32 s56, s56, s34
    s_add_u32 m0, s35, 98304
    s_nop 0
    buffer_load_dwordx4 v19, s[12:15], s56 offen offset:0 lds
    buffer_load_dwordx4 v19, s[12:15], s56 offen offset:1024 lds
    buffer_load_dwordx4 v19, s[12:15], s56 offen offset:2048 lds
    buffer_load_dwordx4 v19, s[12:15], s56 offen offset:3072 lds
    s_add_u32 s56, s56, 0x40000
    s_cmp_ge_u32 s56, s58
    s_cselect_b32 s34, s58, 0
    s_sub_u32 s56, s56, s34
    s_waitcnt vmcnt(12)
    s_barrier
    s_waitcnt vmcnt(8)
    s_barrier
    s_add_u32 m0, s35, 16384
    s_nop 0
    buffer_load_dwordx4 v24, s[8:11], s57 offen offset:0 lds
    buffer_load_dwordx4 v26, s[8:11], s57 offen offset:2048 lds
    s_add_u32 m0, s35, 17408
    s_nop 0
    buffer_load_dwordx4 v25, s[8:11], s57 offen offset:0 lds
    buffer_load_dwordx4 v27, s[8:11], s57 offen offset:2048 lds
    s_add_u32 s57, s57, 0x20000
    s_cmp_eq_u32 s57, 0x700000
    s_cselect_b32 s57, 0, s57
    s_add_u32 m0, s35, 0
    s_nop 0
    buffer_load_dwordx4 v19, s[12:15], s56 offen offset:0 lds
    buffer_load_dwordx4 v19, s[12:15], s56 offen offset:1024 lds
    buffer_load_dwordx4 v19, s[12:15], s56 offen offset:2048 lds
    buffer_load_dwordx4 v19, s[12:15], s56 offen offset:3072 lds
    s_add_u32 s56, s56, 0x40000
    s_cmp_ge_u32 s56, s58
    s_cselect_b32 s34, s58, 0
    s_sub_u32 s56, s56, s34
    s_sub_u32 s46, s46, 1
    s_and_b32 s34, s46, 0xfffffffb
    s_cbranch_scc0 L_g2o_47
L_g2o_48:
    s_waitcnt vmcnt(12)
    s_barrier
    s_add_u32 m0, s35, 81920
    s_nop 0
    buffer_load_dwordx4 v24, s[8:11], s57 offen offset:0 lds
    buffer_load_dwordx4 v26, s[8:11], s57 offen offset:2048 lds
    s_add_u32 m0, s35, 82944
    s_nop 0
    buffer_load_dwordx4 v25, s[8:11], s57 offen offset:0 lds
    buffer_load_dwordx4 v27, s[8:11], s57 offen offset:2048 lds
    s_add_u32 s57, s57, 0x20000
    s_cmp_eq_u32 s57, 0x700000
    s_cselect_b32 s57, 0, s57
    s_add_u32 m0, s35, 65536
    s_nop 0
    buffer_load_dwordx4 v19, s[12:15], s56 offen offset:0 lds
    buffer_load_dwordx4 v19, s[12:15], s56 offen offset:1024 lds
    buffer_load_dwordx4 v19, s[12:15], s56 offen offset:2048 lds
    buffer_load_dwordx4 v19, s[12:15], s56 offen offset:3072 lds
    s_add_u32 s56, s56, 0x40000
    s_cmp_ge_u32 s56, s58
    s_cselect_b32 s34, s58, 0
    s_sub_u32 s56, s56, s34
    s_sub_u32 s46, s46, 1
    s_and_b32 s34, s46, 0xfffffffb
    s_cbranch_scc0 L_g2o_51
L_g2o_52:
    s_waitcnt vmcnt(16)
    s_barrier
    s_add_u32 m0, s35, 49152
    s_nop 0
    buffer_load_dwordx4 v24, s[8:11], s57 offen offset:0 lds
    buffer_load_dwordx4 v26, s[8:11], s57 offen offset:2048 lds
    s_add_u32 m0, s35, 50176
    s_nop 0
    buffer_load_dwordx4 v25, s[8:11], s57 offen offset:0 lds
    buffer_load_dwordx4 v27, s[8:11], s57 offen offset:2048 lds
    s_add_u32 s57, s57, 0x20000
    s_cmp_eq_u32 s57, 0x700000
    s_cselect_b32 s57, 0, s57
    s_add_u32 m0, s35, 32768
    s_nop 0
    buffer_load_dwordx4 v19, s[12:15], s56 offen offset:0 lds
    buffer_load_dwordx4 v19, s[12:15], s56 offen offset:1024 lds
    buffer_load_dwordx4 v19, s[12:15], s56 offen offset:2048 lds
    buffer_load_dwordx4 v19, s[12:15], s56 offen offset:3072 lds
    s_add_u32 s56, s56, 0x40000
    s_cmp_ge_u32 s56, s58
    s_cselect_b32 s34, s58, 0
    s_sub_u32 s56, s56, s34
    s_sub_u32 s46, s46, 1
    s_and_b32 s34, s46, 0xfffffffb
    s_cbranch_scc0 L_g2o_55
L_g2o_56:
    s_waitcnt vmcnt(16)
    s_barrier
    s_add_u32 m0, s35, 114688
    s_nop 0
    buffer_load_dwordx4 v24, s[8:11], s57 offen offset:0 lds
    buffer_load_dwordx4 v26, s[8:11], s57 offen offset:2048 lds
    s_add_u32 m0, s35, 115712
    s_nop 0
    buffer_load_dwordx4 v25, s[8:11], s57 offen offset:0 lds
    buffer_load_dwordx4 v27, s[8:11], s57 offen offset:2048 lds
    s_add_u32 s57, s57, 0x20000
    s_cmp_eq_u32 s57, 0x700000
    s_cselect_b32 s57, 0, s57
    s_add_u32 m0, s35, 98304
    s_nop 0
    buffer_load_dwordx4 v19, s[12:15], s56 offen offset:0 lds
    buffer_load_dwordx4 v19, s[12:15], s56 offen offset:1024 lds
    buffer_load_dwordx4 v19, s[12:15], s56 offen offset:2048 lds
    buffer_load_dwordx4 v19, s[12:15], s56 offen offset:3072 lds
    s_add_u32 s56, s56, 0x40000
    s_cmp_ge_u32 s56, s58
    s_cselect_b32 s34, s58, 0
    s_sub_u32 s56, s56, s34
    s_sub_u32 s46, s46, 1
    s_and_b32 s34, s46, 0xfffffffb
    s_cbranch_scc0 L_g2o_59
L_g2o_60:
    s_sub_u32 s44, s44, 1
L_g2_lloop:
    s_waitcnt vmcnt(16)
    s_barrier
    s_add_u32 m0, s35, 16384
    s_nop 0
    buffer_load_dwordx4 v24, s[8:11], s57 offen offset:0 lds
    buffer_load_dwordx4 v26, s[8:11], s57 offen offset:2048 lds
    s_add_u32 m0, s35, 17408
    s_nop 0
    buffer_load_dwordx4 v25, s[8:11], s57 offen offset:0 lds
    buffer_load_dwordx4 v27, s[8:11], s57 offen offset:2048 lds
    s_add_u32 s57, s57, 0x20000
    s_cmp_eq_u32 s57, 0x700000
    s_cselect_b32 s57, 0, s57
    s_add_u32 m0, s35, 0
    s_nop 0
    buffer_load_dwordx4 v19, s[12:15], s56 offen offset:0 lds
    buffer_load_dwordx4 v19, s[12:15], s56 offen offset:1024 lds
    buffer_load_dwordx4 v19, s[12:15], s56 offen offset:2048 lds
    buffer_load_dwordx4 v19, s[12:15], s56 offen offset:3072 lds
    s_add_u32 s56, s56, 0x40000
    s_cmp_ge_u32 s56, s58
    s_cselect_b32 s34, s58, 0
    s_sub_u32 s56, s56, s34
    s_sub_u32 s46, s46, 1
    s_and_b32 s34, s46, 0xfffffffb
    s_cbranch_scc0 L_g2o_63
L_g2o_64:
    s_waitcnt vmcnt(16)
    s_barrier
    s_add_u32 m0, s35, 81920
    s_nop 0
    buffer_load_dwordx4 v24, s[8:11], s57 offen offset:0 lds
    buffer_load_dwordx4 v26, s[8:11], s57 offen offset:2048 lds
    s_add_u32 m0, s35, 82944
    s_nop 0
    buffer_load_dwordx4 v25, s[8:11], s57 offen offset:0 lds
    buffer_load_dwordx4 v27, s[8:11], s57 offen offset:2048 lds
    s_add_u32 s57, s57, 0x20000
    s_cmp_eq_u32 s57, 0x700000
    s_cselect_b32 s57, 0, s57
    s_add_u32 m0, s35, 65536
    s_nop 0
    buffer_load_dwordx4 v19, s[12:15], s56 offen offset:0 lds
    buffer_load_dwordx4 v19, s[12:15], s56 offen offset:1024 lds
    buffer_load_dwordx4 v19, s[12:15], s56 offen offset:2048 lds
    buffer_load_dwordx4 v19, s[12:15], s56 offen offset:3072 lds
    s_add_u32 s56, s56, 0x40000
    s_cmp_ge_u32 s56, s58
    s_cselect_b32 s34, s58, 0
    s_sub_u32 s56, s56, s34
    s_sub_u32 s46, s46, 1
    s_and_b32 s34, s46, 0xfffffffb
    s_cbranch_scc0 L_g2o_67
L_g2o_68:
    s_waitcnt vmcnt(16)
    s_barrier
    s_add_u32 m0, s35, 49152
    s_nop 0
    buffer_load_dwordx4 v24, s[8:11], s57 offen offset:0 lds
    buffer_load_dwordx4 v26, s[8:11], s57 offen offset:2048 lds
    s_add_u32 m0, s35, 50176
    s_nop 0
    buffer_load_dwordx4 v25, s[8:11], s57 offen offset:0 lds
    buffer_load_dwordx4 v27, s[8:11], s57 offen offset:2048 lds
    s_add_u32 s57, s57, 0x20000
    s_cmp_eq_u32 s57, 0x700000
    s_cselect_b32 s57, 0, s57
    s_add_u32 m0, s35, 32768
    s_nop 0
    buffer_load_dwordx4 v19, s[12:15], s56 offen offset:0 lds
    buffer_load_dwordx4 v19, s[12:15], s56 offen offset:1024 lds
    buffer_load_dwordx4 v19, s[12:15], s56 offen offset:2048 lds
    buffer_load_dwordx4 v19, s[12:15], s56 offen offset:3072 lds
    s_add_u32 s56, s56, 0x40000
    s_cmp_ge_u32 s56, s58
    s_cselect_b32 s34, s58, 0
    s_sub_u32 s56, s56, s34
    s_sub_u32 s46, s46, 1
    s_and_b32 s34, s46, 0xfffffffb
    s_cbranch_scc0 L_g2o_71
L_g2o_72:
    s_waitcnt vmcnt(16)
    s_barrier
    s_add_u32 m0, s35, 114688
    s_nop 0
    buffer_load_dwordx4 v24, s[8:11], s57 offen offset:0 lds
    buffer_load_dwordx4 v26, s[8:11], s57 offen offset:2048 lds
    s_add_u32 m0, s35, 115712
    s_nop 0
    buffer_load_dwordx4 v25, s[8:11], s57 offen offset:0 lds
    buffer_load_dwordx4 v27, s[8:11], s57 offen offset:2048 lds
    s_add_u32 s57, s57, 0x20000
    s_cmp_eq_u32 s57, 0x700000
    s_cselect_b32 s57, 0, s57
    s_add_u32 m0, s35, 98304
    s_nop 0
    buffer_load_dwordx4 v19, s[12:15], s56 offen offset:0 lds
    buffer_load_dwordx4 v19, s[12:15], s56 offen offset:1024 lds
    buffer_load_dwordx4 v19, s[12:15], s56 offen offset:2048 lds
    buffer_load_dwordx4 v19, s[12:15], s56 offen offset:3072 lds
    s_add_u32 s56, s56, 0x40000
    s_cmp_ge_u32 s56, s58
    s_cselect_b32 s34, s58, 0
    s_sub_u32 s56, s56, s34
    s_sub_u32 s46, s46, 1
    s_and_b32 s34, s46, 0xfffffffb
    s_cbranch_scc0 L_g2o_75
L_g2o_76:
    s_sub_u32 s44, s44, 1
    s_cmp_lg_u32 s44, 0
    s_cbranch_scc1 L_g2_lloop
    s_waitcnt vmcnt(16)
    s_barrier
    s_waitcnt vmcnt(8)
    s_barrier
    s_waitcnt vmcnt(0)
    s_barrier
    s_endpgm
L_g2o_47:
    s_cmp_eq_u32 s46, 0
    s_cbranch_scc1 L_g2o_49
    buffer_load_dword v22, v21, s[52:55], s39 offen sc1
    s_branch L_g2o_48
L_g2o_50:
    s_sleep 8
    buffer_load_dword v22, v21, s[52:55], s39 offen sc1
    s_waitcnt vmcnt(0)
L_g2o_49:
    v_readfirstlane_b32 s40, v22
    s_cmp_lt_u32 s40, 16
    s_cbranch_scc1 L_g2o_50
    s_cmp_eq_u32 s31, 0
    s_cbranch_scc1 L_g2o_48
    s_mov_b32 s8, s92
    s_mov_b32 s9, s93
    s_mov_b32 s10, 0x200000
    s_mov_b32 s11, 0x00020000
    s_mov_b32 s57, 0
    s_mov_b32 s56, s59
    s_mov_b32 s58, -1
    s_branch L_g2o_48
L_g2o_51:
    s_cmp_eq_u32 s46, 0
    s_cbranch_scc1 L_g2o_53
    buffer_load_dword v22, v21, s[52:55], s39 offen sc1
    s_branch L_g2o_52
L_g2o_54:
    s_sleep 8
    buffer_load_dword v22, v21, s[52:55], s39 offen sc1
    s_waitcnt vmcnt(0)
L_g2o_53:
    v_readfirstlane_b32 s40, v22
    s_cmp_lt_u32 s40, 16
    s_cbranch_scc1 L_g2o_54
    s_cmp_eq_u32 s31, 0
    s_cbranch_scc1 L_g2o_52
    s_mov_b32 s8, s92
    s_mov_b32 s9, s93
    s_mov_b32 s10, 0x200000
    s_mov_b32 s11, 0x00020000
    s_mov_b32 s57, 0
    s_mov_b32 s56, s59
    s_mov_b32 s58, -1
    s_branch L_g2o_52
L_g2o_55:
    s_cmp_eq_u32 s46, 0
    s_cbranch_scc1 L_g2o_57
    buffer_load_dword v22, v21, s[52:55], s39 offen sc1
    s_branch L_g2o_56
L_g2o_58:
    s_sleep 8
    buffer_load_dword v22, v21, s[52:55], s39 offen sc1
    s_waitcnt vmcnt(0)
L_g2o_57:
    v_readfirstlane_b32 s40, v22
    s_cmp_lt_u32 s40, 16
    s_cbranch_scc1 L_g2o_58
    s_cmp_eq_u32 s31, 0
    s_cbranch_scc1 L_g2o_56
    s_mov_b32 s8, s92
    s_mov_b32 s9, s93
    s_mov_b32 s10, 0x200000
    s_mov_b32 s11, 0x00020000
    s_mov_b32 s57, 0
    s_mov_b32 s56, s59
    s_mov_b32 s58, -1
    s_branch L_g2o_56
L_g2o_59:
    s_cmp_eq_u32 s46, 0
    s_cbranch_scc1 L_g2o_61
    buffer_load_dword v22, v21, s[52:55], s39 offen sc1
    s_branch L_g2o_60
L_g2o_62:
    s_sleep 8
    buffer_load_dword v22, v21, s[52:55], s39 offen sc1
    s_waitcnt vmcnt(0)
L_g2o_61:
    v_readfirstlane_b32 s40, v22
    s_cmp_lt_u32 s40, 16
    s_cbranch_scc1 L_g2o_62
    s_cmp_eq_u32 s31, 0
    s_cbranch_scc1 L_g2o_60
    s_mov_b32 s8, s92
    s_mov_b32 s9, s93
    s_mov_b32 s10, 0x200000
    s_mov_b32 s11, 0x00020000
    s_mov_b32 s57, 0
    s_mov_b32 s56, s59
    s_mov_b32 s58, -1
    s_branch L_g2o_60
L_g2o_63:
    s_cmp_eq_u32 s46, 0
    s_cbranch_scc1 L_g2o_65
    buffer_load_dword v22, v21, s[52:55], s39 offen sc1
    s_branch L_g2o_64
L_g2o_66:
    s_sleep 8
    buffer_load_dword v22, v21, s[52:55], s39 offen sc1
    s_waitcnt vmcnt(0)
L_g2o_65:
    v_readfirstlane_b32 s40, v22
    s_cmp_lt_u32 s40, 16
    s_cbranch_scc1 L_g2o_66
    s_cmp_eq_u32 s31, 0
    s_cbranch_scc1 L_g2o_64
    s_mov_b32 s8, s92
    s_mov_b32 s9, s93
    s_mov_b32 s10, 0x200000
    s_mov_b32 s11, 0x00020000
    s_mov_b32 s57, 0
    s_mov_b32 s56, s59
    s_mov_b32 s58, -1
    s_branch L_g2o_64
L_g2o_67:
    s_cmp_eq_u32 s46, 0
    s_cbranch_scc1 L_g2o_69
    buffer_load_dword v22, v21, s[52:55], s39 offen sc1
    s_branch L_g2o_68
L_g2o_70:
    s_sleep 8
    buffer_load_dword v22, v21, s[52:55], s39 offen sc1
    s_waitcnt vmcnt(0)
L_g2o_69:
    v_readfirstlane_b32 s40, v22
    s_cmp_lt_u32 s40, 16
    s_cbranch_scc1 L_g2o_70
    s_cmp_eq_u32 s31, 0
    s_cbranch_scc1 L_g2o_68
    s_mov_b32 s8, s92
    s_mov_b32 s9, s93
    s_mov_b32 s10, 0x200000
    s_mov_b32 s11, 0x00020000
    s_mov_b32 s57, 0
    s_mov_b32 s56, s59
    s_mov_b32 s58, -1
    s_branch L_g2o_68
L_g2o_71:
    s_cmp_eq_u32 s46, 0
    s_cbranch_scc1 L_g2o_73
    buffer_load_dword v22, v21, s[52:55], s39 offen sc1
    s_branch L_g2o_72
L_g2o_74:
    s_sleep 8
    buffer_load_dword v22, v21, s[52:55], s39 offen sc1
    s_waitcnt vmcnt(0)
L_g2o_73:
    v_readfirstlane_b32 s40, v22
    s_cmp_lt_u32 s40, 16
    s_cbranch_scc1 L_g2o_74
    s_cmp_eq_u32 s31, 0
    s_cbranch_scc1 L_g2o_72
    s_mov_b32 s8, s92
    s_mov_b32 s9, s93
    s_mov_b32 s10, 0x200000
    s_mov_b32 s11, 0x00020000
    s_mov_b32 s57, 0
    s_mov_b32 s56, s59
    s_mov_b32 s58, -1
    s_branch L_g2o_72
L_g2o_75:
    s_cmp_eq_u32 s46, 0
    s_cbranch_scc1 L_g2o_77
    buffer_load_dword v22, v21, s[52:55], s39 offen sc1
    s_branch L_g2o_76
L_g2o_78:
    s_sleep 8
    buffer_load_dword v22, v21, s[52:55], s39 offen sc1
    s_waitcnt vmcnt(0)
L_g2o_77:
    v_readfirstlane_b32 s40, v22
    s_cmp_lt_u32 s40, 16
    s_cbranch_scc1 L_g2o_78
    s_cmp_eq_u32 s31, 0
    s_cbranch_scc1 L_g2o_76
    s_mov_b32 s8, s92
    s_mov_b32 s9, s93
    s_mov_b32 s10, 0x200000
    s_mov_b32 s11, 0x00020000
    s_mov_b32 s57, 0
    s_mov_b32 s56, s59
    s_mov_b32 s58, -1
    s_branch L_g2o_76
L_k1_done:
    s_endpgm
.section .rodata,"a"
.p2align 6
.amdhsa_kernel parallel_sum__sliding_block__mixer_channel_mlp__prompt_kernel
  .amdhsa_next_free_vgpr 256
  .amdhsa_next_free_sgpr 96
  .amdhsa_accum_offset 256
  .amdhsa_group_segment_fixed_size 0
  .amdhsa_kernarg_size 88
  .amdhsa_user_sgpr_count 2
  .amdhsa_user_sgpr_kernarg_segment_ptr 1
  .amdhsa_system_sgpr_workgroup_id_x 1
  .amdhsa_float_denorm_mode_32 3
  .amdhsa_float_denorm_mode_16_64 3
.end_amdhsa_kernel
```
